```python
import torch

def _softmax(x, axis=-1):
    return torch.softmax(x, dim=axis)
def _gelu(x):
    return torch.nn.functional.gelu(x, approximate="tanh")
def _silu(x):
    return torch.nn.functional.silu(x)
def _sigmoid(x):
    return torch.sigmoid(x)
def _layernorm(x, axis=-1, eps=1e-5):
    m = x.mean(dim=axis, keepdim=True)
    v = x.var(dim=axis, keepdim=True, unbiased=False)
    return (x - m) / torch.sqrt(v + eps)
def _scatter_add(tgt, idx, src, axis=0):
    return tgt.clone().index_add_(axis, idx, src)
def _segment_sum(src, seg, n):
    out = torch.zeros((n,) + src.shape[1:], dtype=src.dtype)
    return out.index_add_(0, seg, src)
def _pad(x, pw):
    flat = tuple(v for pair in reversed(pw) for v in pair)
    return torch.nn.functional.pad(x, flat)

kernel_name = 'recurrent_scan__spectral_gfnet__glu_gated_swiglu__prompt'

def setup_inputs():

    _w = (lambda a: (lambda t: t.to(torch.bfloat16) if t.is_floating_point() else t)(torch.as_tensor(a)))
    def _A_setup():
        B, S, D = 1, 2048, 640
        Df = D // 2 + 1
        return {
            "x": _w((lambda *s: torch.randn(*s, dtype=torch.bfloat16) * 0.2)(B, S, D)),
            "w_r": _w((lambda *s: torch.randn(*s, dtype=torch.bfloat16) * 1.6)(S, Df) * 0.02),
            "w_i": _w((lambda *s: torch.randn(*s, dtype=torch.bfloat16) * 1.6)(S, Df) * 0.02),
        }
    _A_in = _A_setup()

    def _B_setup():
        B, S, D, F = 1, 2048, 640, 1536
        return {
            "x": _w((lambda *s: torch.randn(*s, dtype=torch.bfloat16) * 0.2)(B, S, D)),
            "w1": _w((lambda *s: torch.randn(*s, dtype=torch.bfloat16) * 0.8)(D, F) * (2.0 / D) ** 0.5),
            "w3": _w((lambda *s: torch.randn(*s, dtype=torch.bfloat16) * 0.8)(D, F) * (2.0 / D) ** 0.5),
            "w2": _w((lambda *s: torch.randn(*s, dtype=torch.bfloat16) * 0.8)(F, D) * (2.0 / F) ** 0.5),
        }
    _B_in = _B_setup()

    return {
        "A_x": _A_in["x"],
        "A_w_r": _A_in["w_r"],
        "A_w_i": _A_in["w_i"],
        "B_x": _B_in["x"],
        "B_w1": _B_in["w1"],
        "B_w3": _B_in["w3"],
        "B_w2": _B_in["w2"],
    }

def reference(A_x, A_w_r, A_w_i, B_x, B_w1, B_w3, B_w2):
    def _A_ref(x, w_r, w_i):
        B, S, D = x.shape
        X = (lambda x, axes=(-2,-1): torch.fft.rfft2(x.float(), dim=axes))(x, axes=(-2, -1))
        W = w_r + 1j * w_i
        X = X * W
        y = (lambda x, s, axes=(-2,-1): torch.fft.irfft2(x, s=s, dim=axes).to(torch.bfloat16))(X, (S, D), axes=(-2, -1))
        return y

    def _B_ref(x, w1, w3, w2):
        gate = torch.einsum("bsd,df->bsf", x, w1)
        up = torch.einsum("bsd,df->bsf", x, w3)
        h = _silu(gate) * up
        out = torch.einsum("bsf,fd->bsd", h, w2)
        return out

    x = A_x
    xn = _layernorm(x, axis=-1)
    s = _A_ref(xn, A_w_r, A_w_i)
    g = _silu(_B_ref(xn, B_w1, B_w3, B_w2))
    return x + s * g
```

```asm
; @launch kernel=k1_kernel grid=(256,1,1) block=(768,1,1) lds=163840
; @launch kernel=k2_kernel grid=(512,1,1) block=(256,1,1) lds=81920
; @launch kernel=k3_kernel grid=(256,1,1) block=(512,1,1) lds=163840
.amdgcn_target "amdgcn-amd-amdhsa--gfx950"
.text
.globl k1_kernel
.p2align 8
.type k1_kernel,@function
k1_kernel:
    s_cmp_ge_u32 s2, 256
    s_cbranch_scc1 K1_END
    s_load_dwordx2 s[4:5], s[0:1], 0
    s_load_dwordx2 s[6:7], s[0:1], 72
    s_load_dwordx4 s[56:59], s[0:1], 8
    s_load_dwordx4 s[60:63], s[0:1], 32
    s_load_dwordx2 s[24:25], s[0:1], 48
    v_lshrrev_b32 v2, 6, v0
    v_and_b32 v1, 63, v0
    v_readfirstlane_b32 s28, v2
    v_lshlrev_b32 v12, 4, v1
    s_and_b32 s26, s2, 63
    s_lshr_b32 s27, s2, 6
    s_mul_i32 s29, s26, 1280
    v_lshrrev_b32 v7, 4, v0
    v_and_b32 v8, 15, v0
    s_mov_b32 s30, 81920
    v_mul_lo_u32 v6, v7, s30
    v_lshl_add_u32 v6, v8, 4, v6
    s_cmp_ge_u32 s28, 10
    s_cbranch_scc1 K1_HLOAD
    s_waitcnt lgkmcnt(0)
    s_cmp_ge_u32 s28, 8
    s_cbranch_scc1 K1_LOADED
    s_mov_b32 s8, s4
    s_mov_b32 s9, s5
    s_mov_b32 s10, 2621440
    s_mov_b32 s11, 0x00020000
    buffer_load_dwordx4 v[16:19], v6, s[8:11], s29 offen offset:0
    buffer_load_dwordx4 v[20:23], v6, s[8:11], s29 offen offset:256
    buffer_load_dwordx4 v[24:27], v6, s[8:11], s29 offen offset:512
    buffer_load_dwordx4 v[28:31], v6, s[8:11], s29 offen offset:768
    buffer_load_dwordx4 v[32:35], v6, s[8:11], s29 offen offset:1024
    s_branch K1_LOADED
K1_HLOAD:
    s_nop 1
    s_setprio 3
    s_getpc_b64 s[32:33]
    s_add_u32 s32, s32, k1_kernel@rel32@lo+4
    s_addc_u32 s33, s33, k1_kernel@rel32@hi+12
    v_lshlrev_b32 v2, 7, v1
    v_min_u32 v2, k2_kernel-k1_kernel-4, v2
    s_cmp_eq_u32 s28, 10
    s_cbranch_scc1 K1_PFT
    global_load_dword v120, v2, s[32:33]
    s_branch K1_PFE
K1_PFT:
    s_nop 0
    s_getpc_b64 s[32:33]
    s_add_u32 s32, s32, TBL_E32F@rel32@lo+4
    s_addc_u32 s33, s33, TBL_E32F@rel32@hi+12
    s_mov_b32 m0, 159744
    s_nop 0
    global_load_lds_dwordx4 v12, s[32:33] offset:0
    global_load_lds_dwordx4 v12, s[32:33] offset:1024
    global_load_lds_dwordx4 v12, s[32:33] offset:2048
    global_load_lds_dwordx4 v12, s[32:33] offset:3072
K1_PFE:
    s_nop 0
    v_and_b32 v11, 15, v1
    v_lshrrev_b32 v10, 4, v1
    s_waitcnt lgkmcnt(0)
    s_branch K1_HELPER
K1_LOADED:
    s_nop 1
    s_cmp_ge_u32 s28, 5
    s_cselect_b32 s41, 1, 0
    s_mul_i32 s30, s41, 5
    s_sub_u32 s40, s28, s30
    s_mov_b32 s12, s6
    s_mov_b32 s13, s7
    s_mov_b32 s14, 2621440
    s_mov_b32 s15, 0x00020000
    s_add_u32 s16, s6, 4194304
    s_addc_u32 s17, s7, 0
    s_mov_b32 s18, 2629632
    s_mov_b32 s19, 0x00020000
    v_and_b32 v11, 15, v1
    v_lshrrev_b32 v10, 4, v1
    s_mul_i32 s30, s27, 80
    s_lshr_b32 s31, s28, 1
    s_lshl_b32 s31, s31, 4
    s_add_u32 s30, s30, s31
    v_add_u32 v9, s30, v11
    s_and_b32 s30, s28, 1
    s_mul_i32 s30, s30, 20
    v_add_u32 v68, s30, v10
    v_mul_u32_u24 v68, v9, v68
    v_lshlrev_b32 v68, 3, v68
    v_cvt_f32_u32 v50, v68
    v_mul_f32 v51, 0x3acccccd, v50
    v_floor_f32 v51, v51
    v_fmac_f32 v50, 0xc4200000, v51
    v_mul_f32 v50, 0xbacccccd, v50
    v_cos_f32 v36, v50
    v_sin_f32 v37, v50
    v_cvt_f32_u32 v50, v9
    v_mul_f32 v51, 0x3acccccd, v50
    v_floor_f32 v51, v51
    v_fmac_f32 v50, 0xc4200000, v51
    v_mul_f32 v50, 0xbacccccd, v50
    v_cos_f32 v42, v50
    v_sin_f32 v43, v50
    v_lshlrev_b32 v68, 5, v9
    v_cvt_f32_u32 v50, v68
    v_mul_f32 v51, 0x3acccccd, v50
    v_floor_f32 v51, v51
    v_fmac_f32 v50, 0xc4200000, v51
    v_mul_f32 v50, 0xbacccccd, v50
    v_cos_f32 v44, v50
    v_sin_f32 v45, v50
    s_mul_i32 s30, s28, 10240
    s_add_u32 s30, s30, 40960
    v_add_u32 v69, s30, v12
    v_cmp_eq_u32 vcc, 0, v9
    v_mov_b32 v68, 0xbf803f80
    v_pk_mul_f32 v[46:47], v[36:37], v[42:43] op_sel_hi:[1,0]
    v_pk_fma_f32 v[38:39], v[36:37], v[42:43], v[46:47] op_sel:[1,1,0] op_sel_hi:[0,1,1] neg_lo:[1,0,0]
    v_cvt_pk_bf16_f32 v52, v36, v38
    v_cvt_pk_bf16_f32 v56, v37, v39
    v_pk_mul_f32 v[48:49], v[36:37], v[44:45] op_sel_hi:[1,0]
    v_pk_fma_f32 v[36:37], v[36:37], v[44:45], v[48:49] op_sel:[1,1,0] op_sel_hi:[0,1,1] neg_lo:[1,0,0]
    v_pk_mul_f32 v[46:47], v[38:39], v[42:43] op_sel_hi:[1,0]
    v_pk_fma_f32 v[40:41], v[38:39], v[42:43], v[46:47] op_sel:[1,1,0] op_sel_hi:[0,1,1] neg_lo:[1,0,0]
    v_pk_mul_f32 v[46:47], v[40:41], v[42:43] op_sel_hi:[1,0]
    v_pk_fma_f32 v[38:39], v[40:41], v[42:43], v[46:47] op_sel:[1,1,0] op_sel_hi:[0,1,1] neg_lo:[1,0,0]
    v_cvt_pk_bf16_f32 v53, v40, v38
    v_cvt_pk_bf16_f32 v57, v41, v39
    v_pk_mul_f32 v[46:47], v[38:39], v[42:43] op_sel_hi:[1,0]
    v_pk_fma_f32 v[40:41], v[38:39], v[42:43], v[46:47] op_sel:[1,1,0] op_sel_hi:[0,1,1] neg_lo:[1,0,0]
    v_pk_mul_f32 v[46:47], v[40:41], v[42:43] op_sel_hi:[1,0]
    v_pk_fma_f32 v[38:39], v[40:41], v[42:43], v[46:47] op_sel:[1,1,0] op_sel_hi:[0,1,1] neg_lo:[1,0,0]
    v_cvt_pk_bf16_f32 v54, v40, v38
    v_cvt_pk_bf16_f32 v58, v41, v39
    v_pk_mul_f32 v[46:47], v[38:39], v[42:43] op_sel_hi:[1,0]
    v_pk_fma_f32 v[40:41], v[38:39], v[42:43], v[46:47] op_sel:[1,1,0] op_sel_hi:[0,1,1] neg_lo:[1,0,0]
    v_pk_mul_f32 v[46:47], v[40:41], v[42:43] op_sel_hi:[1,0]
    v_pk_fma_f32 v[38:39], v[40:41], v[42:43], v[46:47] op_sel:[1,1,0] op_sel_hi:[0,1,1] neg_lo:[1,0,0]
    v_cvt_pk_bf16_f32 v55, v40, v38
    v_cvt_pk_bf16_f32 v59, v41, v39
    v_cndmask_b32 v56, v56, v68, vcc
    v_cndmask_b32 v57, v57, v68, vcc
    v_cndmask_b32 v58, v58, v68, vcc
    v_cndmask_b32 v59, v59, v68, vcc
    ds_write_b128 v69, v[52:55] offset:0
    ds_write_b128 v69, v[56:59] offset:1024
    v_pk_mul_f32 v[46:47], v[36:37], v[42:43] op_sel_hi:[1,0]
    v_pk_fma_f32 v[38:39], v[36:37], v[42:43], v[46:47] op_sel:[1,1,0] op_sel_hi:[0,1,1] neg_lo:[1,0,0]
    v_cvt_pk_bf16_f32 v60, v36, v38
    v_cvt_pk_bf16_f32 v64, v37, v39
    v_pk_mul_f32 v[48:49], v[36:37], v[44:45] op_sel_hi:[1,0]
    v_pk_fma_f32 v[36:37], v[36:37], v[44:45], v[48:49] op_sel:[1,1,0] op_sel_hi:[0,1,1] neg_lo:[1,0,0]
    v_pk_mul_f32 v[46:47], v[38:39], v[42:43] op_sel_hi:[1,0]
    v_pk_fma_f32 v[40:41], v[38:39], v[42:43], v[46:47] op_sel:[1,1,0] op_sel_hi:[0,1,1] neg_lo:[1,0,0]
    v_pk_mul_f32 v[46:47], v[40:41], v[42:43] op_sel_hi:[1,0]
    v_pk_fma_f32 v[38:39], v[40:41], v[42:43], v[46:47] op_sel:[1,1,0] op_sel_hi:[0,1,1] neg_lo:[1,0,0]
    v_cvt_pk_bf16_f32 v61, v40, v38
    v_cvt_pk_bf16_f32 v65, v41, v39
    v_pk_mul_f32 v[46:47], v[38:39], v[42:43] op_sel_hi:[1,0]
    v_pk_fma_f32 v[40:41], v[38:39], v[42:43], v[46:47] op_sel:[1,1,0] op_sel_hi:[0,1,1] neg_lo:[1,0,0]
    v_pk_mul_f32 v[46:47], v[40:41], v[42:43] op_sel_hi:[1,0]
    v_pk_fma_f32 v[38:39], v[40:41], v[42:43], v[46:47] op_sel:[1,1,0] op_sel_hi:[0,1,1] neg_lo:[1,0,0]
    v_cvt_pk_bf16_f32 v62, v40, v38
    v_cvt_pk_bf16_f32 v66, v41, v39
    v_pk_mul_f32 v[46:47], v[38:39], v[42:43] op_sel_hi:[1,0]
    v_pk_fma_f32 v[40:41], v[38:39], v[42:43], v[46:47] op_sel:[1,1,0] op_sel_hi:[0,1,1] neg_lo:[1,0,0]
    v_pk_mul_f32 v[46:47], v[40:41], v[42:43] op_sel_hi:[1,0]
    v_pk_fma_f32 v[38:39], v[40:41], v[42:43], v[46:47] op_sel:[1,1,0] op_sel_hi:[0,1,1] neg_lo:[1,0,0]
    v_cvt_pk_bf16_f32 v63, v40, v38
    v_cvt_pk_bf16_f32 v67, v41, v39
    v_cndmask_b32 v64, v64, v68, vcc
    v_cndmask_b32 v65, v65, v68, vcc
    v_cndmask_b32 v66, v66, v68, vcc
    v_cndmask_b32 v67, v67, v68, vcc
    ds_write_b128 v69, v[60:63] offset:2048
    ds_write_b128 v69, v[64:67] offset:3072
    v_pk_mul_f32 v[46:47], v[36:37], v[42:43] op_sel_hi:[1,0]
    v_pk_fma_f32 v[38:39], v[36:37], v[42:43], v[46:47] op_sel:[1,1,0] op_sel_hi:[0,1,1] neg_lo:[1,0,0]
    v_cvt_pk_bf16_f32 v52, v36, v38
    v_cvt_pk_bf16_f32 v56, v37, v39
    v_pk_mul_f32 v[48:49], v[36:37], v[44:45] op_sel_hi:[1,0]
    v_pk_fma_f32 v[36:37], v[36:37], v[44:45], v[48:49] op_sel:[1,1,0] op_sel_hi:[0,1,1] neg_lo:[1,0,0]
    v_pk_mul_f32 v[46:47], v[38:39], v[42:43] op_sel_hi:[1,0]
    v_pk_fma_f32 v[40:41], v[38:39], v[42:43], v[46:47] op_sel:[1,1,0] op_sel_hi:[0,1,1] neg_lo:[1,0,0]
    v_pk_mul_f32 v[46:47], v[40:41], v[42:43] op_sel_hi:[1,0]
    v_pk_fma_f32 v[38:39], v[40:41], v[42:43], v[46:47] op_sel:[1,1,0] op_sel_hi:[0,1,1] neg_lo:[1,0,0]
    v_cvt_pk_bf16_f32 v53, v40, v38
    v_cvt_pk_bf16_f32 v57, v41, v39
    v_pk_mul_f32 v[46:47], v[38:39], v[42:43] op_sel_hi:[1,0]
    v_pk_fma_f32 v[40:41], v[38:39], v[42:43], v[46:47] op_sel:[1,1,0] op_sel_hi:[0,1,1] neg_lo:[1,0,0]
    v_pk_mul_f32 v[46:47], v[40:41], v[42:43] op_sel_hi:[1,0]
    v_pk_fma_f32 v[38:39], v[40:41], v[42:43], v[46:47] op_sel:[1,1,0] op_sel_hi:[0,1,1] neg_lo:[1,0,0]
    v_cvt_pk_bf16_f32 v54, v40, v38
    v_cvt_pk_bf16_f32 v58, v41, v39
    v_pk_mul_f32 v[46:47], v[38:39], v[42:43] op_sel_hi:[1,0]
    v_pk_fma_f32 v[40:41], v[38:39], v[42:43], v[46:47] op_sel:[1,1,0] op_sel_hi:[0,1,1] neg_lo:[1,0,0]
    v_pk_mul_f32 v[46:47], v[40:41], v[42:43] op_sel_hi:[1,0]
    v_pk_fma_f32 v[38:39], v[40:41], v[42:43], v[46:47] op_sel:[1,1,0] op_sel_hi:[0,1,1] neg_lo:[1,0,0]
    v_cvt_pk_bf16_f32 v55, v40, v38
    v_cvt_pk_bf16_f32 v59, v41, v39
    v_cndmask_b32 v56, v56, v68, vcc
    v_cndmask_b32 v57, v57, v68, vcc
    v_cndmask_b32 v58, v58, v68, vcc
    v_cndmask_b32 v59, v59, v68, vcc
    ds_write_b128 v69, v[52:55] offset:4096
    ds_write_b128 v69, v[56:59] offset:5120
    v_pk_mul_f32 v[46:47], v[36:37], v[42:43] op_sel_hi:[1,0]
    v_pk_fma_f32 v[38:39], v[36:37], v[42:43], v[46:47] op_sel:[1,1,0] op_sel_hi:[0,1,1] neg_lo:[1,0,0]
    v_cvt_pk_bf16_f32 v60, v36, v38
    v_cvt_pk_bf16_f32 v64, v37, v39
    v_pk_mul_f32 v[48:49], v[36:37], v[44:45] op_sel_hi:[1,0]
    v_pk_fma_f32 v[36:37], v[36:37], v[44:45], v[48:49] op_sel:[1,1,0] op_sel_hi:[0,1,1] neg_lo:[1,0,0]
    v_pk_mul_f32 v[46:47], v[38:39], v[42:43] op_sel_hi:[1,0]
    v_pk_fma_f32 v[40:41], v[38:39], v[42:43], v[46:47] op_sel:[1,1,0] op_sel_hi:[0,1,1] neg_lo:[1,0,0]
    v_pk_mul_f32 v[46:47], v[40:41], v[42:43] op_sel_hi:[1,0]
    v_pk_fma_f32 v[38:39], v[40:41], v[42:43], v[46:47] op_sel:[1,1,0] op_sel_hi:[0,1,1] neg_lo:[1,0,0]
    v_cvt_pk_bf16_f32 v61, v40, v38
    v_cvt_pk_bf16_f32 v65, v41, v39
    v_pk_mul_f32 v[46:47], v[38:39], v[42:43] op_sel_hi:[1,0]
    v_pk_fma_f32 v[40:41], v[38:39], v[42:43], v[46:47] op_sel:[1,1,0] op_sel_hi:[0,1,1] neg_lo:[1,0,0]
    v_pk_mul_f32 v[46:47], v[40:41], v[42:43] op_sel_hi:[1,0]
    v_pk_fma_f32 v[38:39], v[40:41], v[42:43], v[46:47] op_sel:[1,1,0] op_sel_hi:[0,1,1] neg_lo:[1,0,0]
    v_cvt_pk_bf16_f32 v62, v40, v38
    v_cvt_pk_bf16_f32 v66, v41, v39
    v_pk_mul_f32 v[46:47], v[38:39], v[42:43] op_sel_hi:[1,0]
    v_pk_fma_f32 v[40:41], v[38:39], v[42:43], v[46:47] op_sel:[1,1,0] op_sel_hi:[0,1,1] neg_lo:[1,0,0]
    v_pk_mul_f32 v[46:47], v[40:41], v[42:43] op_sel_hi:[1,0]
    v_pk_fma_f32 v[38:39], v[40:41], v[42:43], v[46:47] op_sel:[1,1,0] op_sel_hi:[0,1,1] neg_lo:[1,0,0]
    v_cvt_pk_bf16_f32 v63, v40, v38
    v_cvt_pk_bf16_f32 v67, v41, v39
    v_cndmask_b32 v64, v64, v68, vcc
    v_cndmask_b32 v65, v65, v68, vcc
    v_cndmask_b32 v66, v66, v68, vcc
    v_cndmask_b32 v67, v67, v68, vcc
    ds_write_b128 v69, v[60:63] offset:6144
    ds_write_b128 v69, v[64:67] offset:7168
    v_pk_mul_f32 v[46:47], v[36:37], v[42:43] op_sel_hi:[1,0]
    v_pk_fma_f32 v[38:39], v[36:37], v[42:43], v[46:47] op_sel:[1,1,0] op_sel_hi:[0,1,1] neg_lo:[1,0,0]
    v_cvt_pk_bf16_f32 v52, v36, v38
    v_cvt_pk_bf16_f32 v56, v37, v39
    v_pk_mul_f32 v[46:47], v[38:39], v[42:43] op_sel_hi:[1,0]
    v_pk_fma_f32 v[40:41], v[38:39], v[42:43], v[46:47] op_sel:[1,1,0] op_sel_hi:[0,1,1] neg_lo:[1,0,0]
    v_pk_mul_f32 v[46:47], v[40:41], v[42:43] op_sel_hi:[1,0]
    v_pk_fma_f32 v[38:39], v[40:41], v[42:43], v[46:47] op_sel:[1,1,0] op_sel_hi:[0,1,1] neg_lo:[1,0,0]
    v_cvt_pk_bf16_f32 v53, v40, v38
    v_cvt_pk_bf16_f32 v57, v41, v39
    v_pk_mul_f32 v[46:47], v[38:39], v[42:43] op_sel_hi:[1,0]
    v_pk_fma_f32 v[40:41], v[38:39], v[42:43], v[46:47] op_sel:[1,1,0] op_sel_hi:[0,1,1] neg_lo:[1,0,0]
    v_pk_mul_f32 v[46:47], v[40:41], v[42:43] op_sel_hi:[1,0]
    v_pk_fma_f32 v[38:39], v[40:41], v[42:43], v[46:47] op_sel:[1,1,0] op_sel_hi:[0,1,1] neg_lo:[1,0,0]
    v_cvt_pk_bf16_f32 v54, v40, v38
    v_cvt_pk_bf16_f32 v58, v41, v39
    v_pk_mul_f32 v[46:47], v[38:39], v[42:43] op_sel_hi:[1,0]
    v_pk_fma_f32 v[40:41], v[38:39], v[42:43], v[46:47] op_sel:[1,1,0] op_sel_hi:[0,1,1] neg_lo:[1,0,0]
    v_pk_mul_f32 v[46:47], v[40:41], v[42:43] op_sel_hi:[1,0]
    v_pk_fma_f32 v[38:39], v[40:41], v[42:43], v[46:47] op_sel:[1,1,0] op_sel_hi:[0,1,1] neg_lo:[1,0,0]
    v_cvt_pk_bf16_f32 v55, v40, v38
    v_cvt_pk_bf16_f32 v59, v41, v39
    v_cndmask_b32 v56, v56, v68, vcc
    v_cndmask_b32 v57, v57, v68, vcc
    v_cndmask_b32 v58, v58, v68, vcc
    v_cndmask_b32 v59, v59, v68, vcc
    ds_write_b128 v69, v[52:55] offset:8192
    ds_write_b128 v69, v[56:59] offset:9216
    s_mul_i32 s30, s27, 80
    s_lshl_b32 s31, s40, 4
    s_add_u32 s30, s30, s31
    v_add_u32 v9, s30, v11
    s_cmp_ge_u32 s28, 8
    s_cbranch_scc1 K1_LNDONE
    s_waitcnt vmcnt(0)
    v_mov_b32 v4, 0x3f803f80
    v_mov_b32 v2, 0
    v_mov_b32 v3, 0
    v_dot2_f32_bf16 v2, v16, v4, v2
    v_dot2_f32_bf16 v3, v17, v4, v3
    v_dot2_f32_bf16 v2, v18, v4, v2
    v_dot2_f32_bf16 v3, v19, v4, v3
    v_dot2_f32_bf16 v2, v20, v4, v2
    v_dot2_f32_bf16 v3, v21, v4, v3
    v_dot2_f32_bf16 v2, v22, v4, v2
    v_dot2_f32_bf16 v3, v23, v4, v3
    v_dot2_f32_bf16 v2, v24, v4, v2
    v_dot2_f32_bf16 v3, v25, v4, v3
    v_dot2_f32_bf16 v2, v26, v4, v2
    v_dot2_f32_bf16 v3, v27, v4, v3
    v_dot2_f32_bf16 v2, v28, v4, v2
    v_dot2_f32_bf16 v3, v29, v4, v3
    v_dot2_f32_bf16 v2, v30, v4, v2
    v_dot2_f32_bf16 v3, v31, v4, v3
    v_dot2_f32_bf16 v2, v32, v4, v2
    v_dot2_f32_bf16 v3, v33, v4, v3
    v_dot2_f32_bf16 v2, v34, v4, v2
    v_dot2_f32_bf16 v3, v35, v4, v3
    s_nop 2
    v_add_f32 v2, v2, v3
    s_nop 1
    v_add_f32_dpp v2, v2, v2 quad_perm:[1,0,3,2] row_mask:0xf bank_mask:0xf
    s_nop 1
    v_add_f32_dpp v2, v2, v2 quad_perm:[2,3,0,1] row_mask:0xf bank_mask:0xf
    s_nop 1
    v_add_f32_dpp v2, v2, v2 row_half_mirror row_mask:0xf bank_mask:0xf
    s_nop 1
    v_add_f32_dpp v2, v2, v2 row_mirror row_mask:0xf bank_mask:0xf
    v_mul_f32 v2, 0x3acccccd, v2
    v_cvt_pk_bf16_f32 v4, v2, v2
    v_lshlrev_b32 v4, 16, v4
    v_sub_f32 v3, v2, v4
    v_mov_b32 v5, 0xffff0000
    v_mov_b32 v36, 0
    v_mov_b32 v37, 0
    v_mov_b32 v38, 0
    v_mov_b32 v39, 0
    v_lshlrev_b32 v40, 16, v16
    v_and_b32 v41, v5, v16
    v_pk_add_f32 v[40:41], v[40:41], v[4:5] op_sel_hi:[1,0] neg_lo:[0,1] neg_hi:[0,1]
    v_pk_fma_f32 v[36:37], v[40:41], v[40:41], v[36:37]
    v_cvt_pk_bf16_f32 v16, v40, v41
    v_lshlrev_b32 v42, 16, v17
    v_and_b32 v43, v5, v17
    v_pk_add_f32 v[42:43], v[42:43], v[4:5] op_sel_hi:[1,0] neg_lo:[0,1] neg_hi:[0,1]
    v_pk_fma_f32 v[38:39], v[42:43], v[42:43], v[38:39]
    v_cvt_pk_bf16_f32 v17, v42, v43
    v_lshlrev_b32 v44, 16, v18
    v_and_b32 v45, v5, v18
    v_pk_add_f32 v[44:45], v[44:45], v[4:5] op_sel_hi:[1,0] neg_lo:[0,1] neg_hi:[0,1]
    v_pk_fma_f32 v[36:37], v[44:45], v[44:45], v[36:37]
    v_cvt_pk_bf16_f32 v18, v44, v45
    v_lshlrev_b32 v46, 16, v19
    v_and_b32 v47, v5, v19
    v_pk_add_f32 v[46:47], v[46:47], v[4:5] op_sel_hi:[1,0] neg_lo:[0,1] neg_hi:[0,1]
    v_pk_fma_f32 v[38:39], v[46:47], v[46:47], v[38:39]
    v_cvt_pk_bf16_f32 v19, v46, v47
    v_lshlrev_b32 v40, 16, v20
    v_and_b32 v41, v5, v20
    v_pk_add_f32 v[40:41], v[40:41], v[4:5] op_sel_hi:[1,0] neg_lo:[0,1] neg_hi:[0,1]
    v_pk_fma_f32 v[36:37], v[40:41], v[40:41], v[36:37]
    v_cvt_pk_bf16_f32 v20, v40, v41
    v_lshlrev_b32 v42, 16, v21
    v_and_b32 v43, v5, v21
    v_pk_add_f32 v[42:43], v[42:43], v[4:5] op_sel_hi:[1,0] neg_lo:[0,1] neg_hi:[0,1]
    v_pk_fma_f32 v[38:39], v[42:43], v[42:43], v[38:39]
    v_cvt_pk_bf16_f32 v21, v42, v43
    v_lshlrev_b32 v44, 16, v22
    v_and_b32 v45, v5, v22
    v_pk_add_f32 v[44:45], v[44:45], v[4:5] op_sel_hi:[1,0] neg_lo:[0,1] neg_hi:[0,1]
    v_pk_fma_f32 v[36:37], v[44:45], v[44:45], v[36:37]
    v_cvt_pk_bf16_f32 v22, v44, v45
    v_lshlrev_b32 v46, 16, v23
    v_and_b32 v47, v5, v23
    v_pk_add_f32 v[46:47], v[46:47], v[4:5] op_sel_hi:[1,0] neg_lo:[0,1] neg_hi:[0,1]
    v_pk_fma_f32 v[38:39], v[46:47], v[46:47], v[38:39]
    v_cvt_pk_bf16_f32 v23, v46, v47
    v_lshlrev_b32 v40, 16, v24
    v_and_b32 v41, v5, v24
    v_pk_add_f32 v[40:41], v[40:41], v[4:5] op_sel_hi:[1,0] neg_lo:[0,1] neg_hi:[0,1]
    v_pk_fma_f32 v[36:37], v[40:41], v[40:41], v[36:37]
    v_cvt_pk_bf16_f32 v24, v40, v41
    v_lshlrev_b32 v42, 16, v25
    v_and_b32 v43, v5, v25
    v_pk_add_f32 v[42:43], v[42:43], v[4:5] op_sel_hi:[1,0] neg_lo:[0,1] neg_hi:[0,1]
    v_pk_fma_f32 v[38:39], v[42:43], v[42:43], v[38:39]
    v_cvt_pk_bf16_f32 v25, v42, v43
    v_lshlrev_b32 v44, 16, v26
    v_and_b32 v45, v5, v26
    v_pk_add_f32 v[44:45], v[44:45], v[4:5] op_sel_hi:[1,0] neg_lo:[0,1] neg_hi:[0,1]
    v_pk_fma_f32 v[36:37], v[44:45], v[44:45], v[36:37]
    v_cvt_pk_bf16_f32 v26, v44, v45
    v_lshlrev_b32 v46, 16, v27
    v_and_b32 v47, v5, v27
    v_pk_add_f32 v[46:47], v[46:47], v[4:5] op_sel_hi:[1,0] neg_lo:[0,1] neg_hi:[0,1]
    v_pk_fma_f32 v[38:39], v[46:47], v[46:47], v[38:39]
    v_cvt_pk_bf16_f32 v27, v46, v47
    v_lshlrev_b32 v40, 16, v28
    v_and_b32 v41, v5, v28
    v_pk_add_f32 v[40:41], v[40:41], v[4:5] op_sel_hi:[1,0] neg_lo:[0,1] neg_hi:[0,1]
    v_pk_fma_f32 v[36:37], v[40:41], v[40:41], v[36:37]
    v_cvt_pk_bf16_f32 v28, v40, v41
    v_lshlrev_b32 v42, 16, v29
    v_and_b32 v43, v5, v29
    v_pk_add_f32 v[42:43], v[42:43], v[4:5] op_sel_hi:[1,0] neg_lo:[0,1] neg_hi:[0,1]
    v_pk_fma_f32 v[38:39], v[42:43], v[42:43], v[38:39]
    v_cvt_pk_bf16_f32 v29, v42, v43
    v_lshlrev_b32 v44, 16, v30
    v_and_b32 v45, v5, v30
    v_pk_add_f32 v[44:45], v[44:45], v[4:5] op_sel_hi:[1,0] neg_lo:[0,1] neg_hi:[0,1]
    v_pk_fma_f32 v[36:37], v[44:45], v[44:45], v[36:37]
    v_cvt_pk_bf16_f32 v30, v44, v45
    v_lshlrev_b32 v46, 16, v31
    v_and_b32 v47, v5, v31
    v_pk_add_f32 v[46:47], v[46:47], v[4:5] op_sel_hi:[1,0] neg_lo:[0,1] neg_hi:[0,1]
    v_pk_fma_f32 v[38:39], v[46:47], v[46:47], v[38:39]
    v_cvt_pk_bf16_f32 v31, v46, v47
    v_lshlrev_b32 v40, 16, v32
    v_and_b32 v41, v5, v32
    v_pk_add_f32 v[40:41], v[40:41], v[4:5] op_sel_hi:[1,0] neg_lo:[0,1] neg_hi:[0,1]
    v_pk_fma_f32 v[36:37], v[40:41], v[40:41], v[36:37]
    v_cvt_pk_bf16_f32 v32, v40, v41
    v_lshlrev_b32 v42, 16, v33
    v_and_b32 v43, v5, v33
    v_pk_add_f32 v[42:43], v[42:43], v[4:5] op_sel_hi:[1,0] neg_lo:[0,1] neg_hi:[0,1]
    v_pk_fma_f32 v[38:39], v[42:43], v[42:43], v[38:39]
    v_cvt_pk_bf16_f32 v33, v42, v43
    v_lshlrev_b32 v44, 16, v34
    v_and_b32 v45, v5, v34
    v_pk_add_f32 v[44:45], v[44:45], v[4:5] op_sel_hi:[1,0] neg_lo:[0,1] neg_hi:[0,1]
    v_pk_fma_f32 v[36:37], v[44:45], v[44:45], v[36:37]
    v_cvt_pk_bf16_f32 v34, v44, v45
    v_lshlrev_b32 v46, 16, v35
    v_and_b32 v47, v5, v35
    v_pk_add_f32 v[46:47], v[46:47], v[4:5] op_sel_hi:[1,0] neg_lo:[0,1] neg_hi:[0,1]
    v_pk_fma_f32 v[38:39], v[46:47], v[46:47], v[38:39]
    v_cvt_pk_bf16_f32 v35, v46, v47
    v_pk_add_f32 v[36:37], v[36:37], v[38:39]
    v_add_f32 v36, v36, v37
    s_nop 1
    v_add_f32_dpp v36, v36, v36 quad_perm:[1,0,3,2] row_mask:0xf bank_mask:0xf
    s_nop 1
    v_add_f32_dpp v36, v36, v36 quad_perm:[2,3,0,1] row_mask:0xf bank_mask:0xf
    s_nop 1
    v_add_f32_dpp v36, v36, v36 row_half_mirror row_mask:0xf bank_mask:0xf
    s_nop 1
    v_add_f32_dpp v36, v36, v36 row_mirror row_mask:0xf bank_mask:0xf
    v_mul_f32 v36, 0x3acccccd, v36
    v_fma_f32 v36, -v3, v3, v36
    v_max_f32 v36, 0, v36
    v_cvt_pk_bf16_f32 v36, v36, v36
    v_lshlrev_b32 v36, 16, v36
    v_add_f32 v36, 0x3727c5ac, v36
    v_cvt_pk_bf16_f32 v36, v36, v36
    v_lshlrev_b32 v36, 16, v36
    v_sqrt_f32 v36, v36
    s_nop 0
    v_cvt_pk_bf16_f32 v36, v36, v36
    v_lshlrev_b32 v36, 16, v36
    v_rcp_f32 v4, v36
    v_and_b32 v3, 15, v7
    v_xor_b32 v3, v3, v8
    v_mul_u32_u24 v2, 1280, v7
    v_lshl_add_u32 v2, v3, 4, v2
    v_lshlrev_b32 v40, 16, v16
    v_and_b32 v41, v5, v16
    v_pk_mul_f32 v[40:41], v[40:41], v[4:5] op_sel_hi:[1,0]
    v_cvt_pk_bf16_f32 v16, v40, v41
    v_lshlrev_b32 v42, 16, v17
    v_and_b32 v43, v5, v17
    v_pk_mul_f32 v[42:43], v[42:43], v[4:5] op_sel_hi:[1,0]
    v_cvt_pk_bf16_f32 v17, v42, v43
    v_lshlrev_b32 v44, 16, v18
    v_and_b32 v45, v5, v18
    v_pk_mul_f32 v[44:45], v[44:45], v[4:5] op_sel_hi:[1,0]
    v_cvt_pk_bf16_f32 v18, v44, v45
    v_lshlrev_b32 v46, 16, v19
    v_and_b32 v47, v5, v19
    v_pk_mul_f32 v[46:47], v[46:47], v[4:5] op_sel_hi:[1,0]
    v_cvt_pk_bf16_f32 v19, v46, v47
    ds_write_b128 v2, v[16:19] offset:0
    v_lshlrev_b32 v40, 16, v20
    v_and_b32 v41, v5, v20
    v_pk_mul_f32 v[40:41], v[40:41], v[4:5] op_sel_hi:[1,0]
    v_cvt_pk_bf16_f32 v20, v40, v41
    v_lshlrev_b32 v42, 16, v21
    v_and_b32 v43, v5, v21
    v_pk_mul_f32 v[42:43], v[42:43], v[4:5] op_sel_hi:[1,0]
    v_cvt_pk_bf16_f32 v21, v42, v43
    v_lshlrev_b32 v44, 16, v22
    v_and_b32 v45, v5, v22
    v_pk_mul_f32 v[44:45], v[44:45], v[4:5] op_sel_hi:[1,0]
    v_cvt_pk_bf16_f32 v22, v44, v45
    v_lshlrev_b32 v46, 16, v23
    v_and_b32 v47, v5, v23
    v_pk_mul_f32 v[46:47], v[46:47], v[4:5] op_sel_hi:[1,0]
    v_cvt_pk_bf16_f32 v23, v46, v47
    ds_write_b128 v2, v[20:23] offset:256
    v_lshlrev_b32 v40, 16, v24
    v_and_b32 v41, v5, v24
    v_pk_mul_f32 v[40:41], v[40:41], v[4:5] op_sel_hi:[1,0]
    v_cvt_pk_bf16_f32 v24, v40, v41
    v_lshlrev_b32 v42, 16, v25
    v_and_b32 v43, v5, v25
    v_pk_mul_f32 v[42:43], v[42:43], v[4:5] op_sel_hi:[1,0]
    v_cvt_pk_bf16_f32 v25, v42, v43
    v_lshlrev_b32 v44, 16, v26
    v_and_b32 v45, v5, v26
    v_pk_mul_f32 v[44:45], v[44:45], v[4:5] op_sel_hi:[1,0]
    v_cvt_pk_bf16_f32 v26, v44, v45
    v_lshlrev_b32 v46, 16, v27
    v_and_b32 v47, v5, v27
    v_pk_mul_f32 v[46:47], v[46:47], v[4:5] op_sel_hi:[1,0]
    v_cvt_pk_bf16_f32 v27, v46, v47
    ds_write_b128 v2, v[24:27] offset:512
    v_lshlrev_b32 v40, 16, v28
    v_and_b32 v41, v5, v28
    v_pk_mul_f32 v[40:41], v[40:41], v[4:5] op_sel_hi:[1,0]
    v_cvt_pk_bf16_f32 v28, v40, v41
    v_lshlrev_b32 v42, 16, v29
    v_and_b32 v43, v5, v29
    v_pk_mul_f32 v[42:43], v[42:43], v[4:5] op_sel_hi:[1,0]
    v_cvt_pk_bf16_f32 v29, v42, v43
    v_lshlrev_b32 v44, 16, v30
    v_and_b32 v45, v5, v30
    v_pk_mul_f32 v[44:45], v[44:45], v[4:5] op_sel_hi:[1,0]
    v_cvt_pk_bf16_f32 v30, v44, v45
    v_lshlrev_b32 v46, 16, v31
    v_and_b32 v47, v5, v31
    v_pk_mul_f32 v[46:47], v[46:47], v[4:5] op_sel_hi:[1,0]
    v_cvt_pk_bf16_f32 v31, v46, v47
    ds_write_b128 v2, v[28:31] offset:768
    v_lshlrev_b32 v40, 16, v32
    v_and_b32 v41, v5, v32
    v_pk_mul_f32 v[40:41], v[40:41], v[4:5] op_sel_hi:[1,0]
    v_cvt_pk_bf16_f32 v32, v40, v41
    v_lshlrev_b32 v42, 16, v33
    v_and_b32 v43, v5, v33
    v_pk_mul_f32 v[42:43], v[42:43], v[4:5] op_sel_hi:[1,0]
    v_cvt_pk_bf16_f32 v33, v42, v43
    v_lshlrev_b32 v44, 16, v34
    v_and_b32 v45, v5, v34
    v_pk_mul_f32 v[44:45], v[44:45], v[4:5] op_sel_hi:[1,0]
    v_cvt_pk_bf16_f32 v34, v44, v45
    v_lshlrev_b32 v46, 16, v35
    v_and_b32 v47, v5, v35
    v_pk_mul_f32 v[46:47], v[46:47], v[4:5] op_sel_hi:[1,0]
    v_cvt_pk_bf16_f32 v35, v46, v47
    ds_write_b128 v2, v[32:35] offset:1024
K1_LNDONE:
    s_nop 1
    v_and_b32 v2, 3, v11
    v_xor_b32 v2, v2, v10
    v_lshrrev_b32 v3, 2, v11
    v_mul_u32_u24 v4, 1280, v11
    v_lshl_add_u32 v4, v2, 4, v4
    s_lshl_b32 s30, s41, 1
    s_lshl_b32 s31, s41, 9
    s_mul_i32 s42, s41, 768
    s_add_u32 s32, s30, 0
    s_and_b32 s32, s32, 3
    v_xor_b32 v2, s32, v3
    v_lshl_add_u32 v96, v2, 6, v4
    v_add_u32 v96, s31, v96
    s_add_u32 s32, s30, 1
    s_and_b32 s32, s32, 3
    v_xor_b32 v2, s32, v3
    v_lshl_add_u32 v97, v2, 6, v4
    v_add_u32 v97, s31, v97
    s_add_u32 s32, s30, 2
    s_and_b32 s32, s32, 3
    v_xor_b32 v2, s32, v3
    v_lshl_add_u32 v98, v2, 6, v4
    v_add_u32 v98, s42, v98
    s_add_u32 s32, s30, 3
    s_and_b32 s32, s32, 3
    v_xor_b32 v2, s32, v3
    v_lshl_add_u32 v99, v2, 6, v4
    v_add_u32 v99, s42, v99
    s_mul_i32 s30, s40, 20480
    s_add_u32 s30, s30, 40960
    v_add_u32 v100, s30, v12
    s_waitcnt lgkmcnt(0)
    s_barrier
    ds_read_b128 v[16:19], v96 offset:0
    ds_read_b128 v[24:27], v100 offset:0
    ds_read_b128 v[28:31], v100 offset:1024
    ds_read_b128 v[20:23], v96 offset:20480
    ds_read_b128 v[32:35], v97 offset:0
    ds_read_b128 v[40:43], v100 offset:2048
    ds_read_b128 v[44:47], v100 offset:3072
    ds_read_b128 v[36:39], v97 offset:20480
    ds_read_b128 v[48:51], v98 offset:0
    ds_read_b128 v[56:59], v100 offset:4096
    ds_read_b128 v[60:63], v100 offset:5120
    ds_read_b128 v[52:55], v98 offset:20480
    s_waitcnt lgkmcnt(8)
    v_mfma_f32_16x16x32_bf16 v[104:107], v[16:19], v[24:27], 0
    v_mfma_f32_16x16x32_bf16 v[112:115], v[16:19], v[28:31], 0
    v_mfma_f32_16x16x32_bf16 v[108:111], v[20:23], v[24:27], 0
    v_mfma_f32_16x16x32_bf16 v[116:119], v[20:23], v[28:31], 0
    ds_read_b128 v[16:19], v99 offset:0
    ds_read_b128 v[24:27], v100 offset:6144
    ds_read_b128 v[28:31], v100 offset:7168
    ds_read_b128 v[20:23], v99 offset:20480
    s_waitcnt lgkmcnt(8)
    v_mfma_f32_16x16x32_bf16 v[104:107], v[32:35], v[40:43], v[104:107]
    v_mfma_f32_16x16x32_bf16 v[112:115], v[32:35], v[44:47], v[112:115]
    v_mfma_f32_16x16x32_bf16 v[108:111], v[36:39], v[40:43], v[108:111]
    v_mfma_f32_16x16x32_bf16 v[116:119], v[36:39], v[44:47], v[116:119]
    ds_read_b128 v[32:35], v96 offset:256
    ds_read_b128 v[40:43], v100 offset:8192
    ds_read_b128 v[44:47], v100 offset:9216
    ds_read_b128 v[36:39], v96 offset:20736
    s_waitcnt lgkmcnt(8)
    v_mfma_f32_16x16x32_bf16 v[104:107], v[48:51], v[56:59], v[104:107]
    v_mfma_f32_16x16x32_bf16 v[112:115], v[48:51], v[60:63], v[112:115]
    v_mfma_f32_16x16x32_bf16 v[108:111], v[52:55], v[56:59], v[108:111]
    v_mfma_f32_16x16x32_bf16 v[116:119], v[52:55], v[60:63], v[116:119]
    ds_read_b128 v[48:51], v97 offset:256
    ds_read_b128 v[56:59], v100 offset:10240
    ds_read_b128 v[60:63], v100 offset:11264
    ds_read_b128 v[52:55], v97 offset:20736
    s_waitcnt lgkmcnt(8)
    v_mfma_f32_16x16x32_bf16 v[104:107], v[16:19], v[24:27], v[104:107]
    v_mfma_f32_16x16x32_bf16 v[112:115], v[16:19], v[28:31], v[112:115]
    v_mfma_f32_16x16x32_bf16 v[108:111], v[20:23], v[24:27], v[108:111]
    v_mfma_f32_16x16x32_bf16 v[116:119], v[20:23], v[28:31], v[116:119]
    ds_read_b128 v[16:19], v98 offset:256
    ds_read_b128 v[24:27], v100 offset:12288
    ds_read_b128 v[28:31], v100 offset:13312
    ds_read_b128 v[20:23], v98 offset:20736
    s_waitcnt lgkmcnt(8)
    v_mfma_f32_16x16x32_bf16 v[104:107], v[32:35], v[40:43], v[104:107]
    v_mfma_f32_16x16x32_bf16 v[112:115], v[32:35], v[44:47], v[112:115]
    v_mfma_f32_16x16x32_bf16 v[108:111], v[36:39], v[40:43], v[108:111]
    v_mfma_f32_16x16x32_bf16 v[116:119], v[36:39], v[44:47], v[116:119]
    ds_read_b128 v[32:35], v99 offset:256
    ds_read_b128 v[40:43], v100 offset:14336
    ds_read_b128 v[44:47], v100 offset:15360
    ds_read_b128 v[36:39], v99 offset:20736
    s_waitcnt lgkmcnt(8)
    v_mfma_f32_16x16x32_bf16 v[104:107], v[48:51], v[56:59], v[104:107]
    v_mfma_f32_16x16x32_bf16 v[112:115], v[48:51], v[60:63], v[112:115]
    v_mfma_f32_16x16x32_bf16 v[108:111], v[52:55], v[56:59], v[108:111]
    v_mfma_f32_16x16x32_bf16 v[116:119], v[52:55], v[60:63], v[116:119]
    ds_read_b128 v[48:51], v96 offset:512
    ds_read_b128 v[56:59], v100 offset:16384
    ds_read_b128 v[60:63], v100 offset:17408
    ds_read_b128 v[52:55], v96 offset:20992
    s_waitcnt lgkmcnt(8)
    v_mfma_f32_16x16x32_bf16 v[104:107], v[16:19], v[24:27], v[104:107]
    v_mfma_f32_16x16x32_bf16 v[112:115], v[16:19], v[28:31], v[112:115]
    v_mfma_f32_16x16x32_bf16 v[108:111], v[20:23], v[24:27], v[108:111]
    v_mfma_f32_16x16x32_bf16 v[116:119], v[20:23], v[28:31], v[116:119]
    ds_read_b128 v[16:19], v97 offset:512
    ds_read_b128 v[24:27], v100 offset:18432
    ds_read_b128 v[28:31], v100 offset:19456
    ds_read_b128 v[20:23], v97 offset:20992
    s_waitcnt lgkmcnt(8)
    v_mfma_f32_16x16x32_bf16 v[104:107], v[32:35], v[40:43], v[104:107]
    v_mfma_f32_16x16x32_bf16 v[112:115], v[32:35], v[44:47], v[112:115]
    v_mfma_f32_16x16x32_bf16 v[108:111], v[36:39], v[40:43], v[108:111]
    v_mfma_f32_16x16x32_bf16 v[116:119], v[36:39], v[44:47], v[116:119]
    s_waitcnt lgkmcnt(4)
    v_mfma_f32_16x16x32_bf16 v[104:107], v[48:51], v[56:59], v[104:107]
    v_mfma_f32_16x16x32_bf16 v[112:115], v[48:51], v[60:63], v[112:115]
    v_mfma_f32_16x16x32_bf16 v[108:111], v[52:55], v[56:59], v[108:111]
    v_mfma_f32_16x16x32_bf16 v[116:119], v[52:55], v[60:63], v[116:119]
    s_waitcnt lgkmcnt(0)
    v_mfma_f32_16x16x32_bf16 v[104:107], v[16:19], v[24:27], v[104:107]
    v_mfma_f32_16x16x32_bf16 v[112:115], v[16:19], v[28:31], v[112:115]
    v_mfma_f32_16x16x32_bf16 v[108:111], v[20:23], v[24:27], v[108:111]
    v_mfma_f32_16x16x32_bf16 v[116:119], v[20:23], v[28:31], v[116:119]
    s_lshl_b32 s30, s40, 12
    s_add_u32 s30, s30, 40960
    v_add_u32 v2, s30, v12
    s_cmp_eq_u32 s41, 0
    s_cbranch_scc1 K1_KH0
    s_barrier
    ds_write_b128 v2, v[104:107] offset:0
    ds_write_b128 v2, v[108:111] offset:1024
    ds_write_b128 v2, v[112:115] offset:2048
    ds_write_b128 v2, v[116:119] offset:3072
    s_waitcnt lgkmcnt(0)
    s_barrier
    s_cmp_ge_u32 s28, 7
    s_cbranch_scc1 K1_KH1END
    s_lshl_b32 s30, s27, 3
    s_sub_u32 s31, s28, 5
    s_lshl_b32 s31, s31, 2
    s_add_u32 s30, s30, s31
    v_add_u32 v7, s30, v10
    v_and_b32 v3, 15, v7
    v_xor_b32 v3, v3, v11
    v_mul_u32_u24 v4, 1280, v7
    v_lshl_add_u32 v4, v3, 4, v4
    ds_read_b128 v[16:19], v4 offset:0
    ds_read_b128 v[20:23], v4 offset:256
    ds_read_b128 v[24:27], v4 offset:512
    ds_read_b128 v[28:31], v4 offset:768
    ds_read_b128 v[32:35], v4 offset:1024
    v_lshrrev_b32 v3, 2, v7
    v_sub_u32 v3, 0, v3
    v_xor_b32 v3, v3, v11
    v_and_b32 v3, 3, v3
    v_lshlrev_b32 v3, 4, v3
    v_lshl_add_u32 v3, v7, 6, v3
    v_lshrrev_b32 v5, 2, v11
    v_lshl_add_u32 v3, v5, 13, v3
    s_lshr_b32 s30, s26, 2
    s_mul_i32 s42, s30, 163840
    s_and_b32 s30, s26, 3
    s_lshl_b32 s30, s30, 11
    s_add_u32 s42, s42, s30
    s_waitcnt lgkmcnt(4)
    buffer_store_dwordx4 v[16:19], v3, s[12:15], s42 offen sc1
    s_add_u32 s42, s42, 32768
    s_waitcnt lgkmcnt(3)
    buffer_store_dwordx4 v[20:23], v3, s[12:15], s42 offen sc1
    s_add_u32 s42, s42, 32768
    s_waitcnt lgkmcnt(2)
    buffer_store_dwordx4 v[24:27], v3, s[12:15], s42 offen sc1
    s_add_u32 s42, s42, 32768
    s_waitcnt lgkmcnt(1)
    buffer_store_dwordx4 v[28:31], v3, s[12:15], s42 offen sc1
    s_add_u32 s42, s42, 32768
    s_waitcnt lgkmcnt(0)
    buffer_store_dwordx4 v[32:35], v3, s[12:15], s42 offen sc1
K1_KH1END:
    s_endpgm
K1_KH0:
    s_nop 1
    v_add_u32 v3, 143360, v12
    ds_read_b128 v[72:75], v3 offset:16384
    ds_read_b128 v[76:79], v3 offset:17408
    ds_read_b128 v[80:83], v3 offset:18432
    ds_read_b128 v[84:87], v3 offset:19456
    s_barrier
    v_lshlrev_b32 v14, 2, v10
    v_cvt_f32_u32 v14, v14
    v_cvt_f32_u32 v15, s26
    v_mul_f32 v15, 0xba000000, v15
    v_add_f32 v3, 0x00000000, v14
    v_mul_f32 v3, v3, v15
    v_cos_f32 v16, v3
    v_sin_f32 v17, v3
    v_add_f32 v3, 0x3f800000, v14
    v_mul_f32 v3, v3, v15
    v_cos_f32 v18, v3
    v_sin_f32 v19, v3
    v_add_f32 v3, 0x40000000, v14
    v_mul_f32 v3, v3, v15
    v_cos_f32 v20, v3
    v_sin_f32 v21, v3
    v_add_f32 v3, 0x40400000, v14
    v_mul_f32 v3, v3, v15
    v_cos_f32 v22, v3
    v_sin_f32 v23, v3
    v_add_f32 v3, 0x41800000, v14
    v_mul_f32 v3, v3, v15
    v_cos_f32 v24, v3
    v_sin_f32 v25, v3
    v_add_f32 v3, 0x41880000, v14
    v_mul_f32 v3, v3, v15
    v_cos_f32 v26, v3
    v_sin_f32 v27, v3
    v_add_f32 v3, 0x41900000, v14
    v_mul_f32 v3, v3, v15
    v_cos_f32 v28, v3
    v_sin_f32 v29, v3
    v_add_f32 v3, 0x41980000, v14
    v_mul_f32 v3, v3, v15
    v_cos_f32 v30, v3
    v_sin_f32 v31, v3
    v_lshrrev_b32 v4, 2, v1
    v_mul_u32_u24 v4, 81920, v4
    v_and_b32 v5, 3, v1
    v_lshl_add_u32 v4, v5, 4, v4
    v_sub_u32 v5, v2, v12
    v_lshl_add_u32 v5, v10, 8, v5
    v_lshl_add_u32 v5, v11, 2, v5
    s_mul_i32 s30, s27, 5
    s_add_u32 s30, s30, s40
    s_lshl_b32 s30, s30, 12
    s_lshl_b32 s31, s26, 6
    s_add_u32 s30, s30, s31
    s_mov_b32 s32, s30
    s_add_u32 s33, s30, 1310720
    v_lshlrev_b32 v6, 31, v9
    v_or_b32 v6, 1.0, v6
    s_barrier
    ds_read_b128 v[32:35], v2 offset:0
    ds_read_b128 v[36:39], v2 offset:1024
    ds_read_b128 v[40:43], v2 offset:2048
    ds_read_b128 v[44:47], v2 offset:3072
    s_waitcnt lgkmcnt(4)
    v_xor_b32 v88, 0x80008000, v80
    v_xor_b32 v89, 0x80008000, v81
    v_xor_b32 v90, 0x80008000, v82
    v_xor_b32 v91, 0x80008000, v83
    v_xor_b32 v92, 0x80008000, v84
    v_xor_b32 v93, 0x80008000, v85
    v_xor_b32 v94, 0x80008000, v86
    v_xor_b32 v95, 0x80008000, v87
    s_waitcnt lgkmcnt(0)
    v_pk_fma_f32 v[32:33], v[32:33], v[6:7], v[104:105] op_sel_hi:[1,0,1]
    v_pk_fma_f32 v[34:35], v[34:35], v[6:7], v[106:107] op_sel_hi:[1,0,1]
    v_pk_fma_f32 v[36:37], v[36:37], v[6:7], v[108:109] op_sel_hi:[1,0,1]
    v_pk_fma_f32 v[38:39], v[38:39], v[6:7], v[110:111] op_sel_hi:[1,0,1]
    v_pk_fma_f32 v[40:41], v[40:41], v[6:7], v[112:113] op_sel_hi:[1,0,1]
    v_pk_fma_f32 v[42:43], v[42:43], v[6:7], v[114:115] op_sel_hi:[1,0,1]
    v_pk_fma_f32 v[44:45], v[44:45], v[6:7], v[116:117] op_sel_hi:[1,0,1]
    v_pk_fma_f32 v[46:47], v[46:47], v[6:7], v[118:119] op_sel_hi:[1,0,1]
    v_cvt_pk_bf16_f32 v48, v32, v33
    v_cvt_pk_bf16_f32 v49, v34, v35
    v_cvt_pk_bf16_f32 v50, v36, v37
    v_cvt_pk_bf16_f32 v51, v38, v39
    v_cvt_pk_bf16_f32 v52, v40, v41
    v_cvt_pk_bf16_f32 v53, v42, v43
    v_cvt_pk_bf16_f32 v54, v44, v45
    v_cvt_pk_bf16_f32 v55, v46, v47
    v_mfma_f32_16x16x32_bf16 v[56:59], v[72:75], v[48:51], 0
    s_nop 0
    v_mfma_f32_16x16x32_bf16 v[64:67], v[72:75], v[52:55], 0
    v_mfma_f32_16x16x32_bf16 v[60:63], v[76:79], v[48:51], 0
    v_mfma_f32_16x16x32_bf16 v[68:71], v[76:79], v[52:55], 0
    v_mfma_f32_16x16x32_bf16 v[56:59], v[80:83], v[52:55], v[56:59]
    v_mfma_f32_16x16x32_bf16 v[64:67], v[88:91], v[48:51], v[64:67]
    v_mfma_f32_16x16x32_bf16 v[60:63], v[84:87], v[52:55], v[60:63]
    v_mfma_f32_16x16x32_bf16 v[68:71], v[92:95], v[48:51], v[68:71]
    s_nop 4
    v_mul_f32 v96, v56, v16
    v_mul_f32 v97, v56, v17
    v_fma_f32 v96, -v64, v17, v96
    v_fmac_f32 v97, v64, v16
    v_cvt_pk_bf16_f32 v104, v96, v97
    ds_write_b32 v5, v104 offset:0
    v_mul_f32 v98, v57, v18
    v_mul_f32 v99, v57, v19
    v_fma_f32 v98, -v65, v19, v98
    v_fmac_f32 v99, v65, v18
    v_cvt_pk_bf16_f32 v105, v98, v99
    ds_write_b32 v5, v105 offset:64
    v_mul_f32 v100, v58, v20
    v_mul_f32 v101, v58, v21
    v_fma_f32 v100, -v66, v21, v100
    v_fmac_f32 v101, v66, v20
    v_cvt_pk_bf16_f32 v106, v100, v101
    ds_write_b32 v5, v106 offset:128
    v_mul_f32 v102, v59, v22
    v_mul_f32 v103, v59, v23
    v_fma_f32 v102, -v67, v23, v102
    v_fmac_f32 v103, v67, v22
    v_cvt_pk_bf16_f32 v107, v102, v103
    ds_write_b32 v5, v107 offset:192
    v_mul_f32 v96, v60, v24
    v_mul_f32 v97, v60, v25
    v_fma_f32 v96, -v68, v25, v96
    v_fmac_f32 v97, v68, v24
    v_cvt_pk_bf16_f32 v108, v96, v97
    ds_write_b32 v5, v108 offset:1024
    v_mul_f32 v98, v61, v26
    v_mul_f32 v99, v61, v27
    v_fma_f32 v98, -v69, v27, v98
    v_fmac_f32 v99, v69, v26
    v_cvt_pk_bf16_f32 v109, v98, v99
    ds_write_b32 v5, v109 offset:1088
    v_mul_f32 v100, v62, v28
    v_mul_f32 v101, v62, v29
    v_fma_f32 v100, -v70, v29, v100
    v_fmac_f32 v101, v70, v28
    v_cvt_pk_bf16_f32 v110, v100, v101
    ds_write_b32 v5, v110 offset:1152
    v_mul_f32 v102, v63, v30
    v_mul_f32 v103, v63, v31
    v_fma_f32 v102, -v71, v31, v102
    v_fmac_f32 v103, v71, v30
    v_cvt_pk_bf16_f32 v111, v102, v103
    ds_write_b32 v5, v111 offset:1216
    s_waitcnt lgkmcnt(0)
    ds_read_b128 v[112:115], v2 offset:0
    ds_read_b128 v[116:119], v2 offset:1024
    s_waitcnt lgkmcnt(1)
    buffer_store_dwordx4 v[112:115], v4, s[16:19], s32 offen sc1
    s_waitcnt lgkmcnt(0)
    buffer_store_dwordx4 v[116:119], v4, s[16:19], s33 offen sc1
    s_or_b32 s30, s27, s40
    s_cmp_lg_u32 s30, 0
    s_cbranch_scc1 K1_NOTQ
    v_lshlrev_b32 v3, 4, v10
    s_lshl_b32 s30, s26, 6
    s_add_u32 s30, s30, 2621440
    s_add_u32 s31, s30, 4096
    v_cmp_eq_u32 vcc, 0, v11
    s_nop 1
    s_and_b64 exec, exec, vcc
    buffer_store_dwordx4 v[104:107], v3, s[16:19], s30 offen sc1
    buffer_store_dwordx4 v[108:111], v3, s[16:19], s31 offen sc1
    s_mov_b64 exec, -1
K1_NOTQ:
    s_endpgm
K1_HELPER:
    s_nop 3
    s_lshr_b32 s30, s2, 3
    s_cmp_ge_u32 s30, 6
    s_cbranch_scc1 K1_NOCPF
    s_cmp_eq_u32 s28, 10
    s_cbranch_scc1 K1_NOCPF
    v_lshlrev_b32 v2, 7, v1
    s_cmp_ge_u32 s30, 4
    s_cbranch_scc1 K1_CPF2
    s_getpc_b64 s[32:33]
    s_add_u32 s32, s32, k2_kernel@rel32@lo+4
    s_addc_u32 s33, s33, k2_kernel@rel32@hi+12
    s_lshl_b32 s30, s30, 13
    v_add_u32 v2, s30, v2
    v_min_u32 v2, K3_TEXT_END-k2_kernel-4, v2
    global_load_dword v120, v2, s[32:33]
    s_branch K1_NOCPF
K1_CPF2:
    s_nop 1
    s_getpc_b64 s[32:33]
    s_add_u32 s32, s32, TBL_E64@rel32@lo+4
    s_addc_u32 s33, s33, TBL_E64@rel32@hi+12
    s_sub_u32 s30, s30, 4
    s_lshl_b32 s30, s30, 13
    v_add_u32 v2, s30, v2
    v_min_u32 v2, TBL_END-TBL_E64-4, v2
    global_load_dword v120, v2, s[32:33]
K1_NOCPF:
    s_nop 1
    s_mov_b32 s8, s56
    s_mov_b32 s9, s57
    s_mov_b32 s10, 1314816
    s_mov_b32 s11, 0x00020000
    s_mov_b32 s20, s58
    s_mov_b32 s21, s59
    s_mov_b32 s22, 1314816
    s_mov_b32 s23, 0x00020000
    s_cmp_ge_u32 s2, 240
    s_cbranch_scc1 K1_COEF
    s_mul_hi_u32 s30, s2, 0x2aaaaaab
    s_mul_i32 s31, s30, 6
    s_sub_u32 s52, s2, s31
    s_and_b32 s31, s30, 1
    s_lshr_b32 s55, s30, 1
    s_mov_b32 s43, s31
    s_cmp_eq_u32 s31, 1
    s_cselect_b32 s44, s62, s60
    s_cselect_b32 s45, s63, s61
    s_mov_b32 s46, 1966080
    s_mov_b32 s47, 0x00020000
    v_lshrrev_b32 v2, 4, v1
    v_mul_u32_u24 v2, 3072, v2
    v_and_b32 v3, 15, v1
    v_lshl_add_u32 v2, v3, 4, v2
    s_sub_u32 s30, s28, 10
    s_mul_i32 s53, s55, 98304
    s_lshl_b32 s31, s52, 9
    s_add_u32 s53, s53, s31
    s_lshl_b32 s31, s30, 8
    s_add_u32 s53, s53, s31
    s_lshl_b32 s54, s30, 13
    s_add_u32 s54, s54, 143360
    s_mov_b32 m0, s54
    s_nop 0
    buffer_load_dwordx4 v2, s[44:47], s53 offen lds
    s_add_u32 s54, s54, 1024
    s_add_u32 s53, s53, 12288
    s_mov_b32 m0, s54
    s_nop 0
    buffer_load_dwordx4 v2, s[44:47], s53 offen lds
    s_add_u32 s54, s54, 1024
    s_add_u32 s53, s53, 12288
    s_mov_b32 m0, s54
    s_nop 0
    buffer_load_dwordx4 v2, s[44:47], s53 offen lds
    s_add_u32 s54, s54, 1024
    s_add_u32 s53, s53, 12288
    s_mov_b32 m0, s54
    s_nop 0
    buffer_load_dwordx4 v2, s[44:47], s53 offen lds
    s_add_u32 s54, s54, 1024
    s_add_u32 s53, s53, 12288
    s_mov_b32 m0, s54
    s_nop 0
    buffer_load_dwordx4 v2, s[44:47], s53 offen lds
    s_add_u32 s54, s54, 1024
    s_add_u32 s53, s53, 12288
    s_mov_b32 m0, s54
    s_nop 0
    buffer_load_dwordx4 v2, s[44:47], s53 offen lds
    s_add_u32 s54, s54, 1024
    s_add_u32 s53, s53, 12288
    s_mov_b32 m0, s54
    s_nop 0
    buffer_load_dwordx4 v2, s[44:47], s53 offen lds
    s_add_u32 s54, s54, 1024
    s_add_u32 s53, s53, 12288
    s_mov_b32 m0, s54
    s_nop 0
    buffer_load_dwordx4 v2, s[44:47], s53 offen lds
    s_add_u32 s54, s54, 1024
    s_add_u32 s53, s53, 12288
    s_sub_u32 s30, s28, 10
    s_waitcnt vmcnt(8)
    s_barrier
    s_mov_b32 s36, s24
    s_mov_b32 s37, s25
    s_mov_b32 s38, 1966080
    s_mov_b32 s39, 0x00020000
    s_mul_hi_u32 s32, s2, 0x33333334
    s_mul_i32 s33, s32, 5
    s_sub_u32 s33, s2, s33
    s_mul_i32 s34, s32, 40960
    s_lshl_b32 s35, s33, 8
    s_add_u32 s34, s34, s35
    s_lshl_b32 s35, s30, 7
    s_add_u32 s34, s34, s35
    v_lshrrev_b32 v2, 3, v1
    v_mul_u32_u24 v2, 1280, v2
    v_and_b32 v3, 7, v1
    v_lshl_add_u32 v2, v3, 4, v2
    buffer_load_dwordx4 v[136:139], v2, s[36:39], s34 offen
    s_add_u32 s34, s34, 10240
    buffer_load_dwordx4 v[140:143], v2, s[36:39], s34 offen
    s_add_u32 s34, s34, 10240
    buffer_load_dwordx4 v[144:147], v2, s[36:39], s34 offen
    s_add_u32 s34, s34, 10240
    buffer_load_dwordx4 v[148:151], v2, s[36:39], s34 offen
    s_lshl_b32 s31, s2, 1
    s_add_u32 s31, s31, s30
    s_mul_i32 s31, s31, 3072
    buffer_load_dwordx4 v[120:123], v12, s[8:11], s31 offen offset:0
    buffer_load_dwordx4 v[120:123], v12, s[20:23], s31 offen offset:0
    buffer_load_dwordx4 v[120:123], v12, s[8:11], s31 offen offset:1024
    buffer_load_dwordx4 v[120:123], v12, s[20:23], s31 offen offset:1024
    buffer_load_dwordx4 v[120:123], v12, s[8:11], s31 offen offset:2048
    buffer_load_dwordx4 v[120:123], v12, s[20:23], s31 offen offset:2048
    s_add_u32 s48, s6, 25165824
    s_addc_u32 s49, s7, 0
    s_mov_b32 s50, 3932160
    s_mov_b32 s51, 0x00020000
    s_sub_u32 s30, s28, 10
    s_lshl_b32 s54, s30, 13
    s_add_u32 s54, s54, 143360
    v_lshrrev_b32 v2, 2, v11
    v_lshl_add_u32 v2, v10, 3, v2
    v_lshlrev_b32 v2, 8, v2
    v_and_b32 v3, 3, v11
    v_lshl_add_u32 v2, v3, 3, v2
    v_add_u32 v2, s54, v2
    s_barrier
    s_barrier
    s_waitcnt vmcnt(10)
    ds_read_b64_tr_b16 v[16:17], v2 offset:0
    ds_read_b64_tr_b16 v[18:19], v2 offset:1024
    ds_read_b64_tr_b16 v[20:21], v2 offset:32
    ds_read_b64_tr_b16 v[22:23], v2 offset:1056
    ds_read_b64_tr_b16 v[24:25], v2 offset:64
    ds_read_b64_tr_b16 v[26:27], v2 offset:1088
    ds_read_b64_tr_b16 v[28:29], v2 offset:96
    ds_read_b64_tr_b16 v[30:31], v2 offset:1120
    ds_read_b64_tr_b16 v[32:33], v2 offset:128
    ds_read_b64_tr_b16 v[34:35], v2 offset:1152
    ds_read_b64_tr_b16 v[36:37], v2 offset:160
    ds_read_b64_tr_b16 v[38:39], v2 offset:1184
    s_waitcnt lgkmcnt(6)
    ds_read_b64_tr_b16 v[40:41], v2 offset:192
    ds_read_b64_tr_b16 v[42:43], v2 offset:1216
    ds_read_b64_tr_b16 v[44:45], v2 offset:224
    ds_read_b64_tr_b16 v[46:47], v2 offset:1248
    s_lshl_b32 s53, s52, 4
    s_lshl_b32 s30, s30, 3
    s_add_u32 s53, s53, s30
    s_lshl_b32 s54, s55, 1
    s_add_u32 s54, s54, s43
    s_mul_i32 s54, s54, 6144
    s_waitcnt lgkmcnt(0)
    s_add_u32 s30, s53, 0
    s_mul_hi_u32 s31, s30, 0x2aaaaaab
    s_mul_i32 s32, s31, 6
    s_sub_u32 s30, s30, s32
    s_lshl_b32 s30, s30, 10
    s_mul_i32 s31, s31, 245760
    s_add_u32 s30, s30, s31
    s_add_u32 s30, s30, s54
    buffer_store_dwordx4 v[16:19], v12, s[48:51], s30 offen sc1
    s_add_u32 s30, s53, 1
    s_mul_hi_u32 s31, s30, 0x2aaaaaab
    s_mul_i32 s32, s31, 6
    s_sub_u32 s30, s30, s32
    s_lshl_b32 s30, s30, 10
    s_mul_i32 s31, s31, 245760
    s_add_u32 s30, s30, s31
    s_add_u32 s30, s30, s54
    buffer_store_dwordx4 v[20:23], v12, s[48:51], s30 offen sc1
    s_add_u32 s30, s53, 2
    s_mul_hi_u32 s31, s30, 0x2aaaaaab
    s_mul_i32 s32, s31, 6
    s_sub_u32 s30, s30, s32
    s_lshl_b32 s30, s30, 10
    s_mul_i32 s31, s31, 245760
    s_add_u32 s30, s30, s31
    s_add_u32 s30, s30, s54
    buffer_store_dwordx4 v[24:27], v12, s[48:51], s30 offen sc1
    s_add_u32 s30, s53, 3
    s_mul_hi_u32 s31, s30, 0x2aaaaaab
    s_mul_i32 s32, s31, 6
    s_sub_u32 s30, s30, s32
    s_lshl_b32 s30, s30, 10
    s_mul_i32 s31, s31, 245760
    s_add_u32 s30, s30, s31
    s_add_u32 s30, s30, s54
    buffer_store_dwordx4 v[28:31], v12, s[48:51], s30 offen sc1
    s_add_u32 s30, s53, 4
    s_mul_hi_u32 s31, s30, 0x2aaaaaab
    s_mul_i32 s32, s31, 6
    s_sub_u32 s30, s30, s32
    s_lshl_b32 s30, s30, 10
    s_mul_i32 s31, s31, 245760
    s_add_u32 s30, s30, s31
    s_add_u32 s30, s30, s54
    buffer_store_dwordx4 v[32:35], v12, s[48:51], s30 offen sc1
    s_add_u32 s30, s53, 5
    s_mul_hi_u32 s31, s30, 0x2aaaaaab
    s_mul_i32 s32, s31, 6
    s_sub_u32 s30, s30, s32
    s_lshl_b32 s30, s30, 10
    s_mul_i32 s31, s31, 245760
    s_add_u32 s30, s30, s31
    s_add_u32 s30, s30, s54
    buffer_store_dwordx4 v[36:39], v12, s[48:51], s30 offen sc1
    s_add_u32 s30, s53, 6
    s_mul_hi_u32 s31, s30, 0x2aaaaaab
    s_mul_i32 s32, s31, 6
    s_sub_u32 s30, s30, s32
    s_lshl_b32 s30, s30, 10
    s_mul_i32 s31, s31, 245760
    s_add_u32 s30, s30, s31
    s_add_u32 s30, s30, s54
    buffer_store_dwordx4 v[40:43], v12, s[48:51], s30 offen sc1
    s_add_u32 s30, s53, 7
    s_mul_hi_u32 s31, s30, 0x2aaaaaab
    s_mul_i32 s32, s31, 6
    s_sub_u32 s30, s30, s32
    s_lshl_b32 s30, s30, 10
    s_mul_i32 s31, s31, 245760
    s_add_u32 s30, s30, s31
    s_add_u32 s30, s30, s54
    buffer_store_dwordx4 v[44:47], v12, s[48:51], s30 offen sc1
    s_waitcnt vmcnt(14)
    s_add_u32 s48, s6, 23068672
    s_addc_u32 s49, s7, 0
    s_mov_b32 s50, 1966080
    s_mov_b32 s51, 0x00020000
    s_sub_u32 s30, s28, 10
    s_lshl_b32 s54, s30, 13
    s_add_u32 s54, s54, 143360
    v_add_u32 v3, s54, v12
    ds_write_b128 v3, v[136:139] offset:0
    ds_write_b128 v3, v[140:143] offset:1024
    ds_write_b128 v3, v[144:147] offset:2048
    ds_write_b128 v3, v[148:151] offset:3072
    v_lshrrev_b32 v2, 2, v11
    v_lshl_add_u32 v2, v10, 3, v2
    v_lshlrev_b32 v2, 7, v2
    v_and_b32 v3, 3, v11
    v_lshl_add_u32 v2, v3, 3, v2
    v_add_u32 v2, s54, v2
    s_waitcnt lgkmcnt(0)
    ds_read_b64_tr_b16 v[48:49], v2 offset:0
    ds_read_b64_tr_b16 v[50:51], v2 offset:512
    ds_read_b64_tr_b16 v[52:53], v2 offset:32
    ds_read_b64_tr_b16 v[54:55], v2 offset:544
    ds_read_b64_tr_b16 v[56:57], v2 offset:64
    ds_read_b64_tr_b16 v[58:59], v2 offset:576
    ds_read_b64_tr_b16 v[60:61], v2 offset:96
    ds_read_b64_tr_b16 v[62:63], v2 offset:608
    s_mul_hi_u32 s32, s2, 0x33333334
    s_mul_i32 s33, s32, 5
    s_sub_u32 s33, s2, s33
    s_lshl_b32 s33, s33, 3
    s_lshl_b32 s34, s30, 2
    s_add_u32 s33, s33, s34
    s_mul_i32 s32, s32, 5120
    s_waitcnt lgkmcnt(0)
    s_add_u32 s34, s33, 0
    s_mul_hi_u32 s35, s34, 0x33333334
    s_mul_i32 s36, s35, 5
    s_sub_u32 s34, s34, s36
    s_lshl_b32 s34, s34, 10
    s_mul_i32 s35, s35, 245760
    s_add_u32 s34, s34, s35
    s_add_u32 s34, s34, s32
    buffer_store_dwordx4 v[48:51], v12, s[48:51], s34 offen sc1
    s_add_u32 s34, s33, 1
    s_mul_hi_u32 s35, s34, 0x33333334
    s_mul_i32 s36, s35, 5
    s_sub_u32 s34, s34, s36
    s_lshl_b32 s34, s34, 10
    s_mul_i32 s35, s35, 245760
    s_add_u32 s34, s34, s35
    s_add_u32 s34, s34, s32
    buffer_store_dwordx4 v[52:55], v12, s[48:51], s34 offen sc1
    s_add_u32 s34, s33, 2
    s_mul_hi_u32 s35, s34, 0x33333334
    s_mul_i32 s36, s35, 5
    s_sub_u32 s34, s34, s36
    s_lshl_b32 s34, s34, 10
    s_mul_i32 s35, s35, 245760
    s_add_u32 s34, s34, s35
    s_add_u32 s34, s34, s32
    buffer_store_dwordx4 v[56:59], v12, s[48:51], s34 offen sc1
    s_add_u32 s34, s33, 3
    s_mul_hi_u32 s35, s34, 0x33333334
    s_mul_i32 s36, s35, 5
    s_sub_u32 s34, s34, s36
    s_lshl_b32 s34, s34, 10
    s_mul_i32 s35, s35, 245760
    s_add_u32 s34, s34, s35
    s_add_u32 s34, s34, s32
    buffer_store_dwordx4 v[60:63], v12, s[48:51], s34 offen sc1
    s_branch K1_KH1END
K1_COEF:
    s_nop 1
    s_add_u32 s44, s6, 22020096
    s_addc_u32 s45, s7, 0
    s_mov_b32 s46, 65536
    s_mov_b32 s47, 0x00020000
    v_and_b32 v2, 1, v1
    v_lshlrev_b32 v3, 31, v2
    v_xor_b32 v4, 0x80000000, v3
    s_sub_u32 s52, s2, 240
    s_lshl_b32 s52, s52, 1
    s_add_u32 s52, s52, s28
    s_sub_u32 s52, s52, 10
    s_lshl_b32 s52, s52, 1
    s_add_u32 s52, s52, 0
    s_lshr_b32 s32, s52, 5
    s_and_b32 s33, s52, 31
    s_lshr_b32 s34, s33, 4
    s_lshl_b32 s34, s34, 5
    s_bfe_u32 s35, s33, 0x20002
    s_lshl_b32 s35, s35, 3
    s_add_u32 s34, s34, s35
    s_and_b32 s35, s33, 3
    s_add_u32 s34, s34, s35
    s_lshl_b32 s34, s34, 5
    s_lshl_b32 s35, s32, 4
    s_add_u32 s34, s34, s35
    v_bfe_u32 v6, v1, 1, 4
    v_lshrrev_b32 v7, 5, v1
    v_lshl_add_u32 v6, v7, 7, v6
    v_add_u32 v6, s34, v6
    v_sub_u32 v7, 0, v6
    v_and_b32 v7, 2047, v7
    v_mul_u32_u24 v8, 642, v6
    v_mul_u32_u24 v13, 642, v7
    buffer_load_ushort v120, v8, s[8:11], 0 offen
    buffer_load_ushort v121, v8, s[20:23], 0 offen
    buffer_load_ushort v122, v13, s[8:11], 0 offen
    buffer_load_ushort v123, v13, s[20:23], 0 offen
    buffer_load_ushort v124, v8, s[8:11], 0 offen offset:640
    buffer_load_ushort v125, v8, s[20:23], 0 offen offset:640
    buffer_load_ushort v126, v13, s[8:11], 0 offen offset:640
    buffer_load_ushort v127, v13, s[20:23], 0 offen offset:640
    s_sub_u32 s53, s2, 240
    s_lshl_b32 s53, s53, 1
    s_add_u32 s53, s53, s28
    s_sub_u32 s53, s53, 10
    s_lshl_b32 s53, s53, 1
    s_add_u32 s53, s53, 1
    s_lshr_b32 s32, s53, 5
    s_and_b32 s33, s53, 31
    s_lshr_b32 s34, s33, 4
    s_lshl_b32 s34, s34, 5
    s_bfe_u32 s35, s33, 0x20002
    s_lshl_b32 s35, s35, 3
    s_add_u32 s34, s34, s35
    s_and_b32 s35, s33, 3
    s_add_u32 s34, s34, s35
    s_lshl_b32 s34, s34, 5
    s_lshl_b32 s35, s32, 4
    s_add_u32 s34, s34, s35
    v_bfe_u32 v6, v1, 1, 4
    v_lshrrev_b32 v7, 5, v1
    v_lshl_add_u32 v6, v7, 7, v6
    v_add_u32 v6, s34, v6
    v_sub_u32 v7, 0, v6
    v_and_b32 v7, 2047, v7
    v_mul_u32_u24 v8, 642, v6
    v_mul_u32_u24 v13, 642, v7
    buffer_load_ushort v128, v8, s[8:11], 0 offen
    buffer_load_ushort v129, v8, s[20:23], 0 offen
    buffer_load_ushort v130, v13, s[8:11], 0 offen
    buffer_load_ushort v131, v13, s[20:23], 0 offen
    buffer_load_ushort v132, v8, s[8:11], 0 offen offset:640
    buffer_load_ushort v133, v8, s[20:23], 0 offen offset:640
    buffer_load_ushort v134, v13, s[8:11], 0 offen offset:640
    buffer_load_ushort v135, v13, s[20:23], 0 offen offset:640
    v_and_b32 v2, 1, v1
    v_lshlrev_b32 v3, 31, v2
    v_xor_b32 v4, 0x80000000, v3
    s_waitcnt vmcnt(16)
    s_barrier
    s_barrier
    s_barrier
    s_waitcnt vmcnt(0)
    v_lshlrev_b32 v120, 16, v120
    v_lshlrev_b32 v121, 16, v121
    v_lshlrev_b32 v122, 16, v122
    v_lshlrev_b32 v123, 16, v123
    v_lshlrev_b32 v124, 16, v124
    v_lshlrev_b32 v125, 16, v125
    v_lshlrev_b32 v126, 16, v126
    v_lshlrev_b32 v127, 16, v127
    v_add_f32 v120, v120, v122
    v_sub_f32 v121, v121, v123
    v_add_f32 v124, v124, v126
    v_sub_f32 v125, v125, v127
    v_add_f32 v32, v120, v124
    v_add_f32 v33, v121, v125
    v_sub_f32 v34, v120, v124
    v_sub_f32 v35, v121, v125
    v_mul_f32 v32, 0.25, v32
    v_mul_f32 v33, 0.25, v33
    v_mul_f32 v34, 0.25, v34
    v_mul_f32 v35, 0.25, v35
    v_xor_b32 v33, v33, v4
    v_xor_b32 v34, v34, v3
    s_lshl_b32 s30, s52, 10
    buffer_store_dwordx4 v[32:35], v12, s[44:47], s30 offen sc1
    v_lshlrev_b32 v128, 16, v128
    v_lshlrev_b32 v129, 16, v129
    v_lshlrev_b32 v130, 16, v130
    v_lshlrev_b32 v131, 16, v131
    v_lshlrev_b32 v132, 16, v132
    v_lshlrev_b32 v133, 16, v133
    v_lshlrev_b32 v134, 16, v134
    v_lshlrev_b32 v135, 16, v135
    v_add_f32 v128, v128, v130
    v_sub_f32 v129, v129, v131
    v_add_f32 v132, v132, v134
    v_sub_f32 v133, v133, v135
    v_add_f32 v36, v128, v132
    v_add_f32 v37, v129, v133
    v_sub_f32 v38, v128, v132
    v_sub_f32 v39, v129, v133
    v_mul_f32 v36, 0.25, v36
    v_mul_f32 v37, 0.25, v37
    v_mul_f32 v38, 0.25, v38
    v_mul_f32 v39, 0.25, v39
    v_xor_b32 v37, v37, v4
    v_xor_b32 v38, v38, v3
    s_lshl_b32 s30, s53, 10
    buffer_store_dwordx4 v[36:39], v12, s[44:47], s30 offen sc1
    s_branch K1_KH1END
K1_END:
    s_endpgm
.globl k2_kernel
.p2align 8
.type k2_kernel,@function
k2_kernel:
    s_cmp_ge_u32 s2, 512
    s_cbranch_scc1 K2_END
    s_load_dwordx4 s[4:7], s[0:1], 8
    s_load_dwordx4 s[8:11], s[0:1], 32
    s_load_dwordx2 s[12:13], s[0:1], 72
    v_lshrrev_b32 v2, 6, v0
    v_and_b32 v1, 63, v0
    v_readfirstlane_b32 s14, v2
    s_cmp_ge_u32 s2, 256
    s_cbranch_scc1 K2_FFT
    s_and_b32 s15, s2, 7
    s_lshr_b32 s44, s2, 3
    s_and_b32 s28, s15, 1
    s_lshl_b32 s28, s28, 3
    s_and_b32 s45, s44, 7
    s_add_u32 s28, s28, s45
    s_lshr_b32 s29, s15, 1
    s_lshl_b32 s29, s29, 2
    s_lshr_b32 s45, s44, 3
    s_add_u32 s29, s29, s45
    v_lshlrev_b32 v6, 4, v1
    s_lshl_b32 s15, s14, 11
    v_add_u32 v6, s15, v6
    v_lshlrev_b32 v8, 4, v1
    s_mul_i32 s15, s14, 3072
    v_add_u32 v8, s15, v8
    s_lshl_b32 s32, s14, 11
    s_add_u32 s33, s15, 8192
    s_waitcnt lgkmcnt(0)
    s_mov_b32 s16, s12
    s_mov_b32 s17, s13
    s_mov_b32 s18, 2621440
    s_mov_b32 s19, 0x00020000
    s_add_u32 s24, s12, 12582912
    s_addc_u32 s25, s13, 0
    s_mov_b32 s26, 6291456
    s_mov_b32 s27, 0x00020000
    s_add_u32 s20, s12, 25165824
    s_addc_u32 s21, s13, 0
    s_mov_b32 s22, 3932160
    s_mov_b32 s23, 0x00020000
    s_mul_i32 s30, s28, 163840
    s_mul_i32 s31, s29, 245760
    s_add_u32 m0, s32, 0
    s_nop 0
    buffer_load_dwordx4 v6, s[16:19], s30 offen offset:0 lds
    buffer_load_dwordx4 v6, s[16:19], s30 offen offset:1024 lds
    s_add_u32 m0, s33, 0
    s_nop 0
    buffer_load_dwordx4 v8, s[20:23], s31 offen offset:0 lds
    buffer_load_dwordx4 v8, s[20:23], s31 offen offset:1024 lds
    buffer_load_dwordx4 v8, s[20:23], s31 offen offset:2048 lds
    s_add_u32 s30, s30, 8192
    s_add_u32 s31, s31, 12288
    s_add_u32 m0, s32, 20480
    s_nop 0
    buffer_load_dwordx4 v6, s[16:19], s30 offen offset:0 lds
    buffer_load_dwordx4 v6, s[16:19], s30 offen offset:1024 lds
    s_add_u32 m0, s33, 20480
    s_nop 0
    buffer_load_dwordx4 v8, s[20:23], s31 offen offset:0 lds
    buffer_load_dwordx4 v8, s[20:23], s31 offen offset:1024 lds
    buffer_load_dwordx4 v8, s[20:23], s31 offen offset:2048 lds
    s_add_u32 s30, s30, 8192
    s_add_u32 s31, s31, 12288
    s_add_u32 m0, s32, 40960
    s_nop 0
    buffer_load_dwordx4 v6, s[16:19], s30 offen offset:0 lds
    buffer_load_dwordx4 v6, s[16:19], s30 offen offset:1024 lds
    s_add_u32 m0, s33, 40960
    s_nop 0
    buffer_load_dwordx4 v8, s[20:23], s31 offen offset:0 lds
    buffer_load_dwordx4 v8, s[20:23], s31 offen offset:1024 lds
    buffer_load_dwordx4 v8, s[20:23], s31 offen offset:2048 lds
    s_add_u32 s30, s30, 8192
    s_add_u32 s31, s31, 12288
    s_add_u32 m0, s32, 61440
    s_nop 0
    buffer_load_dwordx4 v6, s[16:19], s30 offen offset:0 lds
    buffer_load_dwordx4 v6, s[16:19], s30 offen offset:1024 lds
    s_add_u32 m0, s33, 61440
    s_nop 0
    buffer_load_dwordx4 v8, s[20:23], s31 offen offset:0 lds
    buffer_load_dwordx4 v8, s[20:23], s31 offen offset:1024 lds
    buffer_load_dwordx4 v8, s[20:23], s31 offen offset:2048 lds
    s_add_u32 s30, s30, 8192
    s_add_u32 s31, s31, 12288
    s_and_b32 s35, s14, 1
    s_lshr_b32 s36, s14, 1
    v_and_b32 v11, 15, v1
    v_lshrrev_b32 v12, 4, v1
    v_lshrrev_b32 v2, 2, v11
    v_sub_u32 v2, 0, v2
    v_xor_b32 v2, v2, v12
    v_and_b32 v2, 3, v2
    v_lshlrev_b32 v2, 4, v2
    s_lshl_b32 s15, s35, 12
    v_lshl_add_u32 v2, v11, 6, v2
    v_add_u32 v13, s15, v2
    s_mul_i32 s15, s36, 3072
    s_add_u32 s15, s15, 8192
    v_lshlrev_b32 v2, 4, v1
    v_add_u32 v14, s15, v2
    v_add_u32 v15, 40960, v14
    s_waitcnt vmcnt(15)
    s_barrier
    ds_read_b128 v[88:91], v13 offset:0
    ds_read_b128 v[64:67], v14 offset:0
    ds_read_b128 v[68:71], v14 offset:1024
    ds_read_b128 v[72:75], v14 offset:2048
    ds_read_b128 v[76:79], v14 offset:6144
    ds_read_b128 v[80:83], v14 offset:7168
    ds_read_b128 v[84:87], v14 offset:8192
    ds_read_b128 v[92:95], v13 offset:1024
    ds_read_b128 v[96:99], v13 offset:2048
    ds_read_b128 v[100:103], v13 offset:3072
    s_waitcnt lgkmcnt(0)
    s_waitcnt vmcnt(10)
    s_barrier
    v_mfma_f32_16x16x32_bf16 v[160:163], v[64:67], v[88:91], 0
    ds_read_b128 v[128:131], v13 offset:20480
    v_mfma_f32_16x16x32_bf16 v[176:179], v[68:71], v[88:91], 0
    ds_read_b128 v[104:107], v14 offset:20480
    v_mfma_f32_16x16x32_bf16 v[192:195], v[72:75], v[88:91], 0
    ds_read_b128 v[108:111], v14 offset:21504
    v_mfma_f32_16x16x32_bf16 v[208:211], v[76:79], v[88:91], 0
    ds_read_b128 v[112:115], v14 offset:22528
    v_mfma_f32_16x16x32_bf16 v[224:227], v[80:83], v[88:91], 0
    ds_read_b128 v[116:119], v14 offset:26624
    v_mfma_f32_16x16x32_bf16 v[240:243], v[84:87], v[88:91], 0
    ds_read_b128 v[120:123], v14 offset:27648
    v_mfma_f32_16x16x32_bf16 v[164:167], v[64:67], v[92:95], 0
    ds_read_b128 v[124:127], v14 offset:28672
    v_mfma_f32_16x16x32_bf16 v[180:183], v[68:71], v[92:95], 0
    ds_read_b128 v[132:135], v13 offset:21504
    v_mfma_f32_16x16x32_bf16 v[196:199], v[72:75], v[92:95], 0
    ds_read_b128 v[136:139], v13 offset:22528
    v_mfma_f32_16x16x32_bf16 v[212:215], v[76:79], v[92:95], 0
    ds_read_b128 v[140:143], v13 offset:23552
    v_mfma_f32_16x16x32_bf16 v[228:231], v[80:83], v[92:95], 0
    s_add_u32 m0, s32, 0
    v_mfma_f32_16x16x32_bf16 v[244:247], v[84:87], v[92:95], 0
    buffer_load_dwordx4 v6, s[16:19], s30 offen offset:0 lds
    v_mfma_f32_16x16x32_bf16 v[168:171], v[64:67], v[96:99], 0
    buffer_load_dwordx4 v6, s[16:19], s30 offen offset:1024 lds
    v_mfma_f32_16x16x32_bf16 v[184:187], v[68:71], v[96:99], 0
    s_add_u32 m0, s33, 0
    v_mfma_f32_16x16x32_bf16 v[200:203], v[72:75], v[96:99], 0
    buffer_load_dwordx4 v8, s[20:23], s31 offen offset:0 lds
    v_mfma_f32_16x16x32_bf16 v[216:219], v[76:79], v[96:99], 0
    buffer_load_dwordx4 v8, s[20:23], s31 offen offset:1024 lds
    v_mfma_f32_16x16x32_bf16 v[232:235], v[80:83], v[96:99], 0
    buffer_load_dwordx4 v8, s[20:23], s31 offen offset:2048 lds
    v_mfma_f32_16x16x32_bf16 v[248:251], v[84:87], v[96:99], 0
    s_add_u32 s30, s30, 8192
    v_mfma_f32_16x16x32_bf16 v[172:175], v[64:67], v[100:103], 0
    s_add_u32 s31, s31, 12288
    v_mfma_f32_16x16x32_bf16 v[188:191], v[68:71], v[100:103], 0
    v_mfma_f32_16x16x32_bf16 v[204:207], v[72:75], v[100:103], 0
    v_mfma_f32_16x16x32_bf16 v[220:223], v[76:79], v[100:103], 0
    v_mfma_f32_16x16x32_bf16 v[236:239], v[80:83], v[100:103], 0
    v_mfma_f32_16x16x32_bf16 v[252:255], v[84:87], v[100:103], 0
    s_waitcnt lgkmcnt(0)
    s_waitcnt vmcnt(10)
    s_barrier
    v_mfma_f32_16x16x32_bf16 v[160:163], v[104:107], v[128:131], v[160:163]
    ds_read_b128 v[88:91], v13 offset:40960
    v_mfma_f32_16x16x32_bf16 v[176:179], v[108:111], v[128:131], v[176:179]
    ds_read_b128 v[64:67], v15 offset:0
    v_mfma_f32_16x16x32_bf16 v[192:195], v[112:115], v[128:131], v[192:195]
    ds_read_b128 v[68:71], v15 offset:1024
    v_mfma_f32_16x16x32_bf16 v[208:211], v[116:119], v[128:131], v[208:211]
    ds_read_b128 v[72:75], v15 offset:2048
    v_mfma_f32_16x16x32_bf16 v[224:227], v[120:123], v[128:131], v[224:227]
    ds_read_b128 v[76:79], v15 offset:6144
    v_mfma_f32_16x16x32_bf16 v[240:243], v[124:127], v[128:131], v[240:243]
    ds_read_b128 v[80:83], v15 offset:7168
    v_mfma_f32_16x16x32_bf16 v[164:167], v[104:107], v[132:135], v[164:167]
    ds_read_b128 v[84:87], v15 offset:8192
    v_mfma_f32_16x16x32_bf16 v[180:183], v[108:111], v[132:135], v[180:183]
    ds_read_b128 v[92:95], v13 offset:41984
    v_mfma_f32_16x16x32_bf16 v[196:199], v[112:115], v[132:135], v[196:199]
    ds_read_b128 v[96:99], v13 offset:43008
    v_mfma_f32_16x16x32_bf16 v[212:215], v[116:119], v[132:135], v[212:215]
    ds_read_b128 v[100:103], v13 offset:44032
    v_mfma_f32_16x16x32_bf16 v[228:231], v[120:123], v[132:135], v[228:231]
    s_add_u32 m0, s32, 20480
    v_mfma_f32_16x16x32_bf16 v[244:247], v[124:127], v[132:135], v[244:247]
    buffer_load_dwordx4 v6, s[16:19], s30 offen offset:0 lds
    v_mfma_f32_16x16x32_bf16 v[168:171], v[104:107], v[136:139], v[168:171]
    buffer_load_dwordx4 v6, s[16:19], s30 offen offset:1024 lds
    v_mfma_f32_16x16x32_bf16 v[184:187], v[108:111], v[136:139], v[184:187]
    s_add_u32 m0, s33, 20480
    v_mfma_f32_16x16x32_bf16 v[200:203], v[112:115], v[136:139], v[200:203]
    buffer_load_dwordx4 v8, s[20:23], s31 offen offset:0 lds
    v_mfma_f32_16x16x32_bf16 v[216:219], v[116:119], v[136:139], v[216:219]
    buffer_load_dwordx4 v8, s[20:23], s31 offen offset:1024 lds
    v_mfma_f32_16x16x32_bf16 v[232:235], v[120:123], v[136:139], v[232:235]
    buffer_load_dwordx4 v8, s[20:23], s31 offen offset:2048 lds
    v_mfma_f32_16x16x32_bf16 v[248:251], v[124:127], v[136:139], v[248:251]
    s_add_u32 s30, s30, 8192
    v_mfma_f32_16x16x32_bf16 v[172:175], v[104:107], v[140:143], v[172:175]
    s_add_u32 s31, s31, 12288
    v_mfma_f32_16x16x32_bf16 v[188:191], v[108:111], v[140:143], v[188:191]
    v_mfma_f32_16x16x32_bf16 v[204:207], v[112:115], v[140:143], v[204:207]
    v_mfma_f32_16x16x32_bf16 v[220:223], v[116:119], v[140:143], v[220:223]
    v_mfma_f32_16x16x32_bf16 v[236:239], v[120:123], v[140:143], v[236:239]
    v_mfma_f32_16x16x32_bf16 v[252:255], v[124:127], v[140:143], v[252:255]
    s_waitcnt lgkmcnt(0)
    s_waitcnt vmcnt(10)
    s_barrier
    v_mfma_f32_16x16x32_bf16 v[160:163], v[64:67], v[88:91], v[160:163]
    ds_read_b128 v[128:131], v13 offset:61440
    v_mfma_f32_16x16x32_bf16 v[176:179], v[68:71], v[88:91], v[176:179]
    ds_read_b128 v[104:107], v15 offset:20480
    v_mfma_f32_16x16x32_bf16 v[192:195], v[72:75], v[88:91], v[192:195]
    ds_read_b128 v[108:111], v15 offset:21504
    v_mfma_f32_16x16x32_bf16 v[208:211], v[76:79], v[88:91], v[208:211]
    ds_read_b128 v[112:115], v15 offset:22528
    v_mfma_f32_16x16x32_bf16 v[224:227], v[80:83], v[88:91], v[224:227]
    ds_read_b128 v[116:119], v15 offset:26624
    v_mfma_f32_16x16x32_bf16 v[240:243], v[84:87], v[88:91], v[240:243]
    ds_read_b128 v[120:123], v15 offset:27648
    v_mfma_f32_16x16x32_bf16 v[164:167], v[64:67], v[92:95], v[164:167]
    ds_read_b128 v[124:127], v15 offset:28672
    v_mfma_f32_16x16x32_bf16 v[180:183], v[68:71], v[92:95], v[180:183]
    ds_read_b128 v[132:135], v13 offset:62464
    v_mfma_f32_16x16x32_bf16 v[196:199], v[72:75], v[92:95], v[196:199]
    ds_read_b128 v[136:139], v13 offset:63488
    v_mfma_f32_16x16x32_bf16 v[212:215], v[76:79], v[92:95], v[212:215]
    ds_read_b128 v[140:143], v13 offset:64512
    v_mfma_f32_16x16x32_bf16 v[228:231], v[80:83], v[92:95], v[228:231]
    s_add_u32 m0, s32, 40960
    v_mfma_f32_16x16x32_bf16 v[244:247], v[84:87], v[92:95], v[244:247]
    buffer_load_dwordx4 v6, s[16:19], s30 offen offset:0 lds
    v_mfma_f32_16x16x32_bf16 v[168:171], v[64:67], v[96:99], v[168:171]
    buffer_load_dwordx4 v6, s[16:19], s30 offen offset:1024 lds
    v_mfma_f32_16x16x32_bf16 v[184:187], v[68:71], v[96:99], v[184:187]
    s_add_u32 m0, s33, 40960
    v_mfma_f32_16x16x32_bf16 v[200:203], v[72:75], v[96:99], v[200:203]
    buffer_load_dwordx4 v8, s[20:23], s31 offen offset:0 lds
    v_mfma_f32_16x16x32_bf16 v[216:219], v[76:79], v[96:99], v[216:219]
    buffer_load_dwordx4 v8, s[20:23], s31 offen offset:1024 lds
    v_mfma_f32_16x16x32_bf16 v[232:235], v[80:83], v[96:99], v[232:235]
    buffer_load_dwordx4 v8, s[20:23], s31 offen offset:2048 lds
    v_mfma_f32_16x16x32_bf16 v[248:251], v[84:87], v[96:99], v[248:251]
    s_add_u32 s30, s30, 8192
    v_mfma_f32_16x16x32_bf16 v[172:175], v[64:67], v[100:103], v[172:175]
    s_add_u32 s31, s31, 12288
    v_mfma_f32_16x16x32_bf16 v[188:191], v[68:71], v[100:103], v[188:191]
    v_mfma_f32_16x16x32_bf16 v[204:207], v[72:75], v[100:103], v[204:207]
    v_mfma_f32_16x16x32_bf16 v[220:223], v[76:79], v[100:103], v[220:223]
    v_mfma_f32_16x16x32_bf16 v[236:239], v[80:83], v[100:103], v[236:239]
    v_mfma_f32_16x16x32_bf16 v[252:255], v[84:87], v[100:103], v[252:255]
    s_waitcnt lgkmcnt(0)
    s_waitcnt vmcnt(10)
    s_barrier
    v_mfma_f32_16x16x32_bf16 v[160:163], v[104:107], v[128:131], v[160:163]
    ds_read_b128 v[88:91], v13 offset:0
    v_mfma_f32_16x16x32_bf16 v[176:179], v[108:111], v[128:131], v[176:179]
    ds_read_b128 v[64:67], v14 offset:0
    v_mfma_f32_16x16x32_bf16 v[192:195], v[112:115], v[128:131], v[192:195]
    ds_read_b128 v[68:71], v14 offset:1024
    v_mfma_f32_16x16x32_bf16 v[208:211], v[116:119], v[128:131], v[208:211]
    ds_read_b128 v[72:75], v14 offset:2048
    v_mfma_f32_16x16x32_bf16 v[224:227], v[120:123], v[128:131], v[224:227]
    ds_read_b128 v[76:79], v14 offset:6144
    v_mfma_f32_16x16x32_bf16 v[240:243], v[124:127], v[128:131], v[240:243]
    ds_read_b128 v[80:83], v14 offset:7168
    v_mfma_f32_16x16x32_bf16 v[164:167], v[104:107], v[132:135], v[164:167]
    ds_read_b128 v[84:87], v14 offset:8192
    v_mfma_f32_16x16x32_bf16 v[180:183], v[108:111], v[132:135], v[180:183]
    ds_read_b128 v[92:95], v13 offset:1024
    v_mfma_f32_16x16x32_bf16 v[196:199], v[112:115], v[132:135], v[196:199]
    ds_read_b128 v[96:99], v13 offset:2048
    v_mfma_f32_16x16x32_bf16 v[212:215], v[116:119], v[132:135], v[212:215]
    ds_read_b128 v[100:103], v13 offset:3072
    v_mfma_f32_16x16x32_bf16 v[228:231], v[120:123], v[132:135], v[228:231]
    s_add_u32 m0, s32, 61440
    v_mfma_f32_16x16x32_bf16 v[244:247], v[124:127], v[132:135], v[244:247]
    buffer_load_dwordx4 v6, s[16:19], s30 offen offset:0 lds
    v_mfma_f32_16x16x32_bf16 v[168:171], v[104:107], v[136:139], v[168:171]
    buffer_load_dwordx4 v6, s[16:19], s30 offen offset:1024 lds
    v_mfma_f32_16x16x32_bf16 v[184:187], v[108:111], v[136:139], v[184:187]
    s_add_u32 m0, s33, 61440
    v_mfma_f32_16x16x32_bf16 v[200:203], v[112:115], v[136:139], v[200:203]
    buffer_load_dwordx4 v8, s[20:23], s31 offen offset:0 lds
    v_mfma_f32_16x16x32_bf16 v[216:219], v[116:119], v[136:139], v[216:219]
    buffer_load_dwordx4 v8, s[20:23], s31 offen offset:1024 lds
    v_mfma_f32_16x16x32_bf16 v[232:235], v[120:123], v[136:139], v[232:235]
    buffer_load_dwordx4 v8, s[20:23], s31 offen offset:2048 lds
    v_mfma_f32_16x16x32_bf16 v[248:251], v[124:127], v[136:139], v[248:251]
    s_add_u32 s30, s30, 8192
    v_mfma_f32_16x16x32_bf16 v[172:175], v[104:107], v[140:143], v[172:175]
    s_add_u32 s31, s31, 12288
    v_mfma_f32_16x16x32_bf16 v[188:191], v[108:111], v[140:143], v[188:191]
    v_mfma_f32_16x16x32_bf16 v[204:207], v[112:115], v[140:143], v[204:207]
    v_mfma_f32_16x16x32_bf16 v[220:223], v[116:119], v[140:143], v[220:223]
    v_mfma_f32_16x16x32_bf16 v[236:239], v[120:123], v[140:143], v[236:239]
    v_mfma_f32_16x16x32_bf16 v[252:255], v[124:127], v[140:143], v[252:255]
    s_waitcnt lgkmcnt(0)
    s_mov_b32 s34, 3
K2_GLOOP:
    s_waitcnt vmcnt(10)
    s_barrier
    v_mfma_f32_16x16x32_bf16 v[160:163], v[64:67], v[88:91], v[160:163]
    ds_read_b128 v[128:131], v13 offset:20480
    v_mfma_f32_16x16x32_bf16 v[176:179], v[68:71], v[88:91], v[176:179]
    ds_read_b128 v[104:107], v14 offset:20480
    v_mfma_f32_16x16x32_bf16 v[192:195], v[72:75], v[88:91], v[192:195]
    ds_read_b128 v[108:111], v14 offset:21504
    v_mfma_f32_16x16x32_bf16 v[208:211], v[76:79], v[88:91], v[208:211]
    ds_read_b128 v[112:115], v14 offset:22528
    v_mfma_f32_16x16x32_bf16 v[224:227], v[80:83], v[88:91], v[224:227]
    ds_read_b128 v[116:119], v14 offset:26624
    v_mfma_f32_16x16x32_bf16 v[240:243], v[84:87], v[88:91], v[240:243]
    ds_read_b128 v[120:123], v14 offset:27648
    v_mfma_f32_16x16x32_bf16 v[164:167], v[64:67], v[92:95], v[164:167]
    ds_read_b128 v[124:127], v14 offset:28672
    v_mfma_f32_16x16x32_bf16 v[180:183], v[68:71], v[92:95], v[180:183]
    ds_read_b128 v[132:135], v13 offset:21504
    v_mfma_f32_16x16x32_bf16 v[196:199], v[72:75], v[92:95], v[196:199]
    ds_read_b128 v[136:139], v13 offset:22528
    v_mfma_f32_16x16x32_bf16 v[212:215], v[76:79], v[92:95], v[212:215]
    ds_read_b128 v[140:143], v13 offset:23552
    v_mfma_f32_16x16x32_bf16 v[228:231], v[80:83], v[92:95], v[228:231]
    s_add_u32 m0, s32, 0
    v_mfma_f32_16x16x32_bf16 v[244:247], v[84:87], v[92:95], v[244:247]
    buffer_load_dwordx4 v6, s[16:19], s30 offen offset:0 lds
    v_mfma_f32_16x16x32_bf16 v[168:171], v[64:67], v[96:99], v[168:171]
    buffer_load_dwordx4 v6, s[16:19], s30 offen offset:1024 lds
    v_mfma_f32_16x16x32_bf16 v[184:187], v[68:71], v[96:99], v[184:187]
    s_add_u32 m0, s33, 0
    v_mfma_f32_16x16x32_bf16 v[200:203], v[72:75], v[96:99], v[200:203]
    buffer_load_dwordx4 v8, s[20:23], s31 offen offset:0 lds
    v_mfma_f32_16x16x32_bf16 v[216:219], v[76:79], v[96:99], v[216:219]
    buffer_load_dwordx4 v8, s[20:23], s31 offen offset:1024 lds
    v_mfma_f32_16x16x32_bf16 v[232:235], v[80:83], v[96:99], v[232:235]
    buffer_load_dwordx4 v8, s[20:23], s31 offen offset:2048 lds
    v_mfma_f32_16x16x32_bf16 v[248:251], v[84:87], v[96:99], v[248:251]
    s_add_u32 s30, s30, 8192
    v_mfma_f32_16x16x32_bf16 v[172:175], v[64:67], v[100:103], v[172:175]
    s_add_u32 s31, s31, 12288
    v_mfma_f32_16x16x32_bf16 v[188:191], v[68:71], v[100:103], v[188:191]
    v_mfma_f32_16x16x32_bf16 v[204:207], v[72:75], v[100:103], v[204:207]
    v_mfma_f32_16x16x32_bf16 v[220:223], v[76:79], v[100:103], v[220:223]
    v_mfma_f32_16x16x32_bf16 v[236:239], v[80:83], v[100:103], v[236:239]
    v_mfma_f32_16x16x32_bf16 v[252:255], v[84:87], v[100:103], v[252:255]
    s_waitcnt lgkmcnt(0)
    s_waitcnt vmcnt(10)
    s_barrier
    v_mfma_f32_16x16x32_bf16 v[160:163], v[104:107], v[128:131], v[160:163]
    ds_read_b128 v[88:91], v13 offset:40960
    v_mfma_f32_16x16x32_bf16 v[176:179], v[108:111], v[128:131], v[176:179]
    ds_read_b128 v[64:67], v15 offset:0
    v_mfma_f32_16x16x32_bf16 v[192:195], v[112:115], v[128:131], v[192:195]
    ds_read_b128 v[68:71], v15 offset:1024
    v_mfma_f32_16x16x32_bf16 v[208:211], v[116:119], v[128:131], v[208:211]
    ds_read_b128 v[72:75], v15 offset:2048
    v_mfma_f32_16x16x32_bf16 v[224:227], v[120:123], v[128:131], v[224:227]
    ds_read_b128 v[76:79], v15 offset:6144
    v_mfma_f32_16x16x32_bf16 v[240:243], v[124:127], v[128:131], v[240:243]
    ds_read_b128 v[80:83], v15 offset:7168
    v_mfma_f32_16x16x32_bf16 v[164:167], v[104:107], v[132:135], v[164:167]
    ds_read_b128 v[84:87], v15 offset:8192
    v_mfma_f32_16x16x32_bf16 v[180:183], v[108:111], v[132:135], v[180:183]
    ds_read_b128 v[92:95], v13 offset:41984
    v_mfma_f32_16x16x32_bf16 v[196:199], v[112:115], v[132:135], v[196:199]
    ds_read_b128 v[96:99], v13 offset:43008
    v_mfma_f32_16x16x32_bf16 v[212:215], v[116:119], v[132:135], v[212:215]
    ds_read_b128 v[100:103], v13 offset:44032
    v_mfma_f32_16x16x32_bf16 v[228:231], v[120:123], v[132:135], v[228:231]
    s_add_u32 m0, s32, 20480
    v_mfma_f32_16x16x32_bf16 v[244:247], v[124:127], v[132:135], v[244:247]
    buffer_load_dwordx4 v6, s[16:19], s30 offen offset:0 lds
    v_mfma_f32_16x16x32_bf16 v[168:171], v[104:107], v[136:139], v[168:171]
    buffer_load_dwordx4 v6, s[16:19], s30 offen offset:1024 lds
    v_mfma_f32_16x16x32_bf16 v[184:187], v[108:111], v[136:139], v[184:187]
    s_add_u32 m0, s33, 20480
    v_mfma_f32_16x16x32_bf16 v[200:203], v[112:115], v[136:139], v[200:203]
    buffer_load_dwordx4 v8, s[20:23], s31 offen offset:0 lds
    v_mfma_f32_16x16x32_bf16 v[216:219], v[116:119], v[136:139], v[216:219]
    buffer_load_dwordx4 v8, s[20:23], s31 offen offset:1024 lds
    v_mfma_f32_16x16x32_bf16 v[232:235], v[120:123], v[136:139], v[232:235]
    buffer_load_dwordx4 v8, s[20:23], s31 offen offset:2048 lds
    v_mfma_f32_16x16x32_bf16 v[248:251], v[124:127], v[136:139], v[248:251]
    s_add_u32 s30, s30, 8192
    v_mfma_f32_16x16x32_bf16 v[172:175], v[104:107], v[140:143], v[172:175]
    s_add_u32 s31, s31, 12288
    v_mfma_f32_16x16x32_bf16 v[188:191], v[108:111], v[140:143], v[188:191]
    v_mfma_f32_16x16x32_bf16 v[204:207], v[112:115], v[140:143], v[204:207]
    v_mfma_f32_16x16x32_bf16 v[220:223], v[116:119], v[140:143], v[220:223]
    v_mfma_f32_16x16x32_bf16 v[236:239], v[120:123], v[140:143], v[236:239]
    v_mfma_f32_16x16x32_bf16 v[252:255], v[124:127], v[140:143], v[252:255]
    s_waitcnt lgkmcnt(0)
    s_waitcnt vmcnt(10)
    s_barrier
    v_mfma_f32_16x16x32_bf16 v[160:163], v[64:67], v[88:91], v[160:163]
    ds_read_b128 v[128:131], v13 offset:61440
    v_mfma_f32_16x16x32_bf16 v[176:179], v[68:71], v[88:91], v[176:179]
    ds_read_b128 v[104:107], v15 offset:20480
    v_mfma_f32_16x16x32_bf16 v[192:195], v[72:75], v[88:91], v[192:195]
    ds_read_b128 v[108:111], v15 offset:21504
    v_mfma_f32_16x16x32_bf16 v[208:211], v[76:79], v[88:91], v[208:211]
    ds_read_b128 v[112:115], v15 offset:22528
    v_mfma_f32_16x16x32_bf16 v[224:227], v[80:83], v[88:91], v[224:227]
    ds_read_b128 v[116:119], v15 offset:26624
    v_mfma_f32_16x16x32_bf16 v[240:243], v[84:87], v[88:91], v[240:243]
    ds_read_b128 v[120:123], v15 offset:27648
    v_mfma_f32_16x16x32_bf16 v[164:167], v[64:67], v[92:95], v[164:167]
    ds_read_b128 v[124:127], v15 offset:28672
    v_mfma_f32_16x16x32_bf16 v[180:183], v[68:71], v[92:95], v[180:183]
    ds_read_b128 v[132:135], v13 offset:62464
    v_mfma_f32_16x16x32_bf16 v[196:199], v[72:75], v[92:95], v[196:199]
    ds_read_b128 v[136:139], v13 offset:63488
    v_mfma_f32_16x16x32_bf16 v[212:215], v[76:79], v[92:95], v[212:215]
    ds_read_b128 v[140:143], v13 offset:64512
    v_mfma_f32_16x16x32_bf16 v[228:231], v[80:83], v[92:95], v[228:231]
    s_add_u32 m0, s32, 40960
    v_mfma_f32_16x16x32_bf16 v[244:247], v[84:87], v[92:95], v[244:247]
    buffer_load_dwordx4 v6, s[16:19], s30 offen offset:0 lds
    v_mfma_f32_16x16x32_bf16 v[168:171], v[64:67], v[96:99], v[168:171]
    buffer_load_dwordx4 v6, s[16:19], s30 offen offset:1024 lds
    v_mfma_f32_16x16x32_bf16 v[184:187], v[68:71], v[96:99], v[184:187]
    s_add_u32 m0, s33, 40960
    v_mfma_f32_16x16x32_bf16 v[200:203], v[72:75], v[96:99], v[200:203]
    buffer_load_dwordx4 v8, s[20:23], s31 offen offset:0 lds
    v_mfma_f32_16x16x32_bf16 v[216:219], v[76:79], v[96:99], v[216:219]
    buffer_load_dwordx4 v8, s[20:23], s31 offen offset:1024 lds
    v_mfma_f32_16x16x32_bf16 v[232:235], v[80:83], v[96:99], v[232:235]
    buffer_load_dwordx4 v8, s[20:23], s31 offen offset:2048 lds
    v_mfma_f32_16x16x32_bf16 v[248:251], v[84:87], v[96:99], v[248:251]
    s_add_u32 s30, s30, 8192
    v_mfma_f32_16x16x32_bf16 v[172:175], v[64:67], v[100:103], v[172:175]
    s_add_u32 s31, s31, 12288
    v_mfma_f32_16x16x32_bf16 v[188:191], v[68:71], v[100:103], v[188:191]
    v_mfma_f32_16x16x32_bf16 v[204:207], v[72:75], v[100:103], v[204:207]
    v_mfma_f32_16x16x32_bf16 v[220:223], v[76:79], v[100:103], v[220:223]
    v_mfma_f32_16x16x32_bf16 v[236:239], v[80:83], v[100:103], v[236:239]
    v_mfma_f32_16x16x32_bf16 v[252:255], v[84:87], v[100:103], v[252:255]
    s_waitcnt lgkmcnt(0)
    s_waitcnt vmcnt(10)
    s_barrier
    v_mfma_f32_16x16x32_bf16 v[160:163], v[104:107], v[128:131], v[160:163]
    ds_read_b128 v[88:91], v13 offset:0
    v_mfma_f32_16x16x32_bf16 v[176:179], v[108:111], v[128:131], v[176:179]
    ds_read_b128 v[64:67], v14 offset:0
    v_mfma_f32_16x16x32_bf16 v[192:195], v[112:115], v[128:131], v[192:195]
    ds_read_b128 v[68:71], v14 offset:1024
    v_mfma_f32_16x16x32_bf16 v[208:211], v[116:119], v[128:131], v[208:211]
    ds_read_b128 v[72:75], v14 offset:2048
    v_mfma_f32_16x16x32_bf16 v[224:227], v[120:123], v[128:131], v[224:227]
    ds_read_b128 v[76:79], v14 offset:6144
    v_mfma_f32_16x16x32_bf16 v[240:243], v[124:127], v[128:131], v[240:243]
    ds_read_b128 v[80:83], v14 offset:7168
    v_mfma_f32_16x16x32_bf16 v[164:167], v[104:107], v[132:135], v[164:167]
    ds_read_b128 v[84:87], v14 offset:8192
    v_mfma_f32_16x16x32_bf16 v[180:183], v[108:111], v[132:135], v[180:183]
    ds_read_b128 v[92:95], v13 offset:1024
    v_mfma_f32_16x16x32_bf16 v[196:199], v[112:115], v[132:135], v[196:199]
    ds_read_b128 v[96:99], v13 offset:2048
    v_mfma_f32_16x16x32_bf16 v[212:215], v[116:119], v[132:135], v[212:215]
    ds_read_b128 v[100:103], v13 offset:3072
    v_mfma_f32_16x16x32_bf16 v[228:231], v[120:123], v[132:135], v[228:231]
    s_add_u32 m0, s32, 61440
    v_mfma_f32_16x16x32_bf16 v[244:247], v[124:127], v[132:135], v[244:247]
    buffer_load_dwordx4 v6, s[16:19], s30 offen offset:0 lds
    v_mfma_f32_16x16x32_bf16 v[168:171], v[104:107], v[136:139], v[168:171]
    buffer_load_dwordx4 v6, s[16:19], s30 offen offset:1024 lds
    v_mfma_f32_16x16x32_bf16 v[184:187], v[108:111], v[136:139], v[184:187]
    s_add_u32 m0, s33, 61440
    v_mfma_f32_16x16x32_bf16 v[200:203], v[112:115], v[136:139], v[200:203]
    buffer_load_dwordx4 v8, s[20:23], s31 offen offset:0 lds
    v_mfma_f32_16x16x32_bf16 v[216:219], v[116:119], v[136:139], v[216:219]
    buffer_load_dwordx4 v8, s[20:23], s31 offen offset:1024 lds
    v_mfma_f32_16x16x32_bf16 v[232:235], v[120:123], v[136:139], v[232:235]
    buffer_load_dwordx4 v8, s[20:23], s31 offen offset:2048 lds
    v_mfma_f32_16x16x32_bf16 v[248:251], v[124:127], v[136:139], v[248:251]
    s_add_u32 s30, s30, 8192
    v_mfma_f32_16x16x32_bf16 v[172:175], v[104:107], v[140:143], v[172:175]
    s_add_u32 s31, s31, 12288
    v_mfma_f32_16x16x32_bf16 v[188:191], v[108:111], v[140:143], v[188:191]
    v_mfma_f32_16x16x32_bf16 v[204:207], v[112:115], v[140:143], v[204:207]
    v_mfma_f32_16x16x32_bf16 v[220:223], v[116:119], v[140:143], v[220:223]
    v_mfma_f32_16x16x32_bf16 v[236:239], v[120:123], v[140:143], v[236:239]
    v_mfma_f32_16x16x32_bf16 v[252:255], v[124:127], v[140:143], v[252:255]
    s_waitcnt lgkmcnt(0)
    s_sub_u32 s34, s34, 1
    s_cmp_lg_u32 s34, 0
    s_cbranch_scc1 K2_GLOOP
    s_waitcnt vmcnt(10)
    s_barrier
    v_mfma_f32_16x16x32_bf16 v[160:163], v[64:67], v[88:91], v[160:163]
    ds_read_b128 v[128:131], v13 offset:20480
    v_mfma_f32_16x16x32_bf16 v[176:179], v[68:71], v[88:91], v[176:179]
    ds_read_b128 v[104:107], v14 offset:20480
    v_mfma_f32_16x16x32_bf16 v[192:195], v[72:75], v[88:91], v[192:195]
    ds_read_b128 v[108:111], v14 offset:21504
    v_mfma_f32_16x16x32_bf16 v[208:211], v[76:79], v[88:91], v[208:211]
    ds_read_b128 v[112:115], v14 offset:22528
    v_mfma_f32_16x16x32_bf16 v[224:227], v[80:83], v[88:91], v[224:227]
    ds_read_b128 v[116:119], v14 offset:26624
    v_mfma_f32_16x16x32_bf16 v[240:243], v[84:87], v[88:91], v[240:243]
    ds_read_b128 v[120:123], v14 offset:27648
    v_mfma_f32_16x16x32_bf16 v[164:167], v[64:67], v[92:95], v[164:167]
    ds_read_b128 v[124:127], v14 offset:28672
    v_mfma_f32_16x16x32_bf16 v[180:183], v[68:71], v[92:95], v[180:183]
    ds_read_b128 v[132:135], v13 offset:21504
    v_mfma_f32_16x16x32_bf16 v[196:199], v[72:75], v[92:95], v[196:199]
    ds_read_b128 v[136:139], v13 offset:22528
    v_mfma_f32_16x16x32_bf16 v[212:215], v[76:79], v[92:95], v[212:215]
    ds_read_b128 v[140:143], v13 offset:23552
    v_mfma_f32_16x16x32_bf16 v[228:231], v[80:83], v[92:95], v[228:231]
    v_mfma_f32_16x16x32_bf16 v[244:247], v[84:87], v[92:95], v[244:247]
    v_mfma_f32_16x16x32_bf16 v[168:171], v[64:67], v[96:99], v[168:171]
    v_mfma_f32_16x16x32_bf16 v[184:187], v[68:71], v[96:99], v[184:187]
    v_mfma_f32_16x16x32_bf16 v[200:203], v[72:75], v[96:99], v[200:203]
    v_mfma_f32_16x16x32_bf16 v[216:219], v[76:79], v[96:99], v[216:219]
    v_mfma_f32_16x16x32_bf16 v[232:235], v[80:83], v[96:99], v[232:235]
    v_mfma_f32_16x16x32_bf16 v[248:251], v[84:87], v[96:99], v[248:251]
    v_mfma_f32_16x16x32_bf16 v[172:175], v[64:67], v[100:103], v[172:175]
    v_mfma_f32_16x16x32_bf16 v[188:191], v[68:71], v[100:103], v[188:191]
    v_mfma_f32_16x16x32_bf16 v[204:207], v[72:75], v[100:103], v[204:207]
    v_mfma_f32_16x16x32_bf16 v[220:223], v[76:79], v[100:103], v[220:223]
    v_mfma_f32_16x16x32_bf16 v[236:239], v[80:83], v[100:103], v[236:239]
    v_mfma_f32_16x16x32_bf16 v[252:255], v[84:87], v[100:103], v[252:255]
    s_waitcnt lgkmcnt(0)
    s_waitcnt vmcnt(5)
    s_barrier
    v_mfma_f32_16x16x32_bf16 v[160:163], v[104:107], v[128:131], v[160:163]
    ds_read_b128 v[88:91], v13 offset:40960
    v_mfma_f32_16x16x32_bf16 v[176:179], v[108:111], v[128:131], v[176:179]
    ds_read_b128 v[64:67], v15 offset:0
    v_mfma_f32_16x16x32_bf16 v[192:195], v[112:115], v[128:131], v[192:195]
    ds_read_b128 v[68:71], v15 offset:1024
    v_mfma_f32_16x16x32_bf16 v[208:211], v[116:119], v[128:131], v[208:211]
    ds_read_b128 v[72:75], v15 offset:2048
    v_mfma_f32_16x16x32_bf16 v[224:227], v[120:123], v[128:131], v[224:227]
    ds_read_b128 v[76:79], v15 offset:6144
    v_mfma_f32_16x16x32_bf16 v[240:243], v[124:127], v[128:131], v[240:243]
    ds_read_b128 v[80:83], v15 offset:7168
    v_mfma_f32_16x16x32_bf16 v[164:167], v[104:107], v[132:135], v[164:167]
    ds_read_b128 v[84:87], v15 offset:8192
    v_mfma_f32_16x16x32_bf16 v[180:183], v[108:111], v[132:135], v[180:183]
    ds_read_b128 v[92:95], v13 offset:41984
    v_mfma_f32_16x16x32_bf16 v[196:199], v[112:115], v[132:135], v[196:199]
    ds_read_b128 v[96:99], v13 offset:43008
    v_mfma_f32_16x16x32_bf16 v[212:215], v[116:119], v[132:135], v[212:215]
    ds_read_b128 v[100:103], v13 offset:44032
    v_mfma_f32_16x16x32_bf16 v[228:231], v[120:123], v[132:135], v[228:231]
    v_mfma_f32_16x16x32_bf16 v[244:247], v[124:127], v[132:135], v[244:247]
    v_mfma_f32_16x16x32_bf16 v[168:171], v[104:107], v[136:139], v[168:171]
    v_mfma_f32_16x16x32_bf16 v[184:187], v[108:111], v[136:139], v[184:187]
    v_mfma_f32_16x16x32_bf16 v[200:203], v[112:115], v[136:139], v[200:203]
    v_mfma_f32_16x16x32_bf16 v[216:219], v[116:119], v[136:139], v[216:219]
    v_mfma_f32_16x16x32_bf16 v[232:235], v[120:123], v[136:139], v[232:235]
    v_mfma_f32_16x16x32_bf16 v[248:251], v[124:127], v[136:139], v[248:251]
    v_mfma_f32_16x16x32_bf16 v[172:175], v[104:107], v[140:143], v[172:175]
    v_mfma_f32_16x16x32_bf16 v[188:191], v[108:111], v[140:143], v[188:191]
    v_mfma_f32_16x16x32_bf16 v[204:207], v[112:115], v[140:143], v[204:207]
    v_mfma_f32_16x16x32_bf16 v[220:223], v[116:119], v[140:143], v[220:223]
    v_mfma_f32_16x16x32_bf16 v[236:239], v[120:123], v[140:143], v[236:239]
    v_mfma_f32_16x16x32_bf16 v[252:255], v[124:127], v[140:143], v[252:255]
    s_waitcnt lgkmcnt(0)
    s_waitcnt vmcnt(0)
    s_barrier
    v_mfma_f32_16x16x32_bf16 v[160:163], v[64:67], v[88:91], v[160:163]
    ds_read_b128 v[128:131], v13 offset:61440
    v_mfma_f32_16x16x32_bf16 v[176:179], v[68:71], v[88:91], v[176:179]
    ds_read_b128 v[104:107], v15 offset:20480
    v_mfma_f32_16x16x32_bf16 v[192:195], v[72:75], v[88:91], v[192:195]
    ds_read_b128 v[108:111], v15 offset:21504
    v_mfma_f32_16x16x32_bf16 v[208:211], v[76:79], v[88:91], v[208:211]
    ds_read_b128 v[112:115], v15 offset:22528
    v_mfma_f32_16x16x32_bf16 v[224:227], v[80:83], v[88:91], v[224:227]
    ds_read_b128 v[116:119], v15 offset:26624
    v_mfma_f32_16x16x32_bf16 v[240:243], v[84:87], v[88:91], v[240:243]
    ds_read_b128 v[120:123], v15 offset:27648
    v_mfma_f32_16x16x32_bf16 v[164:167], v[64:67], v[92:95], v[164:167]
    ds_read_b128 v[124:127], v15 offset:28672
    v_mfma_f32_16x16x32_bf16 v[180:183], v[68:71], v[92:95], v[180:183]
    ds_read_b128 v[132:135], v13 offset:62464
    v_mfma_f32_16x16x32_bf16 v[196:199], v[72:75], v[92:95], v[196:199]
    ds_read_b128 v[136:139], v13 offset:63488
    v_mfma_f32_16x16x32_bf16 v[212:215], v[76:79], v[92:95], v[212:215]
    ds_read_b128 v[140:143], v13 offset:64512
    v_mfma_f32_16x16x32_bf16 v[228:231], v[80:83], v[92:95], v[228:231]
    v_mfma_f32_16x16x32_bf16 v[244:247], v[84:87], v[92:95], v[244:247]
    v_mfma_f32_16x16x32_bf16 v[168:171], v[64:67], v[96:99], v[168:171]
    v_mfma_f32_16x16x32_bf16 v[184:187], v[68:71], v[96:99], v[184:187]
    v_mfma_f32_16x16x32_bf16 v[200:203], v[72:75], v[96:99], v[200:203]
    v_mfma_f32_16x16x32_bf16 v[216:219], v[76:79], v[96:99], v[216:219]
    v_mfma_f32_16x16x32_bf16 v[232:235], v[80:83], v[96:99], v[232:235]
    v_mfma_f32_16x16x32_bf16 v[248:251], v[84:87], v[96:99], v[248:251]
    v_mfma_f32_16x16x32_bf16 v[172:175], v[64:67], v[100:103], v[172:175]
    v_mfma_f32_16x16x32_bf16 v[188:191], v[68:71], v[100:103], v[188:191]
    v_mfma_f32_16x16x32_bf16 v[204:207], v[72:75], v[100:103], v[204:207]
    v_mfma_f32_16x16x32_bf16 v[220:223], v[76:79], v[100:103], v[220:223]
    v_mfma_f32_16x16x32_bf16 v[236:239], v[80:83], v[100:103], v[236:239]
    v_mfma_f32_16x16x32_bf16 v[252:255], v[84:87], v[100:103], v[252:255]
    s_waitcnt lgkmcnt(0)
    v_mfma_f32_16x16x32_bf16 v[160:163], v[104:107], v[128:131], v[160:163]
    v_mfma_f32_16x16x32_bf16 v[176:179], v[108:111], v[128:131], v[176:179]
    v_mfma_f32_16x16x32_bf16 v[192:195], v[112:115], v[128:131], v[192:195]
    v_mfma_f32_16x16x32_bf16 v[208:211], v[116:119], v[128:131], v[208:211]
    v_mfma_f32_16x16x32_bf16 v[224:227], v[120:123], v[128:131], v[224:227]
    v_mfma_f32_16x16x32_bf16 v[240:243], v[124:127], v[128:131], v[240:243]
    v_mfma_f32_16x16x32_bf16 v[164:167], v[104:107], v[132:135], v[164:167]
    v_mfma_f32_16x16x32_bf16 v[180:183], v[108:111], v[132:135], v[180:183]
    v_mfma_f32_16x16x32_bf16 v[196:199], v[112:115], v[132:135], v[196:199]
    v_mfma_f32_16x16x32_bf16 v[212:215], v[116:119], v[132:135], v[212:215]
    v_mfma_f32_16x16x32_bf16 v[228:231], v[120:123], v[132:135], v[228:231]
    v_mfma_f32_16x16x32_bf16 v[244:247], v[124:127], v[132:135], v[244:247]
    v_mfma_f32_16x16x32_bf16 v[168:171], v[104:107], v[136:139], v[168:171]
    v_mfma_f32_16x16x32_bf16 v[184:187], v[108:111], v[136:139], v[184:187]
    v_mfma_f32_16x16x32_bf16 v[200:203], v[112:115], v[136:139], v[200:203]
    v_mfma_f32_16x16x32_bf16 v[216:219], v[116:119], v[136:139], v[216:219]
    v_mfma_f32_16x16x32_bf16 v[232:235], v[120:123], v[136:139], v[232:235]
    v_mfma_f32_16x16x32_bf16 v[248:251], v[124:127], v[136:139], v[248:251]
    v_mfma_f32_16x16x32_bf16 v[172:175], v[104:107], v[140:143], v[172:175]
    v_mfma_f32_16x16x32_bf16 v[188:191], v[108:111], v[140:143], v[188:191]
    v_mfma_f32_16x16x32_bf16 v[204:207], v[112:115], v[140:143], v[204:207]
    v_mfma_f32_16x16x32_bf16 v[220:223], v[116:119], v[140:143], v[220:223]
    v_mfma_f32_16x16x32_bf16 v[236:239], v[120:123], v[140:143], v[236:239]
    v_mfma_f32_16x16x32_bf16 v[252:255], v[124:127], v[140:143], v[252:255]
    v_lshrrev_b32 v2, 1, v12
    v_lshl_add_u32 v2, v2, 4, v11
    v_lshlrev_b32 v2, 4, v2
    v_and_b32 v3, 1, v12
    v_lshl_add_u32 v20, v3, 10, v2
    s_lshl_b32 s15, s28, 1
    s_add_u32 s15, s15, s35
    s_mul_i32 s15, s15, 196608
    s_mul_i32 s44, s29, 6
    s_mul_i32 s45, s36, 3
    s_add_u32 s44, s44, s45
    s_add_u32 s45, s44, 0
    s_lshr_b32 s40, s45, 1
    s_lshl_b32 s40, s40, 12
    s_and_b32 s45, s45, 1
    s_lshl_b32 s45, s45, 9
    s_add_u32 s40, s40, s45
    s_add_u32 s40, s40, s15
    s_add_u32 s45, s44, 1
    s_lshr_b32 s41, s45, 1
    s_lshl_b32 s41, s41, 12
    s_and_b32 s45, s45, 1
    s_lshl_b32 s45, s45, 9
    s_add_u32 s41, s41, s45
    s_add_u32 s41, s41, s15
    s_add_u32 s45, s44, 2
    s_lshr_b32 s42, s45, 1
    s_lshl_b32 s42, s42, 12
    s_and_b32 s45, s45, 1
    s_lshl_b32 s45, s45, 9
    s_add_u32 s42, s42, s45
    s_add_u32 s42, s42, s15
    v_mov_b32 v21, 0xffff0000
    v_mov_b32 v22, 0xbfb8aa3b
    v_mov_b32 v24, 1.0
    v_cvt_pk_bf16_f32 v68, v160, v161
    v_cvt_pk_bf16_f32 v74, v162, v163
    v_cvt_pk_bf16_f32 v80, v164, v165
    v_cvt_pk_bf16_f32 v86, v166, v167
    v_cvt_pk_bf16_f32 v69, v208, v209
    v_cvt_pk_bf16_f32 v75, v210, v211
    v_cvt_pk_bf16_f32 v81, v212, v213
    v_cvt_pk_bf16_f32 v87, v214, v215
    v_lshlrev_b32 v64, 16, v68
    v_lshlrev_b32 v70, 16, v74
    v_lshlrev_b32 v76, 16, v80
    v_lshlrev_b32 v82, 16, v86
    v_and_b32 v65, v21, v68
    v_and_b32 v71, v21, v74
    v_and_b32 v77, v21, v80
    v_and_b32 v83, v21, v86
    v_pk_mul_f32 v[66:67], v[64:65], v[22:23] op_sel_hi:[1,0]
    v_pk_mul_f32 v[72:73], v[70:71], v[22:23] op_sel_hi:[1,0]
    v_pk_mul_f32 v[78:79], v[76:77], v[22:23] op_sel_hi:[1,0]
    v_pk_mul_f32 v[84:85], v[82:83], v[22:23] op_sel_hi:[1,0]
    v_exp_f32 v66, v66
    v_exp_f32 v72, v72
    v_exp_f32 v78, v78
    v_exp_f32 v84, v84
    v_exp_f32 v67, v67
    v_exp_f32 v73, v73
    v_exp_f32 v79, v79
    v_exp_f32 v85, v85
    v_pk_add_f32 v[66:67], v[66:67], v[24:25] op_sel_hi:[1,0]
    v_pk_add_f32 v[72:73], v[72:73], v[24:25] op_sel_hi:[1,0]
    v_pk_add_f32 v[78:79], v[78:79], v[24:25] op_sel_hi:[1,0]
    v_pk_add_f32 v[84:85], v[84:85], v[24:25] op_sel_hi:[1,0]
    v_rcp_f32 v66, v66
    v_rcp_f32 v72, v72
    v_rcp_f32 v78, v78
    v_rcp_f32 v84, v84
    v_rcp_f32 v67, v67
    v_rcp_f32 v73, v73
    v_rcp_f32 v79, v79
    v_rcp_f32 v85, v85
    v_pk_mul_f32 v[64:65], v[64:65], v[66:67]
    v_pk_mul_f32 v[70:71], v[70:71], v[72:73]
    v_pk_mul_f32 v[76:77], v[76:77], v[78:79]
    v_pk_mul_f32 v[82:83], v[82:83], v[84:85]
    v_cvt_pk_bf16_f32 v68, v64, v65
    v_cvt_pk_bf16_f32 v74, v70, v71
    v_cvt_pk_bf16_f32 v80, v76, v77
    v_cvt_pk_bf16_f32 v86, v82, v83
    v_lshlrev_b32 v66, 16, v69
    v_lshlrev_b32 v72, 16, v75
    v_lshlrev_b32 v78, 16, v81
    v_lshlrev_b32 v84, 16, v87
    v_and_b32 v67, v21, v69
    v_and_b32 v73, v21, v75
    v_and_b32 v79, v21, v81
    v_and_b32 v85, v21, v87
    v_lshlrev_b32 v64, 16, v68
    v_lshlrev_b32 v70, 16, v74
    v_lshlrev_b32 v76, 16, v80
    v_lshlrev_b32 v82, 16, v86
    v_and_b32 v65, v21, v68
    v_and_b32 v71, v21, v74
    v_and_b32 v77, v21, v80
    v_and_b32 v83, v21, v86
    v_pk_mul_f32 v[64:65], v[64:65], v[66:67]
    v_pk_mul_f32 v[70:71], v[70:71], v[72:73]
    v_pk_mul_f32 v[76:77], v[76:77], v[78:79]
    v_pk_mul_f32 v[82:83], v[82:83], v[84:85]
    v_cvt_pk_bf16_f32 v128, v64, v65
    v_cvt_pk_bf16_f32 v129, v70, v71
    v_cvt_pk_bf16_f32 v130, v76, v77
    v_cvt_pk_bf16_f32 v131, v82, v83
    s_nop 0
    v_permlane16_swap_b32 v128, v130
    v_permlane16_swap_b32 v129, v131
    buffer_store_dwordx4 v[128:131], v20, s[24:27], s40 offen offset:0 sc1
    v_cvt_pk_bf16_f32 v92, v176, v177
    v_cvt_pk_bf16_f32 v98, v178, v179
    v_cvt_pk_bf16_f32 v104, v180, v181
    v_cvt_pk_bf16_f32 v110, v182, v183
    v_cvt_pk_bf16_f32 v93, v224, v225
    v_cvt_pk_bf16_f32 v99, v226, v227
    v_cvt_pk_bf16_f32 v105, v228, v229
    v_cvt_pk_bf16_f32 v111, v230, v231
    v_lshlrev_b32 v88, 16, v92
    v_lshlrev_b32 v94, 16, v98
    v_lshlrev_b32 v100, 16, v104
    v_lshlrev_b32 v106, 16, v110
    v_and_b32 v89, v21, v92
    v_and_b32 v95, v21, v98
    v_and_b32 v101, v21, v104
    v_and_b32 v107, v21, v110
    v_pk_mul_f32 v[90:91], v[88:89], v[22:23] op_sel_hi:[1,0]
    v_pk_mul_f32 v[96:97], v[94:95], v[22:23] op_sel_hi:[1,0]
    v_pk_mul_f32 v[102:103], v[100:101], v[22:23] op_sel_hi:[1,0]
    v_pk_mul_f32 v[108:109], v[106:107], v[22:23] op_sel_hi:[1,0]
    v_exp_f32 v90, v90
    v_exp_f32 v96, v96
    v_exp_f32 v102, v102
    v_exp_f32 v108, v108
    v_exp_f32 v91, v91
    v_exp_f32 v97, v97
    v_exp_f32 v103, v103
    v_exp_f32 v109, v109
    v_pk_add_f32 v[90:91], v[90:91], v[24:25] op_sel_hi:[1,0]
    v_pk_add_f32 v[96:97], v[96:97], v[24:25] op_sel_hi:[1,0]
    v_pk_add_f32 v[102:103], v[102:103], v[24:25] op_sel_hi:[1,0]
    v_pk_add_f32 v[108:109], v[108:109], v[24:25] op_sel_hi:[1,0]
    v_rcp_f32 v90, v90
    v_rcp_f32 v96, v96
    v_rcp_f32 v102, v102
    v_rcp_f32 v108, v108
    v_rcp_f32 v91, v91
    v_rcp_f32 v97, v97
    v_rcp_f32 v103, v103
    v_rcp_f32 v109, v109
    v_pk_mul_f32 v[88:89], v[88:89], v[90:91]
    v_pk_mul_f32 v[94:95], v[94:95], v[96:97]
    v_pk_mul_f32 v[100:101], v[100:101], v[102:103]
    v_pk_mul_f32 v[106:107], v[106:107], v[108:109]
    v_cvt_pk_bf16_f32 v92, v88, v89
    v_cvt_pk_bf16_f32 v98, v94, v95
    v_cvt_pk_bf16_f32 v104, v100, v101
    v_cvt_pk_bf16_f32 v110, v106, v107
    v_lshlrev_b32 v90, 16, v93
    v_lshlrev_b32 v96, 16, v99
    v_lshlrev_b32 v102, 16, v105
    v_lshlrev_b32 v108, 16, v111
    v_and_b32 v91, v21, v93
    v_and_b32 v97, v21, v99
    v_and_b32 v103, v21, v105
    v_and_b32 v109, v21, v111
    v_lshlrev_b32 v88, 16, v92
    v_lshlrev_b32 v94, 16, v98
    v_lshlrev_b32 v100, 16, v104
    v_lshlrev_b32 v106, 16, v110
    v_and_b32 v89, v21, v92
    v_and_b32 v95, v21, v98
    v_and_b32 v101, v21, v104
    v_and_b32 v107, v21, v110
    v_pk_mul_f32 v[88:89], v[88:89], v[90:91]
    v_pk_mul_f32 v[94:95], v[94:95], v[96:97]
    v_pk_mul_f32 v[100:101], v[100:101], v[102:103]
    v_pk_mul_f32 v[106:107], v[106:107], v[108:109]
    v_cvt_pk_bf16_f32 v132, v88, v89
    v_cvt_pk_bf16_f32 v133, v94, v95
    v_cvt_pk_bf16_f32 v134, v100, v101
    v_cvt_pk_bf16_f32 v135, v106, v107
    s_nop 0
    v_permlane16_swap_b32 v132, v134
    v_permlane16_swap_b32 v133, v135
    buffer_store_dwordx4 v[132:135], v20, s[24:27], s41 offen offset:0 sc1
    v_cvt_pk_bf16_f32 v68, v192, v193
    v_cvt_pk_bf16_f32 v74, v194, v195
    v_cvt_pk_bf16_f32 v80, v196, v197
    v_cvt_pk_bf16_f32 v86, v198, v199
    v_cvt_pk_bf16_f32 v69, v240, v241
    v_cvt_pk_bf16_f32 v75, v242, v243
    v_cvt_pk_bf16_f32 v81, v244, v245
    v_cvt_pk_bf16_f32 v87, v246, v247
    v_lshlrev_b32 v64, 16, v68
    v_lshlrev_b32 v70, 16, v74
    v_lshlrev_b32 v76, 16, v80
    v_lshlrev_b32 v82, 16, v86
    v_and_b32 v65, v21, v68
    v_and_b32 v71, v21, v74
    v_and_b32 v77, v21, v80
    v_and_b32 v83, v21, v86
    v_pk_mul_f32 v[66:67], v[64:65], v[22:23] op_sel_hi:[1,0]
    v_pk_mul_f32 v[72:73], v[70:71], v[22:23] op_sel_hi:[1,0]
    v_pk_mul_f32 v[78:79], v[76:77], v[22:23] op_sel_hi:[1,0]
    v_pk_mul_f32 v[84:85], v[82:83], v[22:23] op_sel_hi:[1,0]
    v_exp_f32 v66, v66
    v_exp_f32 v72, v72
    v_exp_f32 v78, v78
    v_exp_f32 v84, v84
    v_exp_f32 v67, v67
    v_exp_f32 v73, v73
    v_exp_f32 v79, v79
    v_exp_f32 v85, v85
    v_pk_add_f32 v[66:67], v[66:67], v[24:25] op_sel_hi:[1,0]
    v_pk_add_f32 v[72:73], v[72:73], v[24:25] op_sel_hi:[1,0]
    v_pk_add_f32 v[78:79], v[78:79], v[24:25] op_sel_hi:[1,0]
    v_pk_add_f32 v[84:85], v[84:85], v[24:25] op_sel_hi:[1,0]
    v_rcp_f32 v66, v66
    v_rcp_f32 v72, v72
    v_rcp_f32 v78, v78
    v_rcp_f32 v84, v84
    v_rcp_f32 v67, v67
    v_rcp_f32 v73, v73
    v_rcp_f32 v79, v79
    v_rcp_f32 v85, v85
    v_pk_mul_f32 v[64:65], v[64:65], v[66:67]
    v_pk_mul_f32 v[70:71], v[70:71], v[72:73]
    v_pk_mul_f32 v[76:77], v[76:77], v[78:79]
    v_pk_mul_f32 v[82:83], v[82:83], v[84:85]
    v_cvt_pk_bf16_f32 v68, v64, v65
    v_cvt_pk_bf16_f32 v74, v70, v71
    v_cvt_pk_bf16_f32 v80, v76, v77
    v_cvt_pk_bf16_f32 v86, v82, v83
    v_lshlrev_b32 v66, 16, v69
    v_lshlrev_b32 v72, 16, v75
    v_lshlrev_b32 v78, 16, v81
    v_lshlrev_b32 v84, 16, v87
    v_and_b32 v67, v21, v69
    v_and_b32 v73, v21, v75
    v_and_b32 v79, v21, v81
    v_and_b32 v85, v21, v87
    v_lshlrev_b32 v64, 16, v68
    v_lshlrev_b32 v70, 16, v74
    v_lshlrev_b32 v76, 16, v80
    v_lshlrev_b32 v82, 16, v86
    v_and_b32 v65, v21, v68
    v_and_b32 v71, v21, v74
    v_and_b32 v77, v21, v80
    v_and_b32 v83, v21, v86
    v_pk_mul_f32 v[64:65], v[64:65], v[66:67]
    v_pk_mul_f32 v[70:71], v[70:71], v[72:73]
    v_pk_mul_f32 v[76:77], v[76:77], v[78:79]
    v_pk_mul_f32 v[82:83], v[82:83], v[84:85]
    v_cvt_pk_bf16_f32 v136, v64, v65
    v_cvt_pk_bf16_f32 v137, v70, v71
    v_cvt_pk_bf16_f32 v138, v76, v77
    v_cvt_pk_bf16_f32 v139, v82, v83
    s_nop 0
    v_permlane16_swap_b32 v136, v138
    v_permlane16_swap_b32 v137, v139
    buffer_store_dwordx4 v[136:139], v20, s[24:27], s42 offen offset:0 sc1
    v_cvt_pk_bf16_f32 v92, v168, v169
    v_cvt_pk_bf16_f32 v98, v170, v171
    v_cvt_pk_bf16_f32 v104, v172, v173
    v_cvt_pk_bf16_f32 v110, v174, v175
    v_cvt_pk_bf16_f32 v93, v216, v217
    v_cvt_pk_bf16_f32 v99, v218, v219
    v_cvt_pk_bf16_f32 v105, v220, v221
    v_cvt_pk_bf16_f32 v111, v222, v223
    v_lshlrev_b32 v88, 16, v92
    v_lshlrev_b32 v94, 16, v98
    v_lshlrev_b32 v100, 16, v104
    v_lshlrev_b32 v106, 16, v110
    v_and_b32 v89, v21, v92
    v_and_b32 v95, v21, v98
    v_and_b32 v101, v21, v104
    v_and_b32 v107, v21, v110
    v_pk_mul_f32 v[90:91], v[88:89], v[22:23] op_sel_hi:[1,0]
    v_pk_mul_f32 v[96:97], v[94:95], v[22:23] op_sel_hi:[1,0]
    v_pk_mul_f32 v[102:103], v[100:101], v[22:23] op_sel_hi:[1,0]
    v_pk_mul_f32 v[108:109], v[106:107], v[22:23] op_sel_hi:[1,0]
    v_exp_f32 v90, v90
    v_exp_f32 v96, v96
    v_exp_f32 v102, v102
    v_exp_f32 v108, v108
    v_exp_f32 v91, v91
    v_exp_f32 v97, v97
    v_exp_f32 v103, v103
    v_exp_f32 v109, v109
    v_pk_add_f32 v[90:91], v[90:91], v[24:25] op_sel_hi:[1,0]
    v_pk_add_f32 v[96:97], v[96:97], v[24:25] op_sel_hi:[1,0]
    v_pk_add_f32 v[102:103], v[102:103], v[24:25] op_sel_hi:[1,0]
    v_pk_add_f32 v[108:109], v[108:109], v[24:25] op_sel_hi:[1,0]
    v_rcp_f32 v90, v90
    v_rcp_f32 v96, v96
    v_rcp_f32 v102, v102
    v_rcp_f32 v108, v108
    v_rcp_f32 v91, v91
    v_rcp_f32 v97, v97
    v_rcp_f32 v103, v103
    v_rcp_f32 v109, v109
    v_pk_mul_f32 v[88:89], v[88:89], v[90:91]
    v_pk_mul_f32 v[94:95], v[94:95], v[96:97]
    v_pk_mul_f32 v[100:101], v[100:101], v[102:103]
    v_pk_mul_f32 v[106:107], v[106:107], v[108:109]
    v_cvt_pk_bf16_f32 v92, v88, v89
    v_cvt_pk_bf16_f32 v98, v94, v95
    v_cvt_pk_bf16_f32 v104, v100, v101
    v_cvt_pk_bf16_f32 v110, v106, v107
    v_lshlrev_b32 v90, 16, v93
    v_lshlrev_b32 v96, 16, v99
    v_lshlrev_b32 v102, 16, v105
    v_lshlrev_b32 v108, 16, v111
    v_and_b32 v91, v21, v93
    v_and_b32 v97, v21, v99
    v_and_b32 v103, v21, v105
    v_and_b32 v109, v21, v111
    v_lshlrev_b32 v88, 16, v92
    v_lshlrev_b32 v94, 16, v98
    v_lshlrev_b32 v100, 16, v104
    v_lshlrev_b32 v106, 16, v110
    v_and_b32 v89, v21, v92
    v_and_b32 v95, v21, v98
    v_and_b32 v101, v21, v104
    v_and_b32 v107, v21, v110
    v_pk_mul_f32 v[88:89], v[88:89], v[90:91]
    v_pk_mul_f32 v[94:95], v[94:95], v[96:97]
    v_pk_mul_f32 v[100:101], v[100:101], v[102:103]
    v_pk_mul_f32 v[106:107], v[106:107], v[108:109]
    v_cvt_pk_bf16_f32 v140, v88, v89
    v_cvt_pk_bf16_f32 v141, v94, v95
    v_cvt_pk_bf16_f32 v142, v100, v101
    v_cvt_pk_bf16_f32 v143, v106, v107
    s_nop 0
    v_permlane16_swap_b32 v140, v142
    v_permlane16_swap_b32 v141, v143
    buffer_store_dwordx4 v[140:143], v20, s[24:27], s40 offen offset:2048 sc1
    v_cvt_pk_bf16_f32 v68, v184, v185
    v_cvt_pk_bf16_f32 v74, v186, v187
    v_cvt_pk_bf16_f32 v80, v188, v189
    v_cvt_pk_bf16_f32 v86, v190, v191
    v_cvt_pk_bf16_f32 v69, v232, v233
    v_cvt_pk_bf16_f32 v75, v234, v235
    v_cvt_pk_bf16_f32 v81, v236, v237
    v_cvt_pk_bf16_f32 v87, v238, v239
    v_lshlrev_b32 v64, 16, v68
    v_lshlrev_b32 v70, 16, v74
    v_lshlrev_b32 v76, 16, v80
    v_lshlrev_b32 v82, 16, v86
    v_and_b32 v65, v21, v68
    v_and_b32 v71, v21, v74
    v_and_b32 v77, v21, v80
    v_and_b32 v83, v21, v86
    v_pk_mul_f32 v[66:67], v[64:65], v[22:23] op_sel_hi:[1,0]
    v_pk_mul_f32 v[72:73], v[70:71], v[22:23] op_sel_hi:[1,0]
    v_pk_mul_f32 v[78:79], v[76:77], v[22:23] op_sel_hi:[1,0]
    v_pk_mul_f32 v[84:85], v[82:83], v[22:23] op_sel_hi:[1,0]
    v_exp_f32 v66, v66
    v_exp_f32 v72, v72
    v_exp_f32 v78, v78
    v_exp_f32 v84, v84
    v_exp_f32 v67, v67
    v_exp_f32 v73, v73
    v_exp_f32 v79, v79
    v_exp_f32 v85, v85
    v_pk_add_f32 v[66:67], v[66:67], v[24:25] op_sel_hi:[1,0]
    v_pk_add_f32 v[72:73], v[72:73], v[24:25] op_sel_hi:[1,0]
    v_pk_add_f32 v[78:79], v[78:79], v[24:25] op_sel_hi:[1,0]
    v_pk_add_f32 v[84:85], v[84:85], v[24:25] op_sel_hi:[1,0]
    v_rcp_f32 v66, v66
    v_rcp_f32 v72, v72
    v_rcp_f32 v78, v78
    v_rcp_f32 v84, v84
    v_rcp_f32 v67, v67
    v_rcp_f32 v73, v73
    v_rcp_f32 v79, v79
    v_rcp_f32 v85, v85
    v_pk_mul_f32 v[64:65], v[64:65], v[66:67]
    v_pk_mul_f32 v[70:71], v[70:71], v[72:73]
    v_pk_mul_f32 v[76:77], v[76:77], v[78:79]
    v_pk_mul_f32 v[82:83], v[82:83], v[84:85]
    v_cvt_pk_bf16_f32 v68, v64, v65
    v_cvt_pk_bf16_f32 v74, v70, v71
    v_cvt_pk_bf16_f32 v80, v76, v77
    v_cvt_pk_bf16_f32 v86, v82, v83
    v_lshlrev_b32 v66, 16, v69
    v_lshlrev_b32 v72, 16, v75
    v_lshlrev_b32 v78, 16, v81
    v_lshlrev_b32 v84, 16, v87
    v_and_b32 v67, v21, v69
    v_and_b32 v73, v21, v75
    v_and_b32 v79, v21, v81
    v_and_b32 v85, v21, v87
    v_lshlrev_b32 v64, 16, v68
    v_lshlrev_b32 v70, 16, v74
    v_lshlrev_b32 v76, 16, v80
    v_lshlrev_b32 v82, 16, v86
    v_and_b32 v65, v21, v68
    v_and_b32 v71, v21, v74
    v_and_b32 v77, v21, v80
    v_and_b32 v83, v21, v86
    v_pk_mul_f32 v[64:65], v[64:65], v[66:67]
    v_pk_mul_f32 v[70:71], v[70:71], v[72:73]
    v_pk_mul_f32 v[76:77], v[76:77], v[78:79]
    v_pk_mul_f32 v[82:83], v[82:83], v[84:85]
    v_cvt_pk_bf16_f32 v128, v64, v65
    v_cvt_pk_bf16_f32 v129, v70, v71
    v_cvt_pk_bf16_f32 v130, v76, v77
    v_cvt_pk_bf16_f32 v131, v82, v83
    s_nop 0
    v_permlane16_swap_b32 v128, v130
    v_permlane16_swap_b32 v129, v131
    buffer_store_dwordx4 v[128:131], v20, s[24:27], s41 offen offset:2048 sc1
    v_cvt_pk_bf16_f32 v92, v200, v201
    v_cvt_pk_bf16_f32 v98, v202, v203
    v_cvt_pk_bf16_f32 v104, v204, v205
    v_cvt_pk_bf16_f32 v110, v206, v207
    v_cvt_pk_bf16_f32 v93, v248, v249
    v_cvt_pk_bf16_f32 v99, v250, v251
    v_cvt_pk_bf16_f32 v105, v252, v253
    v_cvt_pk_bf16_f32 v111, v254, v255
    v_lshlrev_b32 v88, 16, v92
    v_lshlrev_b32 v94, 16, v98
    v_lshlrev_b32 v100, 16, v104
    v_lshlrev_b32 v106, 16, v110
    v_and_b32 v89, v21, v92
    v_and_b32 v95, v21, v98
    v_and_b32 v101, v21, v104
    v_and_b32 v107, v21, v110
    v_pk_mul_f32 v[90:91], v[88:89], v[22:23] op_sel_hi:[1,0]
    v_pk_mul_f32 v[96:97], v[94:95], v[22:23] op_sel_hi:[1,0]
    v_pk_mul_f32 v[102:103], v[100:101], v[22:23] op_sel_hi:[1,0]
    v_pk_mul_f32 v[108:109], v[106:107], v[22:23] op_sel_hi:[1,0]
    v_exp_f32 v90, v90
    v_exp_f32 v96, v96
    v_exp_f32 v102, v102
    v_exp_f32 v108, v108
    v_exp_f32 v91, v91
    v_exp_f32 v97, v97
    v_exp_f32 v103, v103
    v_exp_f32 v109, v109
    v_pk_add_f32 v[90:91], v[90:91], v[24:25] op_sel_hi:[1,0]
    v_pk_add_f32 v[96:97], v[96:97], v[24:25] op_sel_hi:[1,0]
    v_pk_add_f32 v[102:103], v[102:103], v[24:25] op_sel_hi:[1,0]
    v_pk_add_f32 v[108:109], v[108:109], v[24:25] op_sel_hi:[1,0]
    v_rcp_f32 v90, v90
    v_rcp_f32 v96, v96
    v_rcp_f32 v102, v102
    v_rcp_f32 v108, v108
    v_rcp_f32 v91, v91
    v_rcp_f32 v97, v97
    v_rcp_f32 v103, v103
    v_rcp_f32 v109, v109
    v_pk_mul_f32 v[88:89], v[88:89], v[90:91]
    v_pk_mul_f32 v[94:95], v[94:95], v[96:97]
    v_pk_mul_f32 v[100:101], v[100:101], v[102:103]
    v_pk_mul_f32 v[106:107], v[106:107], v[108:109]
    v_cvt_pk_bf16_f32 v92, v88, v89
    v_cvt_pk_bf16_f32 v98, v94, v95
    v_cvt_pk_bf16_f32 v104, v100, v101
    v_cvt_pk_bf16_f32 v110, v106, v107
    v_lshlrev_b32 v90, 16, v93
    v_lshlrev_b32 v96, 16, v99
    v_lshlrev_b32 v102, 16, v105
    v_lshlrev_b32 v108, 16, v111
    v_and_b32 v91, v21, v93
    v_and_b32 v97, v21, v99
    v_and_b32 v103, v21, v105
    v_and_b32 v109, v21, v111
    v_lshlrev_b32 v88, 16, v92
    v_lshlrev_b32 v94, 16, v98
    v_lshlrev_b32 v100, 16, v104
    v_lshlrev_b32 v106, 16, v110
    v_and_b32 v89, v21, v92
    v_and_b32 v95, v21, v98
    v_and_b32 v101, v21, v104
    v_and_b32 v107, v21, v110
    v_pk_mul_f32 v[88:89], v[88:89], v[90:91]
    v_pk_mul_f32 v[94:95], v[94:95], v[96:97]
    v_pk_mul_f32 v[100:101], v[100:101], v[102:103]
    v_pk_mul_f32 v[106:107], v[106:107], v[108:109]
    v_cvt_pk_bf16_f32 v132, v88, v89
    v_cvt_pk_bf16_f32 v133, v94, v95
    v_cvt_pk_bf16_f32 v134, v100, v101
    v_cvt_pk_bf16_f32 v135, v106, v107
    s_nop 0
    v_permlane16_swap_b32 v132, v134
    v_permlane16_swap_b32 v133, v135
    buffer_store_dwordx4 v[132:135], v20, s[24:27], s42 offen offset:2048 sc1
    s_waitcnt vmcnt(0)
    s_endpgm
K2_FFT:
    s_nop 3
    s_sub_u32 s34, s2, 257
    s_cmp_eq_u32 s2, 256
    s_cselect_b32 s37, 1, 0
    v_lshlrev_b32 v8, 4, v1
    v_and_b32 v6, 31, v1
    v_lshrrev_b32 v7, 5, v1
    s_lshl_b32 s39, s14, 12
    s_bfe_u32 s35, s34, 0x50003
    s_bfe_u32 s45, s34, 0x20001
    s_mul_i32 s45, s45, 5
    s_and_b32 s44, s34, 1
    s_sub_u32 s41, 3, s44
    s_mul_i32 s44, s44, 3
    s_add_u32 s45, s45, s44
    s_and_b32 s44, s34, 7
    s_mul_i32 s15, s44, 3
    s_cmp_eq_u32 s44, 6
    s_cselect_b32 s44, 2, 3
    s_cmp_eq_u32 s35, 31
    s_cselect_b32 s45, s15, s45
    s_cselect_b32 s41, s44, s41
    s_add_u32 s36, s45, s14
    s_mul_i32 s15, s35, 20
    s_add_u32 s15, s15, s36
    s_lshl_b32 s15, s15, 12
    s_add_u32 s44, s39, 2621440
    s_cmp_eq_u32 s37, 1
    s_cselect_b32 s15, s44, s15
    s_mov_b32 m0, s39
    s_waitcnt lgkmcnt(0)
    s_add_u32 s16, s12, 4194304
    s_addc_u32 s17, s13, 0
    s_mov_b32 s18, 2629632
    s_mov_b32 s19, 0x00020000
    s_cmp_eq_u32 s37, 0
    s_cbranch_scc1 K2_FGO
    s_cmp_ge_u32 s14, 2
    s_cbranch_scc1 K2_END
    s_mov_b32 s41, 2
K2_FGO:
    s_nop 0
    s_cmp_ge_u32 s14, s41
    s_cbranch_scc1 K2_NOT
    buffer_load_dwordx4 v8, s[16:19], s15 offen offset:0 lds
    buffer_load_dwordx4 v8, s[16:19], s15 offen offset:1024 lds
    buffer_load_dwordx4 v8, s[16:19], s15 offen offset:2048 lds
    buffer_load_dwordx4 v8, s[16:19], s15 offen offset:3072 lds
K2_NOT:
    s_getpc_b64 s[32:33]
    s_add_u32 s32, s32, TBL_E64@rel32@lo+4
    s_addc_u32 s33, s33, TBL_E64@rel32@hi+12
    s_mov_b32 s24, s4
    s_mov_b32 s25, s5
    s_mov_b32 s26, 1314816
    s_mov_b32 s27, 0x00020000
    s_mov_b32 s28, s6
    s_mov_b32 s29, s7
    s_mov_b32 s30, 1314816
    s_mov_b32 s31, 0x00020000
    v_add_u32 v2, s39, v8
    s_add_u32 m0, s39, 49152
    s_nop 0
    global_load_lds_dwordx4 v2, s[32:33] offset:0
    global_load_lds_dwordx4 v2, s[32:33] offset:1024
    global_load_lds_dwordx4 v2, s[32:33] offset:2048
    global_load_lds_dwordx4 v2, s[32:33] offset:3072
    s_cmp_eq_u32 s37, 1
    s_cbranch_scc1 K2_SPEC_LOAD
    v_lshrrev_b32 v2, 3, v1
    v_mul_u32_u24 v2, 20544, v2
    v_and_b32 v3, 7, v1
    v_lshl_add_u32 v2, v3, 4, v2
    s_lshl_b32 s15, s14, 9
    s_add_u32 s15, s15, s35
    s_mul_i32 s15, s15, 642
    s_lshl_b32 s44, s45, 5
    s_add_u32 s15, s15, s44
    s_add_u32 s44, s15, 163328
    s_lshl_b32 s38, s14, 11
    s_add_u32 m0, s38, 16384
    s_nop 0
    buffer_load_dwordx4 v2, s[24:27], s15 offen lds
    buffer_load_dwordx4 v2, s[24:27], s44 offen offset:1024 lds
    s_add_u32 m0, s38, 24576
    s_nop 0
    buffer_load_dwordx4 v2, s[28:31], s15 offen lds
    buffer_load_dwordx4 v2, s[28:31], s44 offen offset:1024 lds
    s_cmp_lt_u32 s14, s41
    s_cbranch_scc1 K2_HASTASK
    s_waitcnt vmcnt(0)
    s_barrier
    s_endpgm
K2_HASTASK:
    s_nop 1
    s_add_u32 s20, s12, 8388608
    s_addc_u32 s21, s13, 0
    s_mov_b32 s22, 2621440
    s_mov_b32 s23, 0x00020000
    v_mov_b32 v14, s35
    v_and_b32 v3, 30, v6
    v_lshl_add_u32 v3, v7, 9, v3
    s_lshl_b32 s44, s14, 5
    s_add_u32 s44, s44, 16384
    v_add_u32 v9, s44, v3
    s_bfe_u32 s44, s35, 0x10002
    s_lshl_b32 s44, s44, 5
    v_lshlrev_b32 v2, 1, v6
    v_xor_b32 v2, s44, v2
    v_lshl_add_u32 v2, v7, 8, v2
    v_add_u32 v15, s39, v2
    v_lshrrev_b32 v2, 3, v1
    v_mul_u32_u24 v2, 81920, v2
    v_bfe_u32 v3, v1, 2, 1
    v_mul_u32_u24 v3, 10240, v3
    v_and_b32 v4, 3, v1
    v_lshlrev_b32 v4, 4, v4
    v_add3_u32 v10, v2, v3, v4
    s_mul_hi_u32 s15, s36, 0x33333334
    s_mul_i32 s44, s15, 5
    s_sub_u32 s44, s36, s44
    s_mul_i32 s15, s15, 20480
    s_lshl_b32 s44, s44, 6
    s_add_u32 s15, s15, s44
    s_mul_i32 s44, s35, 320
    s_add_u32 s40, s15, s44
    s_branch K2_LOADED
K2_SPEC_LOAD:
    s_nop 3
    v_add_u32 v2, 8192, v2
    s_add_u32 m0, s39, 57344
    s_nop 0
    global_load_lds_dwordx4 v2, s[32:33] offset:0
    global_load_lds_dwordx4 v2, s[32:33] offset:1024
    global_load_lds_dwordx4 v2, s[32:33] offset:2048
    global_load_lds_dwordx4 v2, s[32:33] offset:3072
    s_add_u32 s20, s12, 11534336
    s_addc_u32 s21, s13, 0
    s_mov_b32 s22, 8192
    s_mov_b32 s23, 0x00020000
    s_lshl_b32 s44, s14, 4
    v_lshrrev_b32 v14, 1, v6
    v_add_u32 v14, s44, v14
    v_lshlrev_b32 v2, 1, v6
    v_lshl_add_u32 v2, v7, 9, v2
    s_lshl_b32 s44, s14, 6
    v_add_u32 v10, s44, v2
    v_and_b32 v3, 1, v6
    v_lshlrev_b32 v2, 7, v7
    v_add_u32 v2, v14, v2
    v_lshlrev_b32 v9, 3, v2
    v_lshl_add_u32 v9, v3, 2, v9
    v_mov_b32 v15, 0
K2_LOADED:
    s_nop 3
    v_and_b32 v2, 1, v1
    v_mov_b32 v3, 0x80008000
    v_mul_lo_u32 v12, v2, v3
    v_xor_b32 v13, v12, v3
    s_cmp_eq_u32 s37, 1
    s_cbranch_scc1 K2_SPEC_PF
    v_pk_mov_b32 v[192:193], 0, 0
    v_pk_mov_b32 v[194:195], 0, 0
    v_pk_mov_b32 v[196:197], 0, 0
    v_pk_mov_b32 v[198:199], 0, 0
    v_pk_mov_b32 v[200:201], 0, 0
    v_pk_mov_b32 v[202:203], 0, 0
    v_pk_mov_b32 v[204:205], 0, 0
    v_pk_mov_b32 v[206:207], 0, 0
    v_pk_mov_b32 v[208:209], 0, 0
    v_pk_mov_b32 v[210:211], 0, 0
    v_pk_mov_b32 v[212:213], 0, 0
    v_pk_mov_b32 v[214:215], 0, 0
    v_pk_mov_b32 v[216:217], 0, 0
    v_pk_mov_b32 v[218:219], 0, 0
    v_pk_mov_b32 v[220:221], 0, 0
    v_pk_mov_b32 v[222:223], 0, 0
    v_pk_mov_b32 v[224:225], 0, 0
    v_pk_mov_b32 v[226:227], 0, 0
    v_pk_mov_b32 v[228:229], 0, 0
    v_pk_mov_b32 v[230:231], 0, 0
    v_pk_mov_b32 v[232:233], 0, 0
    v_pk_mov_b32 v[234:235], 0, 0
    v_pk_mov_b32 v[236:237], 0, 0
    v_pk_mov_b32 v[238:239], 0, 0
    v_pk_mov_b32 v[240:241], 0, 0
    v_pk_mov_b32 v[242:243], 0, 0
    v_pk_mov_b32 v[244:245], 0, 0
    v_pk_mov_b32 v[246:247], 0, 0
    v_pk_mov_b32 v[248:249], 0, 0
    v_pk_mov_b32 v[250:251], 0, 0
    v_pk_mov_b32 v[252:253], 0, 0
    v_pk_mov_b32 v[254:255], 0, 0
    s_branch K2_PFDONE
K2_SPEC_PF:
    s_nop 1
    s_add_u32 s24, s12, 22020096
    s_addc_u32 s25, s13, 0
    s_mov_b32 s26, 65536
    s_mov_b32 s27, 0x00020000
    s_lshl_b32 s38, s14, 15
    buffer_load_dwordx4 v[192:195], v8, s[24:27], s38 offen
    s_add_u32 s38, s38, 1024
    buffer_load_dwordx4 v[196:199], v8, s[24:27], s38 offen
    s_add_u32 s38, s38, 1024
    buffer_load_dwordx4 v[200:203], v8, s[24:27], s38 offen
    s_add_u32 s38, s38, 1024
    buffer_load_dwordx4 v[204:207], v8, s[24:27], s38 offen
    s_add_u32 s38, s38, 1024
    buffer_load_dwordx4 v[208:211], v8, s[24:27], s38 offen
    s_add_u32 s38, s38, 1024
    buffer_load_dwordx4 v[212:215], v8, s[24:27], s38 offen
    s_add_u32 s38, s38, 1024
    buffer_load_dwordx4 v[216:219], v8, s[24:27], s38 offen
    s_add_u32 s38, s38, 1024
    buffer_load_dwordx4 v[220:223], v8, s[24:27], s38 offen
    s_add_u32 s38, s38, 1024
    buffer_load_dwordx4 v[224:227], v8, s[24:27], s38 offen
    s_add_u32 s38, s38, 1024
    buffer_load_dwordx4 v[228:231], v8, s[24:27], s38 offen
    s_add_u32 s38, s38, 1024
    buffer_load_dwordx4 v[232:235], v8, s[24:27], s38 offen
    s_add_u32 s38, s38, 1024
    buffer_load_dwordx4 v[236:239], v8, s[24:27], s38 offen
    s_add_u32 s38, s38, 1024
    buffer_load_dwordx4 v[240:243], v8, s[24:27], s38 offen
    s_add_u32 s38, s38, 1024
    buffer_load_dwordx4 v[244:247], v8, s[24:27], s38 offen
    s_add_u32 s38, s38, 1024
    buffer_load_dwordx4 v[248:251], v8, s[24:27], s38 offen
    s_add_u32 s38, s38, 1024
    buffer_load_dwordx4 v[252:255], v8, s[24:27], s38 offen
    s_add_u32 s38, s38, 1024
    s_mul_i32 s40, s14, 57344
    s_add_u32 s40, s40, 8192
    s_mov_b32 s44, s40
    s_mov_b32 m0, s44
    s_nop 0
    buffer_load_dwordx4 v8, s[24:27], s38 offen offset:0 lds
    buffer_load_dwordx4 v8, s[24:27], s38 offen offset:1024 lds
    buffer_load_dwordx4 v8, s[24:27], s38 offen offset:2048 lds
    buffer_load_dwordx4 v8, s[24:27], s38 offen offset:3072 lds
    s_add_u32 s38, s38, 4096
    s_add_u32 s44, s44, 4096
    s_mov_b32 m0, s44
    s_nop 0
    buffer_load_dwordx4 v8, s[24:27], s38 offen offset:0 lds
    buffer_load_dwordx4 v8, s[24:27], s38 offen offset:1024 lds
    buffer_load_dwordx4 v8, s[24:27], s38 offen offset:2048 lds
    buffer_load_dwordx4 v8, s[24:27], s38 offen offset:3072 lds
    s_add_u32 s38, s38, 4096
    s_add_u32 s44, s44, 4096
    s_mov_b32 m0, s44
    s_nop 0
    buffer_load_dwordx4 v8, s[24:27], s38 offen offset:0 lds
    buffer_load_dwordx4 v8, s[24:27], s38 offen offset:1024 lds
    buffer_load_dwordx4 v8, s[24:27], s38 offen offset:2048 lds
    buffer_load_dwordx4 v8, s[24:27], s38 offen offset:3072 lds
    s_add_u32 s38, s38, 4096
    s_add_u32 s44, s44, 4096
    s_mov_b32 m0, s44
    s_nop 0
    buffer_load_dwordx4 v8, s[24:27], s38 offen offset:0 lds
    buffer_load_dwordx4 v8, s[24:27], s38 offen offset:1024 lds
    buffer_load_dwordx4 v8, s[24:27], s38 offen offset:2048 lds
    buffer_load_dwordx4 v8, s[24:27], s38 offen offset:3072 lds
    s_add_u32 s38, s38, 4096
    s_add_u32 s44, s44, 4096
    s_waitcnt vmcnt(32)
K2_PFDONE:
    s_nop 1
    v_bfe_u32 v2, v1, 2, 2
    v_lshl_add_u32 v2, v7, 2, v2
    v_lshlrev_b32 v2, 6, v2
    v_bfe_u32 v3, v1, 4, 1
    v_lshl_add_u32 v2, v3, 5, v2
    v_and_b32 v3, 3, v1
    v_lshl_add_u32 v2, v3, 3, v2
    v_add_u32 v11, s39, v2
    s_cmp_eq_u32 s37, 1
    s_cbranch_scc1 K2_TOK
    s_waitcnt vmcnt(0)
K2_TOK:
    ds_read_b64_tr_b16 v[32:33], v11 offset:0
    ds_read_b64_tr_b16 v[34:35], v11 offset:512
    ds_read_b64_tr_b16 v[36:37], v11 offset:1024
    ds_read_b64_tr_b16 v[38:39], v11 offset:1536
    ds_read_b64_tr_b16 v[40:41], v11 offset:2048
    ds_read_b64_tr_b16 v[42:43], v11 offset:2560
    ds_read_b64_tr_b16 v[44:45], v11 offset:3072
    ds_read_b64_tr_b16 v[46:47], v11 offset:3584
    s_waitcnt lgkmcnt(0)
    v_xor_b32_dpp v48, v32, v12 quad_perm:[1,0,3,2] row_mask:0xf bank_mask:0xf
    v_xor_b32_dpp v49, v33, v12 quad_perm:[1,0,3,2] row_mask:0xf bank_mask:0xf
    v_xor_b32_dpp v50, v34, v12 quad_perm:[1,0,3,2] row_mask:0xf bank_mask:0xf
    v_xor_b32_dpp v51, v35, v12 quad_perm:[1,0,3,2] row_mask:0xf bank_mask:0xf
    v_xor_b32_dpp v52, v36, v12 quad_perm:[1,0,3,2] row_mask:0xf bank_mask:0xf
    v_xor_b32_dpp v53, v37, v12 quad_perm:[1,0,3,2] row_mask:0xf bank_mask:0xf
    v_xor_b32_dpp v54, v38, v12 quad_perm:[1,0,3,2] row_mask:0xf bank_mask:0xf
    v_xor_b32_dpp v55, v39, v12 quad_perm:[1,0,3,2] row_mask:0xf bank_mask:0xf
    v_xor_b32_dpp v56, v40, v12 quad_perm:[1,0,3,2] row_mask:0xf bank_mask:0xf
    v_xor_b32_dpp v57, v41, v12 quad_perm:[1,0,3,2] row_mask:0xf bank_mask:0xf
    v_xor_b32_dpp v58, v42, v12 quad_perm:[1,0,3,2] row_mask:0xf bank_mask:0xf
    v_xor_b32_dpp v59, v43, v12 quad_perm:[1,0,3,2] row_mask:0xf bank_mask:0xf
    v_xor_b32_dpp v60, v44, v12 quad_perm:[1,0,3,2] row_mask:0xf bank_mask:0xf
    v_xor_b32_dpp v61, v45, v12 quad_perm:[1,0,3,2] row_mask:0xf bank_mask:0xf
    v_xor_b32_dpp v62, v46, v12 quad_perm:[1,0,3,2] row_mask:0xf bank_mask:0xf
    v_xor_b32_dpp v63, v47, v12 quad_perm:[1,0,3,2] row_mask:0xf bank_mask:0xf
    s_barrier
    ds_read_b128 v[128:131], v8 offset:49152
    ds_read_b128 v[132:135], v8 offset:50176
    ds_read_b128 v[136:139], v8 offset:51200
    ds_read_b128 v[140:143], v8 offset:52224
    ds_read_b128 v[144:147], v8 offset:53248
    ds_read_b128 v[148:151], v8 offset:54272
    ds_read_b128 v[152:155], v8 offset:55296
    ds_read_b128 v[156:159], v8 offset:56320
    s_waitcnt lgkmcnt(0)
    ds_read_b128 v[160:163], v8 offset:57344
    ds_read_b128 v[164:167], v8 offset:58368
    ds_read_b128 v[168:171], v8 offset:59392
    ds_read_b128 v[172:175], v8 offset:60416
    ds_read_b128 v[176:179], v8 offset:61440
    ds_read_b128 v[180:183], v8 offset:62464
    ds_read_b128 v[184:187], v8 offset:63488
    ds_read_b128 v[188:191], v8 offset:64512
    s_waitcnt lgkmcnt(0)
    s_cmp_eq_u32 s37, 1
    s_cbranch_scc1 K2_NOWRD
    ds_read_u16_d16_hi v192, v9 offset:0
    ds_read_u16_d16_hi v224, v9 offset:8192
    ds_read_u16_d16_hi v193, v9 offset:128
    ds_read_u16_d16_hi v225, v9 offset:8320
    ds_read_u16_d16_hi v194, v9 offset:256
    ds_read_u16_d16_hi v226, v9 offset:8448
    ds_read_u16_d16_hi v195, v9 offset:384
    ds_read_u16_d16_hi v227, v9 offset:8576
    ds_read_u16_d16_hi v196, v9 offset:1024
    ds_read_u16_d16_hi v228, v9 offset:9216
    ds_read_u16_d16_hi v197, v9 offset:1152
    ds_read_u16_d16_hi v229, v9 offset:9344
    s_waitcnt lgkmcnt(4)
    ds_read_u16_d16_hi v198, v9 offset:1280
    ds_read_u16_d16_hi v230, v9 offset:9472
    ds_read_u16_d16_hi v199, v9 offset:1408
    ds_read_u16_d16_hi v231, v9 offset:9600
    ds_read_u16_d16_hi v200, v9 offset:2048
    ds_read_u16_d16_hi v232, v9 offset:10240
    ds_read_u16_d16_hi v201, v9 offset:2176
    ds_read_u16_d16_hi v233, v9 offset:10368
    ds_read_u16_d16_hi v202, v9 offset:2304
    ds_read_u16_d16_hi v234, v9 offset:10496
    ds_read_u16_d16_hi v203, v9 offset:2432
    ds_read_u16_d16_hi v235, v9 offset:10624
    s_waitcnt lgkmcnt(4)
    ds_read_u16_d16_hi v204, v9 offset:3072
    ds_read_u16_d16_hi v236, v9 offset:11264
    ds_read_u16_d16_hi v205, v9 offset:3200
    ds_read_u16_d16_hi v237, v9 offset:11392
    ds_read_u16_d16_hi v206, v9 offset:3328
    ds_read_u16_d16_hi v238, v9 offset:11520
    ds_read_u16_d16_hi v207, v9 offset:3456
    ds_read_u16_d16_hi v239, v9 offset:11648
    ds_read_u16_d16_hi v208, v9 offset:4096
    ds_read_u16_d16_hi v240, v9 offset:12288
    ds_read_u16_d16_hi v209, v9 offset:4224
    ds_read_u16_d16_hi v241, v9 offset:12416
    s_waitcnt lgkmcnt(4)
    ds_read_u16_d16_hi v210, v9 offset:4352
    ds_read_u16_d16_hi v242, v9 offset:12544
    ds_read_u16_d16_hi v211, v9 offset:4480
    ds_read_u16_d16_hi v243, v9 offset:12672
    ds_read_u16_d16_hi v212, v9 offset:5120
    ds_read_u16_d16_hi v244, v9 offset:13312
    ds_read_u16_d16_hi v213, v9 offset:5248
    ds_read_u16_d16_hi v245, v9 offset:13440
    ds_read_u16_d16_hi v214, v9 offset:5376
    ds_read_u16_d16_hi v246, v9 offset:13568
    ds_read_u16_d16_hi v215, v9 offset:5504
    ds_read_u16_d16_hi v247, v9 offset:13696
    s_waitcnt lgkmcnt(4)
    ds_read_u16_d16_hi v216, v9 offset:6144
    ds_read_u16_d16_hi v248, v9 offset:14336
    ds_read_u16_d16_hi v217, v9 offset:6272
    ds_read_u16_d16_hi v249, v9 offset:14464
    ds_read_u16_d16_hi v218, v9 offset:6400
    ds_read_u16_d16_hi v250, v9 offset:14592
    ds_read_u16_d16_hi v219, v9 offset:6528
    ds_read_u16_d16_hi v251, v9 offset:14720
    ds_read_u16_d16_hi v220, v9 offset:7168
    ds_read_u16_d16_hi v252, v9 offset:15360
    ds_read_u16_d16_hi v221, v9 offset:7296
    ds_read_u16_d16_hi v253, v9 offset:15488
    s_waitcnt lgkmcnt(4)
    ds_read_u16_d16_hi v222, v9 offset:7424
    ds_read_u16_d16_hi v254, v9 offset:15616
    ds_read_u16_d16_hi v223, v9 offset:7552
    ds_read_u16_d16_hi v255, v9 offset:15744
K2_NOWRD:
    v_mfma_f32_32x32x16_bf16 v[64:79], v[128:131], v[32:35], 0
    v_mfma_f32_32x32x16_bf16 v[80:95], v[144:147], v[32:35], 0
    v_mfma_f32_32x32x16_bf16 v[64:79], v[132:135], v[36:39], v[64:79]
    v_mfma_f32_32x32x16_bf16 v[80:95], v[148:151], v[36:39], v[80:95]
    v_mfma_f32_32x32x16_bf16 v[64:79], v[136:139], v[40:43], v[64:79]
    v_mfma_f32_32x32x16_bf16 v[80:95], v[152:155], v[40:43], v[80:95]
    v_mfma_f32_32x32x16_bf16 v[64:79], v[140:143], v[44:47], v[64:79]
    v_mfma_f32_32x32x16_bf16 v[80:95], v[156:159], v[44:47], v[80:95]
    v_mfma_f32_32x32x16_bf16 v[64:79], v[160:163], v[48:51], v[64:79]
    v_mfma_f32_32x32x16_bf16 v[80:95], v[176:179], v[48:51], v[80:95]
    v_mfma_f32_32x32x16_bf16 v[64:79], v[164:167], v[52:55], v[64:79]
    v_mfma_f32_32x32x16_bf16 v[80:95], v[180:183], v[52:55], v[80:95]
    v_mfma_f32_32x32x16_bf16 v[64:79], v[168:171], v[56:59], v[64:79]
    v_mfma_f32_32x32x16_bf16 v[80:95], v[184:187], v[56:59], v[80:95]
    v_mfma_f32_32x32x16_bf16 v[64:79], v[172:175], v[60:63], v[64:79]
    v_mfma_f32_32x32x16_bf16 v[80:95], v[188:191], v[60:63], v[80:95]
    s_cmp_eq_u32 s37, 1
    s_cbranch_scc1 K2_SPEC_MUL
    v_and_b32 v16, 0x80000000, v13
    s_waitcnt lgkmcnt(0)
    v_xor_b32 v224, v224, v16
    v_xor_b32 v225, v225, v16
    v_xor_b32 v226, v226, v16
    v_xor_b32 v227, v227, v16
    v_xor_b32 v228, v228, v16
    v_xor_b32 v229, v229, v16
    v_xor_b32 v230, v230, v16
    v_xor_b32 v231, v231, v16
    v_xor_b32 v232, v232, v16
    v_xor_b32 v233, v233, v16
    v_xor_b32 v234, v234, v16
    v_xor_b32 v235, v235, v16
    v_xor_b32 v236, v236, v16
    v_xor_b32 v237, v237, v16
    v_xor_b32 v238, v238, v16
    v_xor_b32 v239, v239, v16
    v_xor_b32 v240, v240, v16
    v_xor_b32 v241, v241, v16
    v_xor_b32 v242, v242, v16
    v_xor_b32 v243, v243, v16
    v_xor_b32 v244, v244, v16
    v_xor_b32 v245, v245, v16
    v_xor_b32 v246, v246, v16
    v_xor_b32 v247, v247, v16
    v_xor_b32 v248, v248, v16
    v_xor_b32 v249, v249, v16
    v_xor_b32 v250, v250, v16
    v_xor_b32 v251, v251, v16
    v_xor_b32 v252, v252, v16
    v_xor_b32 v253, v253, v16
    v_xor_b32 v254, v254, v16
    v_xor_b32 v255, v255, v16
    v_mul_f32 v96, v64, v192
    v_mul_f32 v97, v65, v193
    v_mul_f32 v98, v66, v194
    v_mul_f32 v99, v67, v195
    v_mul_f32 v100, v68, v196
    v_mul_f32 v101, v69, v197
    v_mul_f32 v102, v70, v198
    v_mul_f32 v103, v71, v199
    v_mul_f32 v104, v72, v200
    v_mul_f32 v105, v73, v201
    v_mul_f32 v106, v74, v202
    v_mul_f32 v107, v75, v203
    v_mul_f32 v108, v76, v204
    v_mul_f32 v109, v77, v205
    v_mul_f32 v110, v78, v206
    v_mul_f32 v111, v79, v207
    v_mul_f32 v112, v80, v208
    v_mul_f32 v113, v81, v209
    v_mul_f32 v114, v82, v210
    v_mul_f32 v115, v83, v211
    v_mul_f32 v116, v84, v212
    v_mul_f32 v117, v85, v213
    v_mul_f32 v118, v86, v214
    v_mul_f32 v119, v87, v215
    v_mul_f32 v120, v88, v216
    v_mul_f32 v121, v89, v217
    v_mul_f32 v122, v90, v218
    v_mul_f32 v123, v91, v219
    v_mul_f32 v124, v92, v220
    v_mul_f32 v125, v93, v221
    v_mul_f32 v126, v94, v222
    v_mul_f32 v127, v95, v223
    v_fmac_f32_dpp v96, v64, v224 quad_perm:[1,0,3,2] row_mask:0xf bank_mask:0xf
    v_fmac_f32_dpp v97, v65, v225 quad_perm:[1,0,3,2] row_mask:0xf bank_mask:0xf
    v_fmac_f32_dpp v98, v66, v226 quad_perm:[1,0,3,2] row_mask:0xf bank_mask:0xf
    v_fmac_f32_dpp v99, v67, v227 quad_perm:[1,0,3,2] row_mask:0xf bank_mask:0xf
    v_fmac_f32_dpp v100, v68, v228 quad_perm:[1,0,3,2] row_mask:0xf bank_mask:0xf
    v_fmac_f32_dpp v101, v69, v229 quad_perm:[1,0,3,2] row_mask:0xf bank_mask:0xf
    v_fmac_f32_dpp v102, v70, v230 quad_perm:[1,0,3,2] row_mask:0xf bank_mask:0xf
    v_fmac_f32_dpp v103, v71, v231 quad_perm:[1,0,3,2] row_mask:0xf bank_mask:0xf
    v_fmac_f32_dpp v104, v72, v232 quad_perm:[1,0,3,2] row_mask:0xf bank_mask:0xf
    v_fmac_f32_dpp v105, v73, v233 quad_perm:[1,0,3,2] row_mask:0xf bank_mask:0xf
    v_fmac_f32_dpp v106, v74, v234 quad_perm:[1,0,3,2] row_mask:0xf bank_mask:0xf
    v_fmac_f32_dpp v107, v75, v235 quad_perm:[1,0,3,2] row_mask:0xf bank_mask:0xf
    v_fmac_f32_dpp v108, v76, v236 quad_perm:[1,0,3,2] row_mask:0xf bank_mask:0xf
    v_fmac_f32_dpp v109, v77, v237 quad_perm:[1,0,3,2] row_mask:0xf bank_mask:0xf
    v_fmac_f32_dpp v110, v78, v238 quad_perm:[1,0,3,2] row_mask:0xf bank_mask:0xf
    v_fmac_f32_dpp v111, v79, v239 quad_perm:[1,0,3,2] row_mask:0xf bank_mask:0xf
    v_fmac_f32_dpp v112, v80, v240 quad_perm:[1,0,3,2] row_mask:0xf bank_mask:0xf
    v_fmac_f32_dpp v113, v81, v241 quad_perm:[1,0,3,2] row_mask:0xf bank_mask:0xf
    v_fmac_f32_dpp v114, v82, v242 quad_perm:[1,0,3,2] row_mask:0xf bank_mask:0xf
    v_fmac_f32_dpp v115, v83, v243 quad_perm:[1,0,3,2] row_mask:0xf bank_mask:0xf
    v_fmac_f32_dpp v116, v84, v244 quad_perm:[1,0,3,2] row_mask:0xf bank_mask:0xf
    v_fmac_f32_dpp v117, v85, v245 quad_perm:[1,0,3,2] row_mask:0xf bank_mask:0xf
    v_fmac_f32_dpp v118, v86, v246 quad_perm:[1,0,3,2] row_mask:0xf bank_mask:0xf
    v_fmac_f32_dpp v119, v87, v247 quad_perm:[1,0,3,2] row_mask:0xf bank_mask:0xf
    v_fmac_f32_dpp v120, v88, v248 quad_perm:[1,0,3,2] row_mask:0xf bank_mask:0xf
    v_fmac_f32_dpp v121, v89, v249 quad_perm:[1,0,3,2] row_mask:0xf bank_mask:0xf
    v_fmac_f32_dpp v122, v90, v250 quad_perm:[1,0,3,2] row_mask:0xf bank_mask:0xf
    v_fmac_f32_dpp v123, v91, v251 quad_perm:[1,0,3,2] row_mask:0xf bank_mask:0xf
    v_fmac_f32_dpp v124, v92, v252 quad_perm:[1,0,3,2] row_mask:0xf bank_mask:0xf
    v_fmac_f32_dpp v125, v93, v253 quad_perm:[1,0,3,2] row_mask:0xf bank_mask:0xf
    v_fmac_f32_dpp v126, v94, v254 quad_perm:[1,0,3,2] row_mask:0xf bank_mask:0xf
    v_fmac_f32_dpp v127, v95, v255 quad_perm:[1,0,3,2] row_mask:0xf bank_mask:0xf
    s_branch K2_MULDONE
K2_SPEC_MUL:
    s_nop 11
    ds_write_b32 v9, v64 offset:32768
    ds_write_b32 v9, v65 offset:33024
    ds_write_b32 v9, v66 offset:33280
    ds_write_b32 v9, v67 offset:33536
    ds_write_b32 v9, v68 offset:34816
    ds_write_b32 v9, v69 offset:35072
    ds_write_b32 v9, v70 offset:35328
    ds_write_b32 v9, v71 offset:35584
    ds_write_b32 v9, v72 offset:36864
    ds_write_b32 v9, v73 offset:37120
    ds_write_b32 v9, v74 offset:37376
    ds_write_b32 v9, v75 offset:37632
    ds_write_b32 v9, v76 offset:38912
    ds_write_b32 v9, v77 offset:39168
    ds_write_b32 v9, v78 offset:39424
    ds_write_b32 v9, v79 offset:39680
    ds_write_b32 v9, v80 offset:40960
    ds_write_b32 v9, v81 offset:41216
    ds_write_b32 v9, v82 offset:41472
    ds_write_b32 v9, v83 offset:41728
    ds_write_b32 v9, v84 offset:43008
    ds_write_b32 v9, v85 offset:43264
    ds_write_b32 v9, v86 offset:43520
    ds_write_b32 v9, v87 offset:43776
    ds_write_b32 v9, v88 offset:45056
    ds_write_b32 v9, v89 offset:45312
    ds_write_b32 v9, v90 offset:45568
    ds_write_b32 v9, v91 offset:45824
    ds_write_b32 v9, v92 offset:47104
    ds_write_b32 v9, v93 offset:47360
    ds_write_b32 v9, v94 offset:47616
    ds_write_b32 v9, v95 offset:47872
    s_waitcnt lgkmcnt(0)
    s_barrier
    v_and_b32 v17, 4, v9
    v_sub_u32 v16, v9, v17
    v_add_u32 v19, s40, v8
    v_sub_u32 v18, 16384, v16
    v_and_b32 v18, 16383, v18
    v_add_u32 v18, v18, v17
    ds_read_b32 v32, v18 offset:32768
    v_sub_u32 v18, 16128, v16
    v_and_b32 v18, 16383, v18
    v_add_u32 v18, v18, v17
    ds_read_b32 v33, v18 offset:32768
    v_sub_u32 v18, 15872, v16
    v_and_b32 v18, 16383, v18
    v_add_u32 v18, v18, v17
    ds_read_b32 v34, v18 offset:32768
    v_sub_u32 v18, 15616, v16
    v_and_b32 v18, 16383, v18
    v_add_u32 v18, v18, v17
    ds_read_b32 v35, v18 offset:32768
    s_waitcnt lgkmcnt(0)
    v_sub_u32 v18, 14336, v16
    v_and_b32 v18, 16383, v18
    v_add_u32 v18, v18, v17
    ds_read_b32 v36, v18 offset:32768
    v_sub_u32 v18, 14080, v16
    v_and_b32 v18, 16383, v18
    v_add_u32 v18, v18, v17
    ds_read_b32 v37, v18 offset:32768
    v_sub_u32 v18, 13824, v16
    v_and_b32 v18, 16383, v18
    v_add_u32 v18, v18, v17
    ds_read_b32 v38, v18 offset:32768
    v_sub_u32 v18, 13568, v16
    v_and_b32 v18, 16383, v18
    v_add_u32 v18, v18, v17
    ds_read_b32 v39, v18 offset:32768
    s_waitcnt lgkmcnt(0)
    v_sub_u32 v18, 12288, v16
    v_and_b32 v18, 16383, v18
    v_add_u32 v18, v18, v17
    ds_read_b32 v40, v18 offset:32768
    v_sub_u32 v18, 12032, v16
    v_and_b32 v18, 16383, v18
    v_add_u32 v18, v18, v17
    ds_read_b32 v41, v18 offset:32768
    v_sub_u32 v18, 11776, v16
    v_and_b32 v18, 16383, v18
    v_add_u32 v18, v18, v17
    ds_read_b32 v42, v18 offset:32768
    v_sub_u32 v18, 11520, v16
    v_and_b32 v18, 16383, v18
    v_add_u32 v18, v18, v17
    ds_read_b32 v43, v18 offset:32768
    s_waitcnt lgkmcnt(0)
    v_sub_u32 v18, 10240, v16
    v_and_b32 v18, 16383, v18
    v_add_u32 v18, v18, v17
    ds_read_b32 v44, v18 offset:32768
    v_sub_u32 v18, 9984, v16
    v_and_b32 v18, 16383, v18
    v_add_u32 v18, v18, v17
    ds_read_b32 v45, v18 offset:32768
    v_sub_u32 v18, 9728, v16
    v_and_b32 v18, 16383, v18
    v_add_u32 v18, v18, v17
    ds_read_b32 v46, v18 offset:32768
    v_sub_u32 v18, 9472, v16
    v_and_b32 v18, 16383, v18
    v_add_u32 v18, v18, v17
    ds_read_b32 v47, v18 offset:32768
    s_waitcnt lgkmcnt(0)
    s_waitcnt vmcnt(0) lgkmcnt(0)
    v_mul_f32 v96, v64, v192
    s_nop 1
    v_fmac_f32_dpp v96, v64, v193 quad_perm:[1,0,3,2] row_mask:0xf bank_mask:0xf
    v_fmac_f32 v96, v32, v194
    s_nop 1
    v_fmac_f32_dpp v96, v32, v195 quad_perm:[1,0,3,2] row_mask:0xf bank_mask:0xf
    v_mul_f32 v97, v65, v196
    s_nop 1
    v_fmac_f32_dpp v97, v65, v197 quad_perm:[1,0,3,2] row_mask:0xf bank_mask:0xf
    v_fmac_f32 v97, v33, v198
    s_nop 1
    v_fmac_f32_dpp v97, v33, v199 quad_perm:[1,0,3,2] row_mask:0xf bank_mask:0xf
    v_mul_f32 v98, v66, v200
    s_nop 1
    v_fmac_f32_dpp v98, v66, v201 quad_perm:[1,0,3,2] row_mask:0xf bank_mask:0xf
    v_fmac_f32 v98, v34, v202
    s_nop 1
    v_fmac_f32_dpp v98, v34, v203 quad_perm:[1,0,3,2] row_mask:0xf bank_mask:0xf
    v_mul_f32 v99, v67, v204
    s_nop 1
    v_fmac_f32_dpp v99, v67, v205 quad_perm:[1,0,3,2] row_mask:0xf bank_mask:0xf
    v_fmac_f32 v99, v35, v206
    s_nop 1
    v_fmac_f32_dpp v99, v35, v207 quad_perm:[1,0,3,2] row_mask:0xf bank_mask:0xf
    v_mul_f32 v100, v68, v208
    s_nop 1
    v_fmac_f32_dpp v100, v68, v209 quad_perm:[1,0,3,2] row_mask:0xf bank_mask:0xf
    v_fmac_f32 v100, v36, v210
    s_nop 1
    v_fmac_f32_dpp v100, v36, v211 quad_perm:[1,0,3,2] row_mask:0xf bank_mask:0xf
    v_mul_f32 v101, v69, v212
    s_nop 1
    v_fmac_f32_dpp v101, v69, v213 quad_perm:[1,0,3,2] row_mask:0xf bank_mask:0xf
    v_fmac_f32 v101, v37, v214
    s_nop 1
    v_fmac_f32_dpp v101, v37, v215 quad_perm:[1,0,3,2] row_mask:0xf bank_mask:0xf
    v_mul_f32 v102, v70, v216
    s_nop 1
    v_fmac_f32_dpp v102, v70, v217 quad_perm:[1,0,3,2] row_mask:0xf bank_mask:0xf
    v_fmac_f32 v102, v38, v218
    s_nop 1
    v_fmac_f32_dpp v102, v38, v219 quad_perm:[1,0,3,2] row_mask:0xf bank_mask:0xf
    v_mul_f32 v103, v71, v220
    s_nop 1
    v_fmac_f32_dpp v103, v71, v221 quad_perm:[1,0,3,2] row_mask:0xf bank_mask:0xf
    v_fmac_f32 v103, v39, v222
    s_nop 1
    v_fmac_f32_dpp v103, v39, v223 quad_perm:[1,0,3,2] row_mask:0xf bank_mask:0xf
    v_mul_f32 v104, v72, v224
    s_nop 1
    v_fmac_f32_dpp v104, v72, v225 quad_perm:[1,0,3,2] row_mask:0xf bank_mask:0xf
    v_fmac_f32 v104, v40, v226
    s_nop 1
    v_fmac_f32_dpp v104, v40, v227 quad_perm:[1,0,3,2] row_mask:0xf bank_mask:0xf
    v_mul_f32 v105, v73, v228
    s_nop 1
    v_fmac_f32_dpp v105, v73, v229 quad_perm:[1,0,3,2] row_mask:0xf bank_mask:0xf
    v_fmac_f32 v105, v41, v230
    s_nop 1
    v_fmac_f32_dpp v105, v41, v231 quad_perm:[1,0,3,2] row_mask:0xf bank_mask:0xf
    v_mul_f32 v106, v74, v232
    s_nop 1
    v_fmac_f32_dpp v106, v74, v233 quad_perm:[1,0,3,2] row_mask:0xf bank_mask:0xf
    v_fmac_f32 v106, v42, v234
    s_nop 1
    v_fmac_f32_dpp v106, v42, v235 quad_perm:[1,0,3,2] row_mask:0xf bank_mask:0xf
    v_mul_f32 v107, v75, v236
    s_nop 1
    v_fmac_f32_dpp v107, v75, v237 quad_perm:[1,0,3,2] row_mask:0xf bank_mask:0xf
    v_fmac_f32 v107, v43, v238
    s_nop 1
    v_fmac_f32_dpp v107, v43, v239 quad_perm:[1,0,3,2] row_mask:0xf bank_mask:0xf
    v_mul_f32 v108, v76, v240
    s_nop 1
    v_fmac_f32_dpp v108, v76, v241 quad_perm:[1,0,3,2] row_mask:0xf bank_mask:0xf
    v_fmac_f32 v108, v44, v242
    s_nop 1
    v_fmac_f32_dpp v108, v44, v243 quad_perm:[1,0,3,2] row_mask:0xf bank_mask:0xf
    v_mul_f32 v109, v77, v244
    s_nop 1
    v_fmac_f32_dpp v109, v77, v245 quad_perm:[1,0,3,2] row_mask:0xf bank_mask:0xf
    v_fmac_f32 v109, v45, v246
    s_nop 1
    v_fmac_f32_dpp v109, v45, v247 quad_perm:[1,0,3,2] row_mask:0xf bank_mask:0xf
    v_mul_f32 v110, v78, v248
    s_nop 1
    v_fmac_f32_dpp v110, v78, v249 quad_perm:[1,0,3,2] row_mask:0xf bank_mask:0xf
    v_fmac_f32 v110, v46, v250
    s_nop 1
    v_fmac_f32_dpp v110, v46, v251 quad_perm:[1,0,3,2] row_mask:0xf bank_mask:0xf
    v_mul_f32 v111, v79, v252
    s_nop 1
    v_fmac_f32_dpp v111, v79, v253 quad_perm:[1,0,3,2] row_mask:0xf bank_mask:0xf
    v_fmac_f32 v111, v47, v254
    s_nop 1
    v_fmac_f32_dpp v111, v47, v255 quad_perm:[1,0,3,2] row_mask:0xf bank_mask:0xf
    ds_read_b128 v[192:195], v19 offset:0
    v_sub_u32 v18, 8192, v16
    v_and_b32 v18, 16383, v18
    v_add_u32 v18, v18, v17
    ds_read_b32 v32, v18 offset:32768
    ds_read_b128 v[196:199], v19 offset:1024
    v_sub_u32 v18, 7936, v16
    v_and_b32 v18, 16383, v18
    v_add_u32 v18, v18, v17
    ds_read_b32 v33, v18 offset:32768
    ds_read_b128 v[200:203], v19 offset:2048
    v_sub_u32 v18, 7680, v16
    v_and_b32 v18, 16383, v18
    v_add_u32 v18, v18, v17
    ds_read_b32 v34, v18 offset:32768
    ds_read_b128 v[204:207], v19 offset:3072
    v_sub_u32 v18, 7424, v16
    v_and_b32 v18, 16383, v18
    v_add_u32 v18, v18, v17
    ds_read_b32 v35, v18 offset:32768
    s_waitcnt lgkmcnt(0)
    ds_read_b128 v[208:211], v19 offset:4096
    v_sub_u32 v18, 6144, v16
    v_and_b32 v18, 16383, v18
    v_add_u32 v18, v18, v17
    ds_read_b32 v36, v18 offset:32768
    ds_read_b128 v[212:215], v19 offset:5120
    v_sub_u32 v18, 5888, v16
    v_and_b32 v18, 16383, v18
    v_add_u32 v18, v18, v17
    ds_read_b32 v37, v18 offset:32768
    ds_read_b128 v[216:219], v19 offset:6144
    v_sub_u32 v18, 5632, v16
    v_and_b32 v18, 16383, v18
    v_add_u32 v18, v18, v17
    ds_read_b32 v38, v18 offset:32768
    ds_read_b128 v[220:223], v19 offset:7168
    v_sub_u32 v18, 5376, v16
    v_and_b32 v18, 16383, v18
    v_add_u32 v18, v18, v17
    ds_read_b32 v39, v18 offset:32768
    s_waitcnt lgkmcnt(0)
    ds_read_b128 v[224:227], v19 offset:8192
    v_sub_u32 v18, 4096, v16
    v_and_b32 v18, 16383, v18
    v_add_u32 v18, v18, v17
    ds_read_b32 v40, v18 offset:32768
    ds_read_b128 v[228:231], v19 offset:9216
    v_sub_u32 v18, 3840, v16
    v_and_b32 v18, 16383, v18
    v_add_u32 v18, v18, v17
    ds_read_b32 v41, v18 offset:32768
    ds_read_b128 v[232:235], v19 offset:10240
    v_sub_u32 v18, 3584, v16
    v_and_b32 v18, 16383, v18
    v_add_u32 v18, v18, v17
    ds_read_b32 v42, v18 offset:32768
    ds_read_b128 v[236:239], v19 offset:11264
    v_sub_u32 v18, 3328, v16
    v_and_b32 v18, 16383, v18
    v_add_u32 v18, v18, v17
    ds_read_b32 v43, v18 offset:32768
    s_waitcnt lgkmcnt(0)
    ds_read_b128 v[240:243], v19 offset:12288
    v_sub_u32 v18, 2048, v16
    v_and_b32 v18, 16383, v18
    v_add_u32 v18, v18, v17
    ds_read_b32 v44, v18 offset:32768
    ds_read_b128 v[244:247], v19 offset:13312
    v_sub_u32 v18, 1792, v16
    v_and_b32 v18, 16383, v18
    v_add_u32 v18, v18, v17
    ds_read_b32 v45, v18 offset:32768
    ds_read_b128 v[248:251], v19 offset:14336
    v_sub_u32 v18, 1536, v16
    v_and_b32 v18, 16383, v18
    v_add_u32 v18, v18, v17
    ds_read_b32 v46, v18 offset:32768
    ds_read_b128 v[252:255], v19 offset:15360
    v_sub_u32 v18, 1280, v16
    v_and_b32 v18, 16383, v18
    v_add_u32 v18, v18, v17
    ds_read_b32 v47, v18 offset:32768
    s_waitcnt lgkmcnt(0)
    s_waitcnt vmcnt(0) lgkmcnt(0)
    v_mul_f32 v112, v80, v192
    s_nop 1
    v_fmac_f32_dpp v112, v80, v193 quad_perm:[1,0,3,2] row_mask:0xf bank_mask:0xf
    v_fmac_f32 v112, v32, v194
    s_nop 1
    v_fmac_f32_dpp v112, v32, v195 quad_perm:[1,0,3,2] row_mask:0xf bank_mask:0xf
    v_mul_f32 v113, v81, v196
    s_nop 1
    v_fmac_f32_dpp v113, v81, v197 quad_perm:[1,0,3,2] row_mask:0xf bank_mask:0xf
    v_fmac_f32 v113, v33, v198
    s_nop 1
    v_fmac_f32_dpp v113, v33, v199 quad_perm:[1,0,3,2] row_mask:0xf bank_mask:0xf
    v_mul_f32 v114, v82, v200
    s_nop 1
    v_fmac_f32_dpp v114, v82, v201 quad_perm:[1,0,3,2] row_mask:0xf bank_mask:0xf
    v_fmac_f32 v114, v34, v202
    s_nop 1
    v_fmac_f32_dpp v114, v34, v203 quad_perm:[1,0,3,2] row_mask:0xf bank_mask:0xf
    v_mul_f32 v115, v83, v204
    s_nop 1
    v_fmac_f32_dpp v115, v83, v205 quad_perm:[1,0,3,2] row_mask:0xf bank_mask:0xf
    v_fmac_f32 v115, v35, v206
    s_nop 1
    v_fmac_f32_dpp v115, v35, v207 quad_perm:[1,0,3,2] row_mask:0xf bank_mask:0xf
    v_mul_f32 v116, v84, v208
    s_nop 1
    v_fmac_f32_dpp v116, v84, v209 quad_perm:[1,0,3,2] row_mask:0xf bank_mask:0xf
    v_fmac_f32 v116, v36, v210
    s_nop 1
    v_fmac_f32_dpp v116, v36, v211 quad_perm:[1,0,3,2] row_mask:0xf bank_mask:0xf
    v_mul_f32 v117, v85, v212
    s_nop 1
    v_fmac_f32_dpp v117, v85, v213 quad_perm:[1,0,3,2] row_mask:0xf bank_mask:0xf
    v_fmac_f32 v117, v37, v214
    s_nop 1
    v_fmac_f32_dpp v117, v37, v215 quad_perm:[1,0,3,2] row_mask:0xf bank_mask:0xf
    v_mul_f32 v118, v86, v216
    s_nop 1
    v_fmac_f32_dpp v118, v86, v217 quad_perm:[1,0,3,2] row_mask:0xf bank_mask:0xf
    v_fmac_f32 v118, v38, v218
    s_nop 1
    v_fmac_f32_dpp v118, v38, v219 quad_perm:[1,0,3,2] row_mask:0xf bank_mask:0xf
    v_mul_f32 v119, v87, v220
    s_nop 1
    v_fmac_f32_dpp v119, v87, v221 quad_perm:[1,0,3,2] row_mask:0xf bank_mask:0xf
    v_fmac_f32 v119, v39, v222
    s_nop 1
    v_fmac_f32_dpp v119, v39, v223 quad_perm:[1,0,3,2] row_mask:0xf bank_mask:0xf
    v_mul_f32 v120, v88, v224
    s_nop 1
    v_fmac_f32_dpp v120, v88, v225 quad_perm:[1,0,3,2] row_mask:0xf bank_mask:0xf
    v_fmac_f32 v120, v40, v226
    s_nop 1
    v_fmac_f32_dpp v120, v40, v227 quad_perm:[1,0,3,2] row_mask:0xf bank_mask:0xf
    v_mul_f32 v121, v89, v228
    s_nop 1
    v_fmac_f32_dpp v121, v89, v229 quad_perm:[1,0,3,2] row_mask:0xf bank_mask:0xf
    v_fmac_f32 v121, v41, v230
    s_nop 1
    v_fmac_f32_dpp v121, v41, v231 quad_perm:[1,0,3,2] row_mask:0xf bank_mask:0xf
    v_mul_f32 v122, v90, v232
    s_nop 1
    v_fmac_f32_dpp v122, v90, v233 quad_perm:[1,0,3,2] row_mask:0xf bank_mask:0xf
    v_fmac_f32 v122, v42, v234
    s_nop 1
    v_fmac_f32_dpp v122, v42, v235 quad_perm:[1,0,3,2] row_mask:0xf bank_mask:0xf
    v_mul_f32 v123, v91, v236
    s_nop 1
    v_fmac_f32_dpp v123, v91, v237 quad_perm:[1,0,3,2] row_mask:0xf bank_mask:0xf
    v_fmac_f32 v123, v43, v238
    s_nop 1
    v_fmac_f32_dpp v123, v43, v239 quad_perm:[1,0,3,2] row_mask:0xf bank_mask:0xf
    v_mul_f32 v124, v92, v240
    s_nop 1
    v_fmac_f32_dpp v124, v92, v241 quad_perm:[1,0,3,2] row_mask:0xf bank_mask:0xf
    v_fmac_f32 v124, v44, v242
    s_nop 1
    v_fmac_f32_dpp v124, v44, v243 quad_perm:[1,0,3,2] row_mask:0xf bank_mask:0xf
    v_mul_f32 v125, v93, v244
    s_nop 1
    v_fmac_f32_dpp v125, v93, v245 quad_perm:[1,0,3,2] row_mask:0xf bank_mask:0xf
    v_fmac_f32 v125, v45, v246
    s_nop 1
    v_fmac_f32_dpp v125, v45, v247 quad_perm:[1,0,3,2] row_mask:0xf bank_mask:0xf
    v_mul_f32 v126, v94, v248
    s_nop 1
    v_fmac_f32_dpp v126, v94, v249 quad_perm:[1,0,3,2] row_mask:0xf bank_mask:0xf
    v_fmac_f32 v126, v46, v250
    s_nop 1
    v_fmac_f32_dpp v126, v46, v251 quad_perm:[1,0,3,2] row_mask:0xf bank_mask:0xf
    v_mul_f32 v127, v95, v252
    s_nop 1
    v_fmac_f32_dpp v127, v95, v253 quad_perm:[1,0,3,2] row_mask:0xf bank_mask:0xf
    v_fmac_f32 v127, v47, v254
    s_nop 1
    v_fmac_f32_dpp v127, v47, v255 quad_perm:[1,0,3,2] row_mask:0xf bank_mask:0xf
K2_MULDONE:
    s_nop 3
    v_cvt_pk_bf16_f32 v32, v96, v97
    v_cvt_pk_bf16_f32 v33, v98, v99
    v_cvt_pk_bf16_f32 v34, v100, v101
    v_cvt_pk_bf16_f32 v35, v102, v103
    v_cvt_pk_bf16_f32 v36, v104, v105
    v_cvt_pk_bf16_f32 v37, v106, v107
    v_cvt_pk_bf16_f32 v38, v108, v109
    v_cvt_pk_bf16_f32 v39, v110, v111
    v_cvt_pk_bf16_f32 v40, v112, v113
    v_cvt_pk_bf16_f32 v41, v114, v115
    v_cvt_pk_bf16_f32 v42, v116, v117
    v_cvt_pk_bf16_f32 v43, v118, v119
    v_cvt_pk_bf16_f32 v44, v120, v121
    v_cvt_pk_bf16_f32 v45, v122, v123
    v_cvt_pk_bf16_f32 v46, v124, v125
    v_cvt_pk_bf16_f32 v47, v126, v127
    v_xor_b32_dpp v48, v32, v13 quad_perm:[1,0,3,2] row_mask:0xf bank_mask:0xf
    v_xor_b32_dpp v49, v33, v13 quad_perm:[1,0,3,2] row_mask:0xf bank_mask:0xf
    v_xor_b32_dpp v50, v34, v13 quad_perm:[1,0,3,2] row_mask:0xf bank_mask:0xf
    v_xor_b32_dpp v51, v35, v13 quad_perm:[1,0,3,2] row_mask:0xf bank_mask:0xf
    v_xor_b32_dpp v52, v36, v13 quad_perm:[1,0,3,2] row_mask:0xf bank_mask:0xf
    v_xor_b32_dpp v53, v37, v13 quad_perm:[1,0,3,2] row_mask:0xf bank_mask:0xf
    v_xor_b32_dpp v54, v38, v13 quad_perm:[1,0,3,2] row_mask:0xf bank_mask:0xf
    v_xor_b32_dpp v55, v39, v13 quad_perm:[1,0,3,2] row_mask:0xf bank_mask:0xf
    v_xor_b32_dpp v56, v40, v13 quad_perm:[1,0,3,2] row_mask:0xf bank_mask:0xf
    v_xor_b32_dpp v57, v41, v13 quad_perm:[1,0,3,2] row_mask:0xf bank_mask:0xf
    v_xor_b32_dpp v58, v42, v13 quad_perm:[1,0,3,2] row_mask:0xf bank_mask:0xf
    v_xor_b32_dpp v59, v43, v13 quad_perm:[1,0,3,2] row_mask:0xf bank_mask:0xf
    v_xor_b32_dpp v60, v44, v13 quad_perm:[1,0,3,2] row_mask:0xf bank_mask:0xf
    v_xor_b32_dpp v61, v45, v13 quad_perm:[1,0,3,2] row_mask:0xf bank_mask:0xf
    v_xor_b32_dpp v62, v46, v13 quad_perm:[1,0,3,2] row_mask:0xf bank_mask:0xf
    v_xor_b32_dpp v63, v47, v13 quad_perm:[1,0,3,2] row_mask:0xf bank_mask:0xf
    v_mfma_f32_32x32x16_bf16 v[64:79], v[128:131], v[32:35], 0
    v_mfma_f32_32x32x16_bf16 v[80:95], v[144:147], v[32:35], 0
    v_mfma_f32_32x32x16_bf16 v[64:79], v[132:135], v[36:39], v[64:79]
    v_mfma_f32_32x32x16_bf16 v[80:95], v[148:151], v[36:39], v[80:95]
    v_mfma_f32_32x32x16_bf16 v[64:79], v[136:139], v[40:43], v[64:79]
    v_mfma_f32_32x32x16_bf16 v[80:95], v[152:155], v[40:43], v[80:95]
    v_mfma_f32_32x32x16_bf16 v[64:79], v[140:143], v[44:47], v[64:79]
    v_mfma_f32_32x32x16_bf16 v[80:95], v[156:159], v[44:47], v[80:95]
    v_mfma_f32_32x32x16_bf16 v[64:79], v[160:163], v[48:51], v[64:79]
    v_mfma_f32_32x32x16_bf16 v[80:95], v[176:179], v[48:51], v[80:95]
    v_mfma_f32_32x32x16_bf16 v[64:79], v[164:167], v[52:55], v[64:79]
    v_mfma_f32_32x32x16_bf16 v[80:95], v[180:183], v[52:55], v[80:95]
    v_mfma_f32_32x32x16_bf16 v[64:79], v[168:171], v[56:59], v[64:79]
    v_mfma_f32_32x32x16_bf16 v[80:95], v[184:187], v[56:59], v[80:95]
    v_mfma_f32_32x32x16_bf16 v[64:79], v[172:175], v[60:63], v[64:79]
    v_mfma_f32_32x32x16_bf16 v[80:95], v[188:191], v[60:63], v[80:95]
    s_nop 10
    v_cvt_pk_bf16_f32 v32, v64, v65
    v_cvt_pk_bf16_f32 v33, v66, v67
    v_cvt_pk_bf16_f32 v34, v68, v69
    v_cvt_pk_bf16_f32 v35, v70, v71
    v_cvt_pk_bf16_f32 v36, v72, v73
    v_cvt_pk_bf16_f32 v37, v74, v75
    v_cvt_pk_bf16_f32 v38, v76, v77
    v_cvt_pk_bf16_f32 v39, v78, v79
    v_cvt_pk_bf16_f32 v40, v80, v81
    v_cvt_pk_bf16_f32 v41, v82, v83
    v_cvt_pk_bf16_f32 v42, v84, v85
    v_cvt_pk_bf16_f32 v43, v86, v87
    v_cvt_pk_bf16_f32 v44, v88, v89
    v_cvt_pk_bf16_f32 v45, v90, v91
    v_cvt_pk_bf16_f32 v46, v92, v93
    v_cvt_pk_bf16_f32 v47, v94, v95
    s_cmp_eq_u32 s37, 1
    s_cbranch_scc1 K2_SPEC_STORE
    ds_write_b16 v15, v32 offset:0
    ds_write_b16_d16_hi v15, v32 offset:64
    ds_write_b16 v15, v33 offset:128
    ds_write_b16_d16_hi v15, v33 offset:192
    ds_write_b16 v15, v34 offset:512
    ds_write_b16_d16_hi v15, v34 offset:576
    ds_write_b16 v15, v35 offset:640
    ds_write_b16_d16_hi v15, v35 offset:704
    ds_write_b16 v15, v36 offset:1024
    ds_write_b16_d16_hi v15, v36 offset:1088
    ds_write_b16 v15, v37 offset:1152
    ds_write_b16_d16_hi v15, v37 offset:1216
    ds_write_b16 v15, v38 offset:1536
    ds_write_b16_d16_hi v15, v38 offset:1600
    ds_write_b16 v15, v39 offset:1664
    ds_write_b16_d16_hi v15, v39 offset:1728
    ds_write_b16 v15, v40 offset:2048
    ds_write_b16_d16_hi v15, v40 offset:2112
    ds_write_b16 v15, v41 offset:2176
    ds_write_b16_d16_hi v15, v41 offset:2240
    ds_write_b16 v15, v42 offset:2560
    ds_write_b16_d16_hi v15, v42 offset:2624
    ds_write_b16 v15, v43 offset:2688
    ds_write_b16_d16_hi v15, v43 offset:2752
    ds_write_b16 v15, v44 offset:3072
    ds_write_b16_d16_hi v15, v44 offset:3136
    ds_write_b16 v15, v45 offset:3200
    ds_write_b16_d16_hi v15, v45 offset:3264
    ds_write_b16 v15, v46 offset:3584
    ds_write_b16_d16_hi v15, v46 offset:3648
    ds_write_b16 v15, v47 offset:3712
    ds_write_b16_d16_hi v15, v47 offset:3776
    v_add_u32 v2, s39, v8
    s_waitcnt lgkmcnt(0)
    ds_read_b128 v[96:99], v2 offset:0
    ds_read_b128 v[100:103], v2 offset:1024
    ds_read_b128 v[104:107], v2 offset:2048
    ds_read_b128 v[108:111], v2 offset:3072
    s_waitcnt lgkmcnt(3)
    buffer_store_dwordx4 v[96:99], v10, s[20:23], s40 offen sc1
    s_add_u32 s40, s40, 655360
    s_waitcnt lgkmcnt(2)
    buffer_store_dwordx4 v[100:103], v10, s[20:23], s40 offen sc1
    s_add_u32 s40, s40, 655360
    s_waitcnt lgkmcnt(1)
    buffer_store_dwordx4 v[104:107], v10, s[20:23], s40 offen sc1
    s_add_u32 s40, s40, 655360
    s_waitcnt lgkmcnt(0)
    buffer_store_dwordx4 v[108:111], v10, s[20:23], s40 offen sc1
    s_branch K2_FEND
K2_SPEC_STORE:
    s_nop 1
    s_mov_b32 s38, 0
    buffer_store_short v32, v10, s[20:23], s38 offen
    s_mov_b32 s38, 128
    buffer_store_short_d16_hi v32, v10, s[20:23], s38 offen
    s_mov_b32 s38, 256
    buffer_store_short v33, v10, s[20:23], s38 offen
    s_mov_b32 s38, 384
    buffer_store_short_d16_hi v33, v10, s[20:23], s38 offen
    s_mov_b32 s38, 1024
    buffer_store_short v34, v10, s[20:23], s38 offen
    s_mov_b32 s38, 1152
    buffer_store_short_d16_hi v34, v10, s[20:23], s38 offen
    s_mov_b32 s38, 1280
    buffer_store_short v35, v10, s[20:23], s38 offen
    s_mov_b32 s38, 1408
    buffer_store_short_d16_hi v35, v10, s[20:23], s38 offen
    s_mov_b32 s38, 2048
    buffer_store_short v36, v10, s[20:23], s38 offen
    s_mov_b32 s38, 2176
    buffer_store_short_d16_hi v36, v10, s[20:23], s38 offen
    s_mov_b32 s38, 2304
    buffer_store_short v37, v10, s[20:23], s38 offen
    s_mov_b32 s38, 2432
    buffer_store_short_d16_hi v37, v10, s[20:23], s38 offen
    s_mov_b32 s38, 3072
    buffer_store_short v38, v10, s[20:23], s38 offen
    s_mov_b32 s38, 3200
    buffer_store_short_d16_hi v38, v10, s[20:23], s38 offen
    s_mov_b32 s38, 3328
    buffer_store_short v39, v10, s[20:23], s38 offen
    s_mov_b32 s38, 3456
    buffer_store_short_d16_hi v39, v10, s[20:23], s38 offen
    s_mov_b32 s38, 4096
    buffer_store_short v40, v10, s[20:23], s38 offen
    s_mov_b32 s38, 4224
    buffer_store_short_d16_hi v40, v10, s[20:23], s38 offen
    s_mov_b32 s38, 4352
    buffer_store_short v41, v10, s[20:23], s38 offen
    s_mov_b32 s38, 4480
    buffer_store_short_d16_hi v41, v10, s[20:23], s38 offen
    s_mov_b32 s38, 5120
    buffer_store_short v42, v10, s[20:23], s38 offen
    s_mov_b32 s38, 5248
    buffer_store_short_d16_hi v42, v10, s[20:23], s38 offen
    s_mov_b32 s38, 5376
    buffer_store_short v43, v10, s[20:23], s38 offen
    s_mov_b32 s38, 5504
    buffer_store_short_d16_hi v43, v10, s[20:23], s38 offen
    s_mov_b32 s38, 6144
    buffer_store_short v44, v10, s[20:23], s38 offen
    s_mov_b32 s38, 6272
    buffer_store_short_d16_hi v44, v10, s[20:23], s38 offen
    s_mov_b32 s38, 6400
    buffer_store_short v45, v10, s[20:23], s38 offen
    s_mov_b32 s38, 6528
    buffer_store_short_d16_hi v45, v10, s[20:23], s38 offen
    s_mov_b32 s38, 7168
    buffer_store_short v46, v10, s[20:23], s38 offen
    s_mov_b32 s38, 7296
    buffer_store_short_d16_hi v46, v10, s[20:23], s38 offen
    s_mov_b32 s38, 7424
    buffer_store_short v47, v10, s[20:23], s38 offen
    s_mov_b32 s38, 7552
    buffer_store_short_d16_hi v47, v10, s[20:23], s38 offen
K2_FEND:
    s_endpgm
K2_END:
    s_endpgm
.globl k3_kernel
.p2align 8
.type k3_kernel,@function
k3_kernel:
    s_cmp_ge_u32 s2, 256
    s_cbranch_scc1 K3_END
    s_setprio 3
    s_load_dwordx2 s[6:7], s[0:1], 72
    s_load_dwordx2 s[4:5], s[0:1], 0
    s_load_dwordx2 s[8:9], s[0:1], 56
    v_lshrrev_b32 v2, 6, v0
    v_and_b32 v1, 63, v0
    v_readfirstlane_b32 s12, v2
    v_lshlrev_b32 v9, 4, v1
    s_and_b32 s13, s2, 7
    s_lshr_b32 s14, s2, 3
    s_lshl_b32 s42, s13, 2
    s_and_b32 s15, s14, 3
    s_add_u32 s42, s42, s15
    s_lshr_b32 s43, s14, 2
    s_mul_i32 s44, s12, 10240
    s_mul_i32 s49, s42, 81920
    s_add_u32 s49, s49, s44
    s_mov_b32 s50, s44
    s_waitcnt lgkmcnt(0)
    s_add_u32 s28, s6, 8388608
    s_addc_u32 s29, s7, 0
    s_mov_b32 s30, 2621440
    s_mov_b32 s31, 0x00020000
    s_mov_b32 m0, s50
    s_nop 0
    buffer_load_dwordx4 v9, s[28:31], s49 offen offset:0 lds
    buffer_load_dwordx4 v9, s[28:31], s49 offen offset:1024 lds
    buffer_load_dwordx4 v9, s[28:31], s49 offen offset:2048 lds
    buffer_load_dwordx4 v9, s[28:31], s49 offen offset:3072 lds
    s_add_u32 s50, s50, 4096
    s_add_u32 s49, s49, 4096
    s_mov_b32 m0, s50
    s_nop 0
    buffer_load_dwordx4 v9, s[28:31], s49 offen offset:0 lds
    buffer_load_dwordx4 v9, s[28:31], s49 offen offset:1024 lds
    buffer_load_dwordx4 v9, s[28:31], s49 offen offset:2048 lds
    buffer_load_dwordx4 v9, s[28:31], s49 offen offset:3072 lds
    s_add_u32 s50, s50, 4096
    s_add_u32 s49, s49, 4096
    s_mov_b32 m0, s50
    s_nop 0
    buffer_load_dwordx4 v9, s[28:31], s49 offen offset:0 lds
    buffer_load_dwordx4 v9, s[28:31], s49 offen offset:1024 lds
    s_add_u32 s36, s6, 11534336
    s_addc_u32 s37, s7, 0
    s_mov_b32 s38, 8192
    s_mov_b32 s39, 0x00020000
    v_lshlrev_b32 v11, 2, v1
    s_lshl_b32 s13, s42, 8
    s_and_b32 s51, s12, 1
    s_lshl_b32 s14, s51, 7
    s_add_u32 s13, s13, s14
    buffer_load_dword v10, v11, s[36:39], s13 offen
    s_setprio 0
    s_add_u32 s32, s6, 12582912
    s_addc_u32 s33, s7, 0
    s_mov_b32 s34, 6291456
    s_mov_b32 s35, 0x00020000
    s_add_u32 s20, s6, 23068672
    s_addc_u32 s21, s7, 0
    s_mov_b32 s22, 1966080
    s_mov_b32 s23, 0x00020000
    s_cmp_ge_u32 s12, 4
    s_cselect_b64 vcc, -1, 0
    s_cmp_ge_u32 s12, 6
    s_cbranch_scc1 K3_DFT_PRE
    s_mul_i32 s13, s12, 12
    s_mul_i32 s46, s43, 48
    s_add_u32 s46, s46, s13
    s_mul_i32 s46, s46, 5120
    s_mul_i32 s47, s42, 48
    s_add_u32 s47, s47, s13
    s_lshl_b32 s47, s47, 12
    s_branch K3_I2
K3_DFT_PRE:
    s_nop 3
    s_setprio 2
    v_and_b32 v4, 15, v1
    s_mul_i32 s13, s43, 80
    v_add_u32 v4, s13, v4
    v_lshrrev_b32 v5, 4, v1
    v_lshlrev_b32 v5, 2, v5
    s_mul_i32 s13, s51, 160
    v_add_u32 v5, s13, v5
    v_mul_u32_u24 v40, v4, v5
    v_cvt_f32_u32 v2, v40
    v_mul_f32 v3, 0x3acccccd, v2
    v_floor_f32 v3, v3
    v_fmac_f32 v2, 0xc4200000, v3
    v_mul_f32 v2, 0xbacccccd, v2
    v_cos_f32 v128, v2
    v_sin_f32 v129, v2
    v_mul_f32 v128, 0x35cccccd, v128
    v_mul_f32 v129, 0x35cccccd, v129
    v_cvt_f32_u32 v2, v4
    v_mul_f32 v3, 0x3acccccd, v2
    v_floor_f32 v3, v3
    v_fmac_f32 v2, 0xc4200000, v3
    v_mul_f32 v2, 0xbacccccd, v2
    v_cos_f32 v32, v2
    v_sin_f32 v33, v2
    v_lshlrev_b32 v40, 4, v4
    v_cvt_f32_u32 v2, v40
    v_mul_f32 v3, 0x3acccccd, v2
    v_floor_f32 v3, v3
    v_fmac_f32 v2, 0xc4200000, v3
    v_mul_f32 v2, 0xbacccccd, v2
    v_cos_f32 v34, v2
    v_sin_f32 v35, v2
    v_add_f32 v26, v34, v34
    v_pk_mul_f32 v[36:37], v[128:129], v[32:33] op_sel_hi:[1,0]
    v_pk_fma_f32 v[130:131], v[128:129], v[32:33], v[36:37] op_sel:[1,1,0] op_sel_hi:[0,1,1] neg_lo:[1,0,0]
    v_pk_mul_f32 v[36:37], v[130:131], v[32:33] op_sel_hi:[1,0]
    v_pk_fma_f32 v[132:133], v[130:131], v[32:33], v[36:37] op_sel:[1,1,0] op_sel_hi:[0,1,1] neg_lo:[1,0,0]
    v_pk_mul_f32 v[36:37], v[132:133], v[32:33] op_sel_hi:[1,0]
    v_pk_fma_f32 v[134:135], v[132:133], v[32:33], v[36:37] op_sel:[1,1,0] op_sel_hi:[0,1,1] neg_lo:[1,0,0]
    v_pk_mul_f32 v[36:37], v[128:129], v[34:35] op_sel_hi:[1,0]
    v_pk_fma_f32 v[168:169], v[128:129], v[34:35], v[36:37] op_sel:[1,1,0] op_sel_hi:[0,1,1] neg_lo:[1,0,0]
    v_pk_mul_f32 v[38:39], v[130:131], v[34:35] op_sel_hi:[1,0]
    v_pk_fma_f32 v[170:171], v[130:131], v[34:35], v[38:39] op_sel:[1,1,0] op_sel_hi:[0,1,1] neg_lo:[1,0,0]
    v_pk_mul_f32 v[36:37], v[132:133], v[34:35] op_sel_hi:[1,0]
    v_pk_fma_f32 v[172:173], v[132:133], v[34:35], v[36:37] op_sel:[1,1,0] op_sel_hi:[0,1,1] neg_lo:[1,0,0]
    v_pk_mul_f32 v[38:39], v[134:135], v[34:35] op_sel_hi:[1,0]
    v_pk_fma_f32 v[174:175], v[134:135], v[34:35], v[38:39] op_sel:[1,1,0] op_sel_hi:[0,1,1] neg_lo:[1,0,0]
    v_cvt_pk_bf16_f32 v208, v128, v129
    v_cvt_pk_bf16_f32 v209, v130, v131
    v_cvt_pk_bf16_f32 v210, v132, v133
    v_cvt_pk_bf16_f32 v211, v134, v135
    v_add_u32 v4, 16, v4
    v_mul_u32_u24 v40, v4, v5
    v_cvt_f32_u32 v2, v40
    v_mul_f32 v3, 0x3acccccd, v2
    v_floor_f32 v3, v3
    v_fmac_f32 v2, 0xc4200000, v3
    v_mul_f32 v2, 0xbacccccd, v2
    v_cos_f32 v136, v2
    v_sin_f32 v137, v2
    v_mul_f32 v136, 0x35cccccd, v136
    v_mul_f32 v137, 0x35cccccd, v137
    v_cvt_f32_u32 v2, v4
    v_mul_f32 v3, 0x3acccccd, v2
    v_floor_f32 v3, v3
    v_fmac_f32 v2, 0xc4200000, v3
    v_mul_f32 v2, 0xbacccccd, v2
    v_cos_f32 v32, v2
    v_sin_f32 v33, v2
    v_lshlrev_b32 v40, 4, v4
    v_cvt_f32_u32 v2, v40
    v_mul_f32 v3, 0x3acccccd, v2
    v_floor_f32 v3, v3
    v_fmac_f32 v2, 0xc4200000, v3
    v_mul_f32 v2, 0xbacccccd, v2
    v_cos_f32 v34, v2
    v_sin_f32 v35, v2
    v_add_f32 v27, v34, v34
    v_pk_mul_f32 v[36:37], v[136:137], v[32:33] op_sel_hi:[1,0]
    v_pk_fma_f32 v[138:139], v[136:137], v[32:33], v[36:37] op_sel:[1,1,0] op_sel_hi:[0,1,1] neg_lo:[1,0,0]
    v_pk_mul_f32 v[36:37], v[138:139], v[32:33] op_sel_hi:[1,0]
    v_pk_fma_f32 v[140:141], v[138:139], v[32:33], v[36:37] op_sel:[1,1,0] op_sel_hi:[0,1,1] neg_lo:[1,0,0]
    v_pk_mul_f32 v[36:37], v[140:141], v[32:33] op_sel_hi:[1,0]
    v_pk_fma_f32 v[142:143], v[140:141], v[32:33], v[36:37] op_sel:[1,1,0] op_sel_hi:[0,1,1] neg_lo:[1,0,0]
    v_pk_mul_f32 v[36:37], v[136:137], v[34:35] op_sel_hi:[1,0]
    v_pk_fma_f32 v[176:177], v[136:137], v[34:35], v[36:37] op_sel:[1,1,0] op_sel_hi:[0,1,1] neg_lo:[1,0,0]
    v_pk_mul_f32 v[38:39], v[138:139], v[34:35] op_sel_hi:[1,0]
    v_pk_fma_f32 v[178:179], v[138:139], v[34:35], v[38:39] op_sel:[1,1,0] op_sel_hi:[0,1,1] neg_lo:[1,0,0]
    v_pk_mul_f32 v[36:37], v[140:141], v[34:35] op_sel_hi:[1,0]
    v_pk_fma_f32 v[180:181], v[140:141], v[34:35], v[36:37] op_sel:[1,1,0] op_sel_hi:[0,1,1] neg_lo:[1,0,0]
    v_pk_mul_f32 v[38:39], v[142:143], v[34:35] op_sel_hi:[1,0]
    v_pk_fma_f32 v[182:183], v[142:143], v[34:35], v[38:39] op_sel:[1,1,0] op_sel_hi:[0,1,1] neg_lo:[1,0,0]
    v_cvt_pk_bf16_f32 v212, v136, v137
    v_cvt_pk_bf16_f32 v213, v138, v139
    v_cvt_pk_bf16_f32 v214, v140, v141
    v_cvt_pk_bf16_f32 v215, v142, v143
    v_add_u32 v4, 16, v4
    v_mul_u32_u24 v40, v4, v5
    v_cvt_f32_u32 v2, v40
    v_mul_f32 v3, 0x3acccccd, v2
    v_floor_f32 v3, v3
    v_fmac_f32 v2, 0xc4200000, v3
    v_mul_f32 v2, 0xbacccccd, v2
    v_cos_f32 v144, v2
    v_sin_f32 v145, v2
    v_mul_f32 v144, 0x35cccccd, v144
    v_mul_f32 v145, 0x35cccccd, v145
    v_cvt_f32_u32 v2, v4
    v_mul_f32 v3, 0x3acccccd, v2
    v_floor_f32 v3, v3
    v_fmac_f32 v2, 0xc4200000, v3
    v_mul_f32 v2, 0xbacccccd, v2
    v_cos_f32 v32, v2
    v_sin_f32 v33, v2
    v_lshlrev_b32 v40, 4, v4
    v_cvt_f32_u32 v2, v40
    v_mul_f32 v3, 0x3acccccd, v2
    v_floor_f32 v3, v3
    v_fmac_f32 v2, 0xc4200000, v3
    v_mul_f32 v2, 0xbacccccd, v2
    v_cos_f32 v34, v2
    v_sin_f32 v35, v2
    v_add_f32 v28, v34, v34
    v_pk_mul_f32 v[36:37], v[144:145], v[32:33] op_sel_hi:[1,0]
    v_pk_fma_f32 v[146:147], v[144:145], v[32:33], v[36:37] op_sel:[1,1,0] op_sel_hi:[0,1,1] neg_lo:[1,0,0]
    v_pk_mul_f32 v[36:37], v[146:147], v[32:33] op_sel_hi:[1,0]
    v_pk_fma_f32 v[148:149], v[146:147], v[32:33], v[36:37] op_sel:[1,1,0] op_sel_hi:[0,1,1] neg_lo:[1,0,0]
    v_pk_mul_f32 v[36:37], v[148:149], v[32:33] op_sel_hi:[1,0]
    v_pk_fma_f32 v[150:151], v[148:149], v[32:33], v[36:37] op_sel:[1,1,0] op_sel_hi:[0,1,1] neg_lo:[1,0,0]
    v_pk_mul_f32 v[36:37], v[144:145], v[34:35] op_sel_hi:[1,0]
    v_pk_fma_f32 v[184:185], v[144:145], v[34:35], v[36:37] op_sel:[1,1,0] op_sel_hi:[0,1,1] neg_lo:[1,0,0]
    v_pk_mul_f32 v[38:39], v[146:147], v[34:35] op_sel_hi:[1,0]
    v_pk_fma_f32 v[186:187], v[146:147], v[34:35], v[38:39] op_sel:[1,1,0] op_sel_hi:[0,1,1] neg_lo:[1,0,0]
    v_pk_mul_f32 v[36:37], v[148:149], v[34:35] op_sel_hi:[1,0]
    v_pk_fma_f32 v[188:189], v[148:149], v[34:35], v[36:37] op_sel:[1,1,0] op_sel_hi:[0,1,1] neg_lo:[1,0,0]
    v_pk_mul_f32 v[38:39], v[150:151], v[34:35] op_sel_hi:[1,0]
    v_pk_fma_f32 v[190:191], v[150:151], v[34:35], v[38:39] op_sel:[1,1,0] op_sel_hi:[0,1,1] neg_lo:[1,0,0]
    v_cvt_pk_bf16_f32 v216, v144, v145
    v_cvt_pk_bf16_f32 v217, v146, v147
    v_cvt_pk_bf16_f32 v218, v148, v149
    v_cvt_pk_bf16_f32 v219, v150, v151
    v_add_u32 v4, 16, v4
    v_mul_u32_u24 v40, v4, v5
    v_cvt_f32_u32 v2, v40
    v_mul_f32 v3, 0x3acccccd, v2
    v_floor_f32 v3, v3
    v_fmac_f32 v2, 0xc4200000, v3
    v_mul_f32 v2, 0xbacccccd, v2
    v_cos_f32 v152, v2
    v_sin_f32 v153, v2
    v_mul_f32 v152, 0x35cccccd, v152
    v_mul_f32 v153, 0x35cccccd, v153
    v_cvt_f32_u32 v2, v4
    v_mul_f32 v3, 0x3acccccd, v2
    v_floor_f32 v3, v3
    v_fmac_f32 v2, 0xc4200000, v3
    v_mul_f32 v2, 0xbacccccd, v2
    v_cos_f32 v32, v2
    v_sin_f32 v33, v2
    v_lshlrev_b32 v40, 4, v4
    v_cvt_f32_u32 v2, v40
    v_mul_f32 v3, 0x3acccccd, v2
    v_floor_f32 v3, v3
    v_fmac_f32 v2, 0xc4200000, v3
    v_mul_f32 v2, 0xbacccccd, v2
    v_cos_f32 v34, v2
    v_sin_f32 v35, v2
    v_add_f32 v29, v34, v34
    v_pk_mul_f32 v[36:37], v[152:153], v[32:33] op_sel_hi:[1,0]
    v_pk_fma_f32 v[154:155], v[152:153], v[32:33], v[36:37] op_sel:[1,1,0] op_sel_hi:[0,1,1] neg_lo:[1,0,0]
    v_pk_mul_f32 v[36:37], v[154:155], v[32:33] op_sel_hi:[1,0]
    v_pk_fma_f32 v[156:157], v[154:155], v[32:33], v[36:37] op_sel:[1,1,0] op_sel_hi:[0,1,1] neg_lo:[1,0,0]
    v_pk_mul_f32 v[36:37], v[156:157], v[32:33] op_sel_hi:[1,0]
    v_pk_fma_f32 v[158:159], v[156:157], v[32:33], v[36:37] op_sel:[1,1,0] op_sel_hi:[0,1,1] neg_lo:[1,0,0]
    v_pk_mul_f32 v[36:37], v[152:153], v[34:35] op_sel_hi:[1,0]
    v_pk_fma_f32 v[192:193], v[152:153], v[34:35], v[36:37] op_sel:[1,1,0] op_sel_hi:[0,1,1] neg_lo:[1,0,0]
    v_pk_mul_f32 v[38:39], v[154:155], v[34:35] op_sel_hi:[1,0]
    v_pk_fma_f32 v[194:195], v[154:155], v[34:35], v[38:39] op_sel:[1,1,0] op_sel_hi:[0,1,1] neg_lo:[1,0,0]
    v_pk_mul_f32 v[36:37], v[156:157], v[34:35] op_sel_hi:[1,0]
    v_pk_fma_f32 v[196:197], v[156:157], v[34:35], v[36:37] op_sel:[1,1,0] op_sel_hi:[0,1,1] neg_lo:[1,0,0]
    v_pk_mul_f32 v[38:39], v[158:159], v[34:35] op_sel_hi:[1,0]
    v_pk_fma_f32 v[198:199], v[158:159], v[34:35], v[38:39] op_sel:[1,1,0] op_sel_hi:[0,1,1] neg_lo:[1,0,0]
    v_cvt_pk_bf16_f32 v220, v152, v153
    v_cvt_pk_bf16_f32 v221, v154, v155
    v_cvt_pk_bf16_f32 v222, v156, v157
    v_cvt_pk_bf16_f32 v223, v158, v159
    v_add_u32 v4, 16, v4
    v_mul_u32_u24 v40, v4, v5
    v_cvt_f32_u32 v2, v40
    v_mul_f32 v3, 0x3acccccd, v2
    v_floor_f32 v3, v3
    v_fmac_f32 v2, 0xc4200000, v3
    v_mul_f32 v2, 0xbacccccd, v2
    v_cos_f32 v160, v2
    v_sin_f32 v161, v2
    v_mul_f32 v160, 0x35cccccd, v160
    v_mul_f32 v161, 0x35cccccd, v161
    v_cvt_f32_u32 v2, v4
    v_mul_f32 v3, 0x3acccccd, v2
    v_floor_f32 v3, v3
    v_fmac_f32 v2, 0xc4200000, v3
    v_mul_f32 v2, 0xbacccccd, v2
    v_cos_f32 v32, v2
    v_sin_f32 v33, v2
    v_lshlrev_b32 v40, 4, v4
    v_cvt_f32_u32 v2, v40
    v_mul_f32 v3, 0x3acccccd, v2
    v_floor_f32 v3, v3
    v_fmac_f32 v2, 0xc4200000, v3
    v_mul_f32 v2, 0xbacccccd, v2
    v_cos_f32 v34, v2
    v_sin_f32 v35, v2
    v_add_f32 v30, v34, v34
    v_pk_mul_f32 v[36:37], v[160:161], v[32:33] op_sel_hi:[1,0]
    v_pk_fma_f32 v[162:163], v[160:161], v[32:33], v[36:37] op_sel:[1,1,0] op_sel_hi:[0,1,1] neg_lo:[1,0,0]
    v_pk_mul_f32 v[36:37], v[162:163], v[32:33] op_sel_hi:[1,0]
    v_pk_fma_f32 v[164:165], v[162:163], v[32:33], v[36:37] op_sel:[1,1,0] op_sel_hi:[0,1,1] neg_lo:[1,0,0]
    v_pk_mul_f32 v[36:37], v[164:165], v[32:33] op_sel_hi:[1,0]
    v_pk_fma_f32 v[166:167], v[164:165], v[32:33], v[36:37] op_sel:[1,1,0] op_sel_hi:[0,1,1] neg_lo:[1,0,0]
    v_pk_mul_f32 v[36:37], v[160:161], v[34:35] op_sel_hi:[1,0]
    v_pk_fma_f32 v[200:201], v[160:161], v[34:35], v[36:37] op_sel:[1,1,0] op_sel_hi:[0,1,1] neg_lo:[1,0,0]
    v_pk_mul_f32 v[38:39], v[162:163], v[34:35] op_sel_hi:[1,0]
    v_pk_fma_f32 v[202:203], v[162:163], v[34:35], v[38:39] op_sel:[1,1,0] op_sel_hi:[0,1,1] neg_lo:[1,0,0]
    v_pk_mul_f32 v[36:37], v[164:165], v[34:35] op_sel_hi:[1,0]
    v_pk_fma_f32 v[204:205], v[164:165], v[34:35], v[36:37] op_sel:[1,1,0] op_sel_hi:[0,1,1] neg_lo:[1,0,0]
    v_pk_mul_f32 v[38:39], v[166:167], v[34:35] op_sel_hi:[1,0]
    v_pk_fma_f32 v[206:207], v[166:167], v[34:35], v[38:39] op_sel:[1,1,0] op_sel_hi:[0,1,1] neg_lo:[1,0,0]
    v_cvt_pk_bf16_f32 v224, v160, v161
    v_cvt_pk_bf16_f32 v225, v162, v163
    v_cvt_pk_bf16_f32 v226, v164, v165
    v_cvt_pk_bf16_f32 v227, v166, v167
    s_cmp_lg_u32 s51, 0
    s_cbranch_scc1 K3_NOG0
    v_and_b32 v2, 1, v1
    v_lshlrev_b32 v2, 31, v2
    v_or_b32 v2, 0x354d354d, v2
    s_mov_b64 exec, 0xffff
    v_mov_b32 v208, v2
    v_mov_b32 v212, v2
    v_mov_b32 v216, v2
    v_mov_b32 v220, v2
    v_mov_b32 v224, v2
    s_mov_b64 exec, -1
K3_NOG0:
K3_I2:
    s_nop 3
    s_mov_b32 s16, s4
    s_mov_b32 s17, s5
    s_mov_b32 s18, 2621440
    s_mov_b32 s19, 0x00020000
    s_mov_b32 s24, s8
    s_mov_b32 s25, s9
    s_mov_b32 s26, 2621440
    s_mov_b32 s27, 0x00020000
    v_and_b32 v6, 15, v1
    v_lshrrev_b32 v7, 4, v1
    v_lshrrev_b32 v8, 2, v6
    v_sub_u32 v8, 0, v8
    v_and_b32 v8, 3, v8
    v_xor_b32 v2, v7, v8
    v_mul_u32_u24 v3, 320, v6
    v_lshl_add_u32 v12, v2, 4, v3
    s_mul_i32 s13, s51, 40960
    v_add_u32 v12, s13, v12
    v_lshrrev_b32 v2, 2, v6
    v_lshl_add_u32 v2, v7, 2, v2
    v_mul_u32_u24 v2, 320, v2
    v_and_b32 v3, 3, v6
    v_lshl_add_u32 v2, v3, 3, v2
    v_add_u32 v2, s44, v2
    v_and_b32 v3, 1, v7
    v_lshlrev_b32 v3, 5, v3
    v_add_u32 v13, v2, v3
    v_sub_u32 v14, v2, v3
    v_mul_u32_u24 v2, 320, v6
    v_and_b32 v3, 1, v7
    v_lshl_add_u32 v2, v3, 3, v2
    v_add_u32 v2, s44, v2
    v_lshrrev_b32 v3, 1, v7
    v_xor_b32 v3, v3, v8
    v_lshl_add_u32 v15, v3, 4, v2
    v_xor_b32 v3, 2, v3
    v_lshl_add_u32 v16, v3, 4, v2
    s_lshl_b32 s14, s42, 1
    s_mul_i32 s13, s43, 160
    v_add_u32 v2, 0, v0
    v_mul_u32_u24 v3, 52429, v2
    v_lshrrev_b32 v3, 20, v3
    v_mul_u32_u24 v4, 20, v3
    v_sub_u32 v2, v2, v4
    v_and_b32 v4, 31, v3
    v_lshlrev_b32 v4, 6, v4
    v_lshrrev_b32 v5, 5, v3
    v_add3_u32 v4, v4, v5, s14
    v_mul_u32_u24 v4, 1280, v4
    v_lshl_add_u32 v4, v2, 3, v4
    v_add_u32 v17, s13, v4
    v_add_u32 v2, 512, v0
    v_mul_u32_u24 v3, 52429, v2
    v_lshrrev_b32 v3, 20, v3
    v_mul_u32_u24 v4, 20, v3
    v_sub_u32 v2, v2, v4
    v_and_b32 v4, 31, v3
    v_lshlrev_b32 v4, 6, v4
    v_lshrrev_b32 v5, 5, v3
    v_add3_u32 v4, v4, v5, s14
    v_mul_u32_u24 v4, 1280, v4
    v_lshl_add_u32 v4, v2, 3, v4
    v_add_u32 v18, s13, v4
    v_add_u32 v2, 1024, v0
    v_mul_u32_u24 v3, 52429, v2
    v_lshrrev_b32 v3, 20, v3
    v_mul_u32_u24 v4, 20, v3
    v_sub_u32 v2, v2, v4
    v_and_b32 v4, 31, v3
    v_lshlrev_b32 v4, 6, v4
    v_lshrrev_b32 v5, 5, v3
    v_add3_u32 v4, v4, v5, s14
    v_mul_u32_u24 v4, 1280, v4
    v_lshl_add_u32 v4, v2, 3, v4
    v_add_u32 v19, s13, v4
    s_lshl_b32 s13, s42, 1
    s_add_u32 s13, s13, s51
    v_lshlrev_b32 v4, 6, v6
    v_add_u32 v4, s13, v4
    v_lshlrev_b32 v5, 2, v7
    v_add_u32 v88, 0, v5
    v_mul_u32_u24 v88, v88, v4
    v_and_b32 v88, 2047, v88
    v_cvt_f32_u32 v88, v88
    v_mul_f32 v88, 0x3a000000, v88
    v_cos_f32 v89, v88
    v_sin_f32 v90, v88
    v_add_u32 v92, 1, v5
    v_mul_u32_u24 v92, v92, v4
    v_and_b32 v92, 2047, v92
    v_cvt_f32_u32 v92, v92
    v_mul_f32 v92, 0x3a000000, v92
    v_cos_f32 v93, v92
    v_sin_f32 v94, v92
    v_cvt_pk_bf16_f32 v72, v89, v93
    v_cvt_pk_bf16_f32 v80, v90, v94
    v_add_u32 v88, 2, v5
    v_mul_u32_u24 v88, v88, v4
    v_and_b32 v88, 2047, v88
    v_cvt_f32_u32 v88, v88
    v_mul_f32 v88, 0x3a000000, v88
    v_cos_f32 v89, v88
    v_sin_f32 v90, v88
    v_add_u32 v92, 3, v5
    v_mul_u32_u24 v92, v92, v4
    v_and_b32 v92, 2047, v92
    v_cvt_f32_u32 v92, v92
    v_mul_f32 v92, 0x3a000000, v92
    v_cos_f32 v93, v92
    v_sin_f32 v94, v92
    v_cvt_pk_bf16_f32 v73, v89, v93
    v_cvt_pk_bf16_f32 v81, v90, v94
    v_add_u32 v88, 16, v5
    v_mul_u32_u24 v88, v88, v4
    v_and_b32 v88, 2047, v88
    v_cvt_f32_u32 v88, v88
    v_mul_f32 v88, 0x3a000000, v88
    v_cos_f32 v89, v88
    v_sin_f32 v90, v88
    v_add_u32 v92, 17, v5
    v_mul_u32_u24 v92, v92, v4
    v_and_b32 v92, 2047, v92
    v_cvt_f32_u32 v92, v92
    v_mul_f32 v92, 0x3a000000, v92
    v_cos_f32 v93, v92
    v_sin_f32 v94, v92
    v_cvt_pk_bf16_f32 v74, v89, v93
    v_cvt_pk_bf16_f32 v82, v90, v94
    v_add_u32 v88, 18, v5
    v_mul_u32_u24 v88, v88, v4
    v_and_b32 v88, 2047, v88
    v_cvt_f32_u32 v88, v88
    v_mul_f32 v88, 0x3a000000, v88
    v_cos_f32 v89, v88
    v_sin_f32 v90, v88
    v_add_u32 v92, 19, v5
    v_mul_u32_u24 v92, v92, v4
    v_and_b32 v92, 2047, v92
    v_cvt_f32_u32 v92, v92
    v_mul_f32 v92, 0x3a000000, v92
    v_cos_f32 v93, v92
    v_sin_f32 v94, v92
    v_cvt_pk_bf16_f32 v75, v89, v93
    v_cvt_pk_bf16_f32 v83, v90, v94
    v_add_u32 v4, 1024, v4
    v_add_u32 v88, 0, v5
    v_mul_u32_u24 v88, v88, v4
    v_and_b32 v88, 2047, v88
    v_cvt_f32_u32 v88, v88
    v_mul_f32 v88, 0x3a000000, v88
    v_cos_f32 v89, v88
    v_sin_f32 v90, v88
    v_add_u32 v92, 1, v5
    v_mul_u32_u24 v92, v92, v4
    v_and_b32 v92, 2047, v92
    v_cvt_f32_u32 v92, v92
    v_mul_f32 v92, 0x3a000000, v92
    v_cos_f32 v93, v92
    v_sin_f32 v94, v92
    v_cvt_pk_bf16_f32 v76, v89, v93
    v_cvt_pk_bf16_f32 v84, v90, v94
    v_add_u32 v88, 2, v5
    v_mul_u32_u24 v88, v88, v4
    v_and_b32 v88, 2047, v88
    v_cvt_f32_u32 v88, v88
    v_mul_f32 v88, 0x3a000000, v88
    v_cos_f32 v89, v88
    v_sin_f32 v90, v88
    v_add_u32 v92, 3, v5
    v_mul_u32_u24 v92, v92, v4
    v_and_b32 v92, 2047, v92
    v_cvt_f32_u32 v92, v92
    v_mul_f32 v92, 0x3a000000, v92
    v_cos_f32 v93, v92
    v_sin_f32 v94, v92
    v_cvt_pk_bf16_f32 v77, v89, v93
    v_cvt_pk_bf16_f32 v85, v90, v94
    v_add_u32 v88, 16, v5
    v_mul_u32_u24 v88, v88, v4
    v_and_b32 v88, 2047, v88
    v_cvt_f32_u32 v88, v88
    v_mul_f32 v88, 0x3a000000, v88
    v_cos_f32 v89, v88
    v_sin_f32 v90, v88
    v_add_u32 v92, 17, v5
    v_mul_u32_u24 v92, v92, v4
    v_and_b32 v92, 2047, v92
    v_cvt_f32_u32 v92, v92
    v_mul_f32 v92, 0x3a000000, v92
    v_cos_f32 v93, v92
    v_sin_f32 v94, v92
    v_cvt_pk_bf16_f32 v78, v89, v93
    v_cvt_pk_bf16_f32 v86, v90, v94
    v_add_u32 v88, 18, v5
    v_mul_u32_u24 v88, v88, v4
    v_and_b32 v88, 2047, v88
    v_cvt_f32_u32 v88, v88
    v_mul_f32 v88, 0x3a000000, v88
    v_cos_f32 v89, v88
    v_sin_f32 v90, v88
    v_add_u32 v92, 19, v5
    v_mul_u32_u24 v92, v92, v4
    v_and_b32 v92, 2047, v92
    v_cvt_f32_u32 v92, v92
    v_mul_f32 v92, 0x3a000000, v92
    v_cos_f32 v93, v92
    v_sin_f32 v94, v92
    v_cvt_pk_bf16_f32 v79, v89, v93
    v_cvt_pk_bf16_f32 v87, v90, v94
    s_cbranch_vccnz K3_WD
    s_waitcnt vmcnt(0)
    s_branch K3_WE
K3_WD:
    s_waitcnt vmcnt(0)
K3_WE:
    s_cmp_ge_u32 s12, 2
    s_cbranch_scc1 K3_NOUQ
    v_mul_u32_u24 v11, 320, v1
    v_bfe_u32 v2, v1, 2, 1
    v_lshl_add_u32 v11, v2, 5, v11
    v_add_u32 v11, s44, v11
    s_mov_b32 exec_hi, 0
    ds_write_b32 v11, v10
    s_mov_b64 exec, -1
    s_waitcnt lgkmcnt(0)
K3_NOUQ:
    ds_read_b64_tr_b16 v[32:33], v13 offset:0
    ds_read_b64_tr_b16 v[34:35], v13 offset:5120
    ds_read_b64_tr_b16 v[36:37], v14 offset:32
    ds_read_b64_tr_b16 v[38:39], v14 offset:5152
    ds_read_b64_tr_b16 v[40:41], v13 offset:64
    ds_read_b64_tr_b16 v[42:43], v13 offset:5184
    ds_read_b64_tr_b16 v[44:45], v14 offset:96
    ds_read_b64_tr_b16 v[46:47], v14 offset:5216
    ds_read_b64_tr_b16 v[48:49], v13 offset:128
    ds_read_b64_tr_b16 v[50:51], v13 offset:5248
    ds_read_b64_tr_b16 v[52:53], v14 offset:160
    ds_read_b64_tr_b16 v[54:55], v14 offset:5280
    ds_read_b64_tr_b16 v[56:57], v13 offset:192
    ds_read_b64_tr_b16 v[58:59], v13 offset:5312
    s_waitcnt lgkmcnt(6)
    ds_read_b64_tr_b16 v[60:61], v14 offset:224
    ds_read_b64_tr_b16 v[62:63], v14 offset:5344
    ds_read_b64_tr_b16 v[64:65], v13 offset:256
    ds_read_b64_tr_b16 v[66:67], v13 offset:5376
    ds_read_b64_tr_b16 v[68:69], v14 offset:288
    ds_read_b64_tr_b16 v[70:71], v14 offset:5408
    s_waitcnt lgkmcnt(0)
    v_mfma_f32_16x16x32_bf16 v[88:91], v[32:35], v[72:75], 0
    v_mfma_f32_16x16x32_bf16 v[92:95], v[32:35], v[80:83], 0
    v_mfma_f32_16x16x32_bf16 v[96:99], v[32:35], v[76:79], 0
    v_mfma_f32_16x16x32_bf16 v[100:103], v[32:35], v[84:87], 0
    v_mfma_f32_16x16x32_bf16 v[104:107], v[36:39], v[72:75], 0
    v_mfma_f32_16x16x32_bf16 v[108:111], v[36:39], v[80:83], 0
    v_mfma_f32_16x16x32_bf16 v[112:115], v[36:39], v[76:79], 0
    v_mfma_f32_16x16x32_bf16 v[116:119], v[36:39], v[84:87], 0
    s_cbranch_vccnz K3_TK0E
    buffer_load_dwordx4 v[128:131], v9, s[20:23], s46 offen offset:0
    buffer_load_dwordx4 v[132:135], v9, s[20:23], s46 offen offset:1024
    buffer_load_dwordx4 v[136:139], v9, s[20:23], s46 offen offset:2048
K3_TK0E:
    s_nop 1
    v_sub_f32 v88, v88, v93
    v_add_f32 v89, v89, v92
    v_sub_f32 v90, v90, v95
    v_add_f32 v91, v91, v94
    v_cvt_pk_bf16_f32 v120, v88, v89
    v_cvt_pk_bf16_f32 v121, v90, v91
    ds_write_b64 v15, v[120:121] offset:0
    v_sub_f32 v96, v96, v101
    v_add_f32 v97, v97, v100
    v_sub_f32 v98, v98, v103
    v_add_f32 v99, v99, v102
    v_cvt_pk_bf16_f32 v122, v96, v97
    v_cvt_pk_bf16_f32 v123, v98, v99
    ds_write_b64 v15, v[122:123] offset:5120
    v_mfma_f32_16x16x32_bf16 v[88:91], v[40:43], v[72:75], 0
    v_mfma_f32_16x16x32_bf16 v[92:95], v[40:43], v[80:83], 0
    v_mfma_f32_16x16x32_bf16 v[96:99], v[40:43], v[76:79], 0
    v_mfma_f32_16x16x32_bf16 v[100:103], v[40:43], v[84:87], 0
    s_cbranch_vccnz K3_TK1E
    buffer_load_dwordx4 v[140:143], v9, s[20:23], s46 offen offset:3072
    s_add_u32 s46, s46, 4096
    buffer_load_dwordx4 v[144:147], v9, s[20:23], s46 offen
    s_add_u32 s46, s46, 1024
    buffer_load_dwordx4 v[148:151], v9, s[32:35], s47 offen offset:0
K3_TK1E:
    s_nop 1
    v_sub_f32 v104, v104, v109
    v_add_f32 v105, v105, v108
    v_sub_f32 v106, v106, v111
    v_add_f32 v107, v107, v110
    v_cvt_pk_bf16_f32 v124, v104, v105
    v_cvt_pk_bf16_f32 v125, v106, v107
    ds_write_b64 v16, v[124:125] offset:0
    v_sub_f32 v112, v112, v117
    v_add_f32 v113, v113, v116
    v_sub_f32 v114, v114, v119
    v_add_f32 v115, v115, v118
    v_cvt_pk_bf16_f32 v126, v112, v113
    v_cvt_pk_bf16_f32 v127, v114, v115
    ds_write_b64 v16, v[126:127] offset:5120
    v_mfma_f32_16x16x32_bf16 v[104:107], v[44:47], v[72:75], 0
    v_mfma_f32_16x16x32_bf16 v[108:111], v[44:47], v[80:83], 0
    v_mfma_f32_16x16x32_bf16 v[112:115], v[44:47], v[76:79], 0
    v_mfma_f32_16x16x32_bf16 v[116:119], v[44:47], v[84:87], 0
    s_cbranch_vccnz K3_TK2E
    buffer_load_dwordx4 v[152:155], v9, s[32:35], s47 offen offset:1024
    buffer_load_dwordx4 v[156:159], v9, s[32:35], s47 offen offset:2048
    buffer_load_dwordx4 v[160:163], v9, s[32:35], s47 offen offset:3072
    s_add_u32 s47, s47, 4096
K3_TK2E:
    s_nop 1
    v_sub_f32 v88, v88, v93
    v_add_f32 v89, v89, v92
    v_sub_f32 v90, v90, v95
    v_add_f32 v91, v91, v94
    v_cvt_pk_bf16_f32 v120, v88, v89
    v_cvt_pk_bf16_f32 v121, v90, v91
    ds_write_b64 v15, v[120:121] offset:64
    v_sub_f32 v96, v96, v101
    v_add_f32 v97, v97, v100
    v_sub_f32 v98, v98, v103
    v_add_f32 v99, v99, v102
    v_cvt_pk_bf16_f32 v122, v96, v97
    v_cvt_pk_bf16_f32 v123, v98, v99
    ds_write_b64 v15, v[122:123] offset:5184
    v_mfma_f32_16x16x32_bf16 v[88:91], v[48:51], v[72:75], 0
    v_mfma_f32_16x16x32_bf16 v[92:95], v[48:51], v[80:83], 0
    v_mfma_f32_16x16x32_bf16 v[96:99], v[48:51], v[76:79], 0
    v_mfma_f32_16x16x32_bf16 v[100:103], v[48:51], v[84:87], 0
    s_cbranch_vccnz K3_TK3E
    buffer_load_dwordx4 v[164:167], v9, s[20:23], s46 offen offset:0
    buffer_load_dwordx4 v[168:171], v9, s[20:23], s46 offen offset:1024
    buffer_load_dwordx4 v[172:175], v9, s[20:23], s46 offen offset:2048
K3_TK3E:
    s_nop 1
    v_sub_f32 v104, v104, v109
    v_add_f32 v105, v105, v108
    v_sub_f32 v106, v106, v111
    v_add_f32 v107, v107, v110
    v_cvt_pk_bf16_f32 v124, v104, v105
    v_cvt_pk_bf16_f32 v125, v106, v107
    ds_write_b64 v16, v[124:125] offset:64
    v_sub_f32 v112, v112, v117
    v_add_f32 v113, v113, v116
    v_sub_f32 v114, v114, v119
    v_add_f32 v115, v115, v118
    v_cvt_pk_bf16_f32 v126, v112, v113
    v_cvt_pk_bf16_f32 v127, v114, v115
    ds_write_b64 v16, v[126:127] offset:5184
    v_mfma_f32_16x16x32_bf16 v[104:107], v[52:55], v[72:75], 0
    v_mfma_f32_16x16x32_bf16 v[108:111], v[52:55], v[80:83], 0
    v_mfma_f32_16x16x32_bf16 v[112:115], v[52:55], v[76:79], 0
    v_mfma_f32_16x16x32_bf16 v[116:119], v[52:55], v[84:87], 0
    s_cbranch_vccnz K3_TK4E
    buffer_load_dwordx4 v[176:179], v9, s[20:23], s46 offen offset:3072
    s_add_u32 s46, s46, 4096
    buffer_load_dwordx4 v[180:183], v9, s[20:23], s46 offen
    s_add_u32 s46, s46, 1024
    buffer_load_dwordx4 v[184:187], v9, s[32:35], s47 offen offset:0
K3_TK4E:
    s_nop 1
    v_sub_f32 v88, v88, v93
    v_add_f32 v89, v89, v92
    v_sub_f32 v90, v90, v95
    v_add_f32 v91, v91, v94
    v_cvt_pk_bf16_f32 v120, v88, v89
    v_cvt_pk_bf16_f32 v121, v90, v91
    ds_write_b64 v15, v[120:121] offset:128
    v_sub_f32 v96, v96, v101
    v_add_f32 v97, v97, v100
    v_sub_f32 v98, v98, v103
    v_add_f32 v99, v99, v102
    v_cvt_pk_bf16_f32 v122, v96, v97
    v_cvt_pk_bf16_f32 v123, v98, v99
    ds_write_b64 v15, v[122:123] offset:5248
    v_mfma_f32_16x16x32_bf16 v[88:91], v[56:59], v[72:75], 0
    v_mfma_f32_16x16x32_bf16 v[92:95], v[56:59], v[80:83], 0
    v_mfma_f32_16x16x32_bf16 v[96:99], v[56:59], v[76:79], 0
    v_mfma_f32_16x16x32_bf16 v[100:103], v[56:59], v[84:87], 0
    s_cbranch_vccnz K3_TK5E
    buffer_load_dwordx4 v[188:191], v9, s[32:35], s47 offen offset:1024
    buffer_load_dwordx4 v[192:195], v9, s[32:35], s47 offen offset:2048
    buffer_load_dwordx4 v[196:199], v9, s[32:35], s47 offen offset:3072
    s_add_u32 s47, s47, 4096
K3_TK5E:
    s_nop 1
    v_sub_f32 v104, v104, v109
    v_add_f32 v105, v105, v108
    v_sub_f32 v106, v106, v111
    v_add_f32 v107, v107, v110
    v_cvt_pk_bf16_f32 v124, v104, v105
    v_cvt_pk_bf16_f32 v125, v106, v107
    ds_write_b64 v16, v[124:125] offset:128
    v_sub_f32 v112, v112, v117
    v_add_f32 v113, v113, v116
    v_sub_f32 v114, v114, v119
    v_add_f32 v115, v115, v118
    v_cvt_pk_bf16_f32 v126, v112, v113
    v_cvt_pk_bf16_f32 v127, v114, v115
    ds_write_b64 v16, v[126:127] offset:5248
    v_mfma_f32_16x16x32_bf16 v[104:107], v[60:63], v[72:75], 0
    v_mfma_f32_16x16x32_bf16 v[108:111], v[60:63], v[80:83], 0
    v_mfma_f32_16x16x32_bf16 v[112:115], v[60:63], v[76:79], 0
    v_mfma_f32_16x16x32_bf16 v[116:119], v[60:63], v[84:87], 0
    s_cbranch_vccnz K3_TK6E
    buffer_load_dwordx4 v[200:203], v9, s[20:23], s46 offen offset:0
    buffer_load_dwordx4 v[204:207], v9, s[20:23], s46 offen offset:1024
    buffer_load_dwordx4 v[208:211], v9, s[20:23], s46 offen offset:2048
K3_TK6E:
    s_nop 1
    v_sub_f32 v88, v88, v93
    v_add_f32 v89, v89, v92
    v_sub_f32 v90, v90, v95
    v_add_f32 v91, v91, v94
    v_cvt_pk_bf16_f32 v120, v88, v89
    v_cvt_pk_bf16_f32 v121, v90, v91
    ds_write_b64 v15, v[120:121] offset:192
    v_sub_f32 v96, v96, v101
    v_add_f32 v97, v97, v100
    v_sub_f32 v98, v98, v103
    v_add_f32 v99, v99, v102
    v_cvt_pk_bf16_f32 v122, v96, v97
    v_cvt_pk_bf16_f32 v123, v98, v99
    ds_write_b64 v15, v[122:123] offset:5312
    v_mfma_f32_16x16x32_bf16 v[88:91], v[64:67], v[72:75], 0
    v_mfma_f32_16x16x32_bf16 v[92:95], v[64:67], v[80:83], 0
    v_mfma_f32_16x16x32_bf16 v[96:99], v[64:67], v[76:79], 0
    v_mfma_f32_16x16x32_bf16 v[100:103], v[64:67], v[84:87], 0
    s_cbranch_vccnz K3_TK7E
    buffer_load_dwordx4 v[212:215], v9, s[20:23], s46 offen offset:3072
    s_add_u32 s46, s46, 4096
    buffer_load_dwordx4 v[216:219], v9, s[20:23], s46 offen
    s_add_u32 s46, s46, 1024
    buffer_load_dwordx4 v[220:223], v9, s[32:35], s47 offen offset:0
K3_TK7E:
    s_nop 1
    v_sub_f32 v104, v104, v109
    v_add_f32 v105, v105, v108
    v_sub_f32 v106, v106, v111
    v_add_f32 v107, v107, v110
    v_cvt_pk_bf16_f32 v124, v104, v105
    v_cvt_pk_bf16_f32 v125, v106, v107
    ds_write_b64 v16, v[124:125] offset:192
    v_sub_f32 v112, v112, v117
    v_add_f32 v113, v113, v116
    v_sub_f32 v114, v114, v119
    v_add_f32 v115, v115, v118
    v_cvt_pk_bf16_f32 v126, v112, v113
    v_cvt_pk_bf16_f32 v127, v114, v115
    ds_write_b64 v16, v[126:127] offset:5312
    v_mfma_f32_16x16x32_bf16 v[104:107], v[68:71], v[72:75], 0
    v_mfma_f32_16x16x32_bf16 v[108:111], v[68:71], v[80:83], 0
    v_mfma_f32_16x16x32_bf16 v[112:115], v[68:71], v[76:79], 0
    v_mfma_f32_16x16x32_bf16 v[116:119], v[68:71], v[84:87], 0
    s_cbranch_vccnz K3_TK8E
    buffer_load_dwordx4 v[224:227], v9, s[32:35], s47 offen offset:1024
    buffer_load_dwordx4 v[228:231], v9, s[32:35], s47 offen offset:2048
    buffer_load_dwordx4 v[232:235], v9, s[32:35], s47 offen offset:3072
    s_add_u32 s47, s47, 4096
K3_TK8E:
    s_nop 1
    v_sub_f32 v88, v88, v93
    v_add_f32 v89, v89, v92
    v_sub_f32 v90, v90, v95
    v_add_f32 v91, v91, v94
    v_cvt_pk_bf16_f32 v120, v88, v89
    v_cvt_pk_bf16_f32 v121, v90, v91
    ds_write_b64 v15, v[120:121] offset:256
    v_sub_f32 v96, v96, v101
    v_add_f32 v97, v97, v100
    v_sub_f32 v98, v98, v103
    v_add_f32 v99, v99, v102
    v_cvt_pk_bf16_f32 v122, v96, v97
    v_cvt_pk_bf16_f32 v123, v98, v99
    ds_write_b64 v15, v[122:123] offset:5376
    v_sub_f32 v104, v104, v109
    v_add_f32 v105, v105, v108
    v_sub_f32 v106, v106, v111
    v_add_f32 v107, v107, v110
    v_cvt_pk_bf16_f32 v124, v104, v105
    v_cvt_pk_bf16_f32 v125, v106, v107
    ds_write_b64 v16, v[124:125] offset:256
    v_sub_f32 v112, v112, v117
    v_add_f32 v113, v113, v116
    v_sub_f32 v114, v114, v119
    v_add_f32 v115, v115, v118
    v_cvt_pk_bf16_f32 v126, v112, v113
    v_cvt_pk_bf16_f32 v127, v114, v115
    ds_write_b64 v16, v[126:127] offset:5376
    buffer_load_dwordx2 v[20:21], v17, s[16:19], 0 offen
    buffer_load_dwordx2 v[22:23], v18, s[16:19], 0 offen
    buffer_load_dwordx2 v[24:25], v19, s[16:19], 0 offen
    v_add_u32 v2, 0, v0
    v_mul_u32_u24 v3, 52429, v2
    v_lshrrev_b32 v3, 20, v3
    v_mul_u32_u24 v4, 20, v3
    v_sub_u32 v2, v2, v4
    v_lshrrev_b32 v4, 4, v3
    v_mul_u32_u24 v4, 5, v4
    v_lshrrev_b32 v5, 2, v2
    v_add_u32 v4, v4, v5
    v_lshlrev_b32 v4, 10, v4
    v_and_b32 v2, 3, v2
    v_lshl_add_u32 v4, v2, 8, v4
    v_lshl_add_u32 v5, v2, 2, v5
    v_add_u32 v5, v5, v3
    v_and_b32 v5, 15, v5
    v_lshl_add_u32 v13, v5, 4, v4
    v_add_u32 v2, 512, v0
    v_mul_u32_u24 v3, 52429, v2
    v_lshrrev_b32 v3, 20, v3
    v_mul_u32_u24 v4, 20, v3
    v_sub_u32 v2, v2, v4
    v_lshrrev_b32 v4, 4, v3
    v_mul_u32_u24 v4, 5, v4
    v_lshrrev_b32 v5, 2, v2
    v_add_u32 v4, v4, v5
    v_lshlrev_b32 v4, 10, v4
    v_and_b32 v2, 3, v2
    v_lshl_add_u32 v4, v2, 8, v4
    v_lshl_add_u32 v5, v2, 2, v5
    v_add_u32 v5, v5, v3
    v_and_b32 v5, 15, v5
    v_lshl_add_u32 v14, v5, 4, v4
    v_add_u32 v2, 1024, v0
    v_mul_u32_u24 v3, 52429, v2
    v_lshrrev_b32 v3, 20, v3
    v_mul_u32_u24 v4, 20, v3
    v_sub_u32 v2, v2, v4
    v_lshrrev_b32 v4, 4, v3
    v_mul_u32_u24 v4, 5, v4
    v_lshrrev_b32 v5, 2, v2
    v_add_u32 v4, v4, v5
    v_lshlrev_b32 v4, 10, v4
    v_and_b32 v2, 3, v2
    v_lshl_add_u32 v4, v2, 8, v4
    v_lshl_add_u32 v5, v2, 2, v5
    v_add_u32 v5, v5, v3
    v_and_b32 v5, 15, v5
    v_lshl_add_u32 v15, v5, 4, v4
    s_waitcnt lgkmcnt(0)
    s_cmp_ge_u32 s12, 6
    s_cbranch_scc1 K3_DFT_MAIN
    s_barrier
    s_cbranch_vccnz K3_REDUCE
    buffer_load_dwordx4 v[236:239], v9, s[20:23], s46 offen offset:0
    buffer_load_dwordx4 v[240:243], v9, s[20:23], s46 offen offset:1024
    buffer_load_dwordx4 v[244:247], v9, s[20:23], s46 offen offset:2048
    buffer_load_dwordx4 v[248:251], v9, s[20:23], s46 offen offset:3072
    s_add_u32 s46, s46, 4096
    buffer_load_dwordx4 v[252:255], v9, s[20:23], s46 offen
    s_add_u32 s46, s46, 1024
    buffer_load_dwordx4 v[32:35], v9, s[32:35], s47 offen offset:0
    buffer_load_dwordx4 v[36:39], v9, s[32:35], s47 offen offset:1024
    buffer_load_dwordx4 v[40:43], v9, s[32:35], s47 offen offset:2048
    buffer_load_dwordx4 v[44:47], v9, s[32:35], s47 offen offset:3072
    s_add_u32 s47, s47, 4096
    s_waitcnt vmcnt(27)
    v_mfma_f32_16x16x32_bf16 v[48:51], v[128:131], v[148:151], 0
    v_mfma_f32_16x16x32_bf16 v[52:55], v[132:135], v[148:151], 0
    v_mfma_f32_16x16x32_bf16 v[56:59], v[136:139], v[148:151], 0
    v_mfma_f32_16x16x32_bf16 v[60:63], v[140:143], v[148:151], 0
    v_mfma_f32_16x16x32_bf16 v[64:67], v[144:147], v[148:151], 0
    v_mfma_f32_16x16x32_bf16 v[68:71], v[128:131], v[152:155], 0
    v_mfma_f32_16x16x32_bf16 v[72:75], v[132:135], v[152:155], 0
    v_mfma_f32_16x16x32_bf16 v[76:79], v[136:139], v[152:155], 0
    v_mfma_f32_16x16x32_bf16 v[80:83], v[140:143], v[152:155], 0
    v_mfma_f32_16x16x32_bf16 v[84:87], v[144:147], v[152:155], 0
    v_mfma_f32_16x16x32_bf16 v[88:91], v[128:131], v[156:159], 0
    v_mfma_f32_16x16x32_bf16 v[92:95], v[132:135], v[156:159], 0
    v_mfma_f32_16x16x32_bf16 v[96:99], v[136:139], v[156:159], 0
    v_mfma_f32_16x16x32_bf16 v[100:103], v[140:143], v[156:159], 0
    v_mfma_f32_16x16x32_bf16 v[104:107], v[144:147], v[156:159], 0
    v_mfma_f32_16x16x32_bf16 v[108:111], v[128:131], v[160:163], 0
    v_mfma_f32_16x16x32_bf16 v[112:115], v[132:135], v[160:163], 0
    v_mfma_f32_16x16x32_bf16 v[116:119], v[136:139], v[160:163], 0
    v_mfma_f32_16x16x32_bf16 v[120:123], v[140:143], v[160:163], 0
    v_mfma_f32_16x16x32_bf16 v[124:127], v[144:147], v[160:163], 0
    buffer_load_dwordx4 v[128:131], v9, s[20:23], s46 offen offset:0
    buffer_load_dwordx4 v[132:135], v9, s[20:23], s46 offen offset:1024
    buffer_load_dwordx4 v[136:139], v9, s[20:23], s46 offen offset:2048
    buffer_load_dwordx4 v[140:143], v9, s[20:23], s46 offen offset:3072
    s_add_u32 s46, s46, 4096
    buffer_load_dwordx4 v[144:147], v9, s[20:23], s46 offen
    s_add_u32 s46, s46, 1024
    buffer_load_dwordx4 v[148:151], v9, s[32:35], s47 offen offset:0
    buffer_load_dwordx4 v[152:155], v9, s[32:35], s47 offen offset:1024
    buffer_load_dwordx4 v[156:159], v9, s[32:35], s47 offen offset:2048
    buffer_load_dwordx4 v[160:163], v9, s[32:35], s47 offen offset:3072
    s_add_u32 s47, s47, 4096
    s_waitcnt vmcnt(27)
    v_mfma_f32_16x16x32_bf16 v[48:51], v[164:167], v[184:187], v[48:51]
    v_mfma_f32_16x16x32_bf16 v[52:55], v[168:171], v[184:187], v[52:55]
    v_mfma_f32_16x16x32_bf16 v[56:59], v[172:175], v[184:187], v[56:59]
    v_mfma_f32_16x16x32_bf16 v[60:63], v[176:179], v[184:187], v[60:63]
    v_mfma_f32_16x16x32_bf16 v[64:67], v[180:183], v[184:187], v[64:67]
    v_mfma_f32_16x16x32_bf16 v[68:71], v[164:167], v[188:191], v[68:71]
    v_mfma_f32_16x16x32_bf16 v[72:75], v[168:171], v[188:191], v[72:75]
    v_mfma_f32_16x16x32_bf16 v[76:79], v[172:175], v[188:191], v[76:79]
    v_mfma_f32_16x16x32_bf16 v[80:83], v[176:179], v[188:191], v[80:83]
    v_mfma_f32_16x16x32_bf16 v[84:87], v[180:183], v[188:191], v[84:87]
    v_mfma_f32_16x16x32_bf16 v[88:91], v[164:167], v[192:195], v[88:91]
    v_mfma_f32_16x16x32_bf16 v[92:95], v[168:171], v[192:195], v[92:95]
    v_mfma_f32_16x16x32_bf16 v[96:99], v[172:175], v[192:195], v[96:99]
    v_mfma_f32_16x16x32_bf16 v[100:103], v[176:179], v[192:195], v[100:103]
    v_mfma_f32_16x16x32_bf16 v[104:107], v[180:183], v[192:195], v[104:107]
    v_mfma_f32_16x16x32_bf16 v[108:111], v[164:167], v[196:199], v[108:111]
    v_mfma_f32_16x16x32_bf16 v[112:115], v[168:171], v[196:199], v[112:115]
    v_mfma_f32_16x16x32_bf16 v[116:119], v[172:175], v[196:199], v[116:119]
    v_mfma_f32_16x16x32_bf16 v[120:123], v[176:179], v[196:199], v[120:123]
    v_mfma_f32_16x16x32_bf16 v[124:127], v[180:183], v[196:199], v[124:127]
    buffer_load_dwordx4 v[164:167], v9, s[20:23], s46 offen offset:0
    buffer_load_dwordx4 v[168:171], v9, s[20:23], s46 offen offset:1024
    buffer_load_dwordx4 v[172:175], v9, s[20:23], s46 offen offset:2048
    buffer_load_dwordx4 v[176:179], v9, s[20:23], s46 offen offset:3072
    s_add_u32 s46, s46, 4096
    buffer_load_dwordx4 v[180:183], v9, s[20:23], s46 offen
    s_add_u32 s46, s46, 1024
    buffer_load_dwordx4 v[184:187], v9, s[32:35], s47 offen offset:0
    buffer_load_dwordx4 v[188:191], v9, s[32:35], s47 offen offset:1024
    buffer_load_dwordx4 v[192:195], v9, s[32:35], s47 offen offset:2048
    buffer_load_dwordx4 v[196:199], v9, s[32:35], s47 offen offset:3072
    s_add_u32 s47, s47, 4096
    s_waitcnt vmcnt(27)
    v_mfma_f32_16x16x32_bf16 v[48:51], v[200:203], v[220:223], v[48:51]
    v_mfma_f32_16x16x32_bf16 v[52:55], v[204:207], v[220:223], v[52:55]
    v_mfma_f32_16x16x32_bf16 v[56:59], v[208:211], v[220:223], v[56:59]
    v_mfma_f32_16x16x32_bf16 v[60:63], v[212:215], v[220:223], v[60:63]
    v_mfma_f32_16x16x32_bf16 v[64:67], v[216:219], v[220:223], v[64:67]
    v_mfma_f32_16x16x32_bf16 v[68:71], v[200:203], v[224:227], v[68:71]
    v_mfma_f32_16x16x32_bf16 v[72:75], v[204:207], v[224:227], v[72:75]
    v_mfma_f32_16x16x32_bf16 v[76:79], v[208:211], v[224:227], v[76:79]
    v_mfma_f32_16x16x32_bf16 v[80:83], v[212:215], v[224:227], v[80:83]
    v_mfma_f32_16x16x32_bf16 v[84:87], v[216:219], v[224:227], v[84:87]
    v_mfma_f32_16x16x32_bf16 v[88:91], v[200:203], v[228:231], v[88:91]
    v_mfma_f32_16x16x32_bf16 v[92:95], v[204:207], v[228:231], v[92:95]
    v_mfma_f32_16x16x32_bf16 v[96:99], v[208:211], v[228:231], v[96:99]
    v_mfma_f32_16x16x32_bf16 v[100:103], v[212:215], v[228:231], v[100:103]
    v_mfma_f32_16x16x32_bf16 v[104:107], v[216:219], v[228:231], v[104:107]
    v_mfma_f32_16x16x32_bf16 v[108:111], v[200:203], v[232:235], v[108:111]
    v_mfma_f32_16x16x32_bf16 v[112:115], v[204:207], v[232:235], v[112:115]
    v_mfma_f32_16x16x32_bf16 v[116:119], v[208:211], v[232:235], v[116:119]
    v_mfma_f32_16x16x32_bf16 v[120:123], v[212:215], v[232:235], v[120:123]
    v_mfma_f32_16x16x32_bf16 v[124:127], v[216:219], v[232:235], v[124:127]
    buffer_load_dwordx4 v[200:203], v9, s[20:23], s46 offen offset:0
    buffer_load_dwordx4 v[204:207], v9, s[20:23], s46 offen offset:1024
    buffer_load_dwordx4 v[208:211], v9, s[20:23], s46 offen offset:2048
    buffer_load_dwordx4 v[212:215], v9, s[20:23], s46 offen offset:3072
    s_add_u32 s46, s46, 4096
    buffer_load_dwordx4 v[216:219], v9, s[20:23], s46 offen
    s_add_u32 s46, s46, 1024
    buffer_load_dwordx4 v[220:223], v9, s[32:35], s47 offen offset:0
    buffer_load_dwordx4 v[224:227], v9, s[32:35], s47 offen offset:1024
    buffer_load_dwordx4 v[228:231], v9, s[32:35], s47 offen offset:2048
    buffer_load_dwordx4 v[232:235], v9, s[32:35], s47 offen offset:3072
    s_add_u32 s47, s47, 4096
    s_waitcnt vmcnt(27)
    v_mfma_f32_16x16x32_bf16 v[48:51], v[236:239], v[32:35], v[48:51]
    v_mfma_f32_16x16x32_bf16 v[52:55], v[240:243], v[32:35], v[52:55]
    v_mfma_f32_16x16x32_bf16 v[56:59], v[244:247], v[32:35], v[56:59]
    v_mfma_f32_16x16x32_bf16 v[60:63], v[248:251], v[32:35], v[60:63]
    v_mfma_f32_16x16x32_bf16 v[64:67], v[252:255], v[32:35], v[64:67]
    v_mfma_f32_16x16x32_bf16 v[68:71], v[236:239], v[36:39], v[68:71]
    v_mfma_f32_16x16x32_bf16 v[72:75], v[240:243], v[36:39], v[72:75]
    v_mfma_f32_16x16x32_bf16 v[76:79], v[244:247], v[36:39], v[76:79]
    v_mfma_f32_16x16x32_bf16 v[80:83], v[248:251], v[36:39], v[80:83]
    v_mfma_f32_16x16x32_bf16 v[84:87], v[252:255], v[36:39], v[84:87]
    v_mfma_f32_16x16x32_bf16 v[88:91], v[236:239], v[40:43], v[88:91]
    v_mfma_f32_16x16x32_bf16 v[92:95], v[240:243], v[40:43], v[92:95]
    v_mfma_f32_16x16x32_bf16 v[96:99], v[244:247], v[40:43], v[96:99]
    v_mfma_f32_16x16x32_bf16 v[100:103], v[248:251], v[40:43], v[100:103]
    v_mfma_f32_16x16x32_bf16 v[104:107], v[252:255], v[40:43], v[104:107]
    v_mfma_f32_16x16x32_bf16 v[108:111], v[236:239], v[44:47], v[108:111]
    v_mfma_f32_16x16x32_bf16 v[112:115], v[240:243], v[44:47], v[112:115]
    v_mfma_f32_16x16x32_bf16 v[116:119], v[244:247], v[44:47], v[116:119]
    v_mfma_f32_16x16x32_bf16 v[120:123], v[248:251], v[44:47], v[120:123]
    v_mfma_f32_16x16x32_bf16 v[124:127], v[252:255], v[44:47], v[124:127]
    buffer_load_dwordx4 v[236:239], v9, s[20:23], s46 offen offset:0
    buffer_load_dwordx4 v[240:243], v9, s[20:23], s46 offen offset:1024
    buffer_load_dwordx4 v[244:247], v9, s[20:23], s46 offen offset:2048
    buffer_load_dwordx4 v[248:251], v9, s[20:23], s46 offen offset:3072
    s_add_u32 s46, s46, 4096
    buffer_load_dwordx4 v[252:255], v9, s[20:23], s46 offen
    s_add_u32 s46, s46, 1024
    buffer_load_dwordx4 v[32:35], v9, s[32:35], s47 offen offset:0
    buffer_load_dwordx4 v[36:39], v9, s[32:35], s47 offen offset:1024
    buffer_load_dwordx4 v[40:43], v9, s[32:35], s47 offen offset:2048
    buffer_load_dwordx4 v[44:47], v9, s[32:35], s47 offen offset:3072
    s_add_u32 s47, s47, 4096
    s_waitcnt vmcnt(27)
    v_mfma_f32_16x16x32_bf16 v[48:51], v[128:131], v[148:151], v[48:51]
    v_mfma_f32_16x16x32_bf16 v[52:55], v[132:135], v[148:151], v[52:55]
    v_mfma_f32_16x16x32_bf16 v[56:59], v[136:139], v[148:151], v[56:59]
    v_mfma_f32_16x16x32_bf16 v[60:63], v[140:143], v[148:151], v[60:63]
    v_mfma_f32_16x16x32_bf16 v[64:67], v[144:147], v[148:151], v[64:67]
    v_mfma_f32_16x16x32_bf16 v[68:71], v[128:131], v[152:155], v[68:71]
    v_mfma_f32_16x16x32_bf16 v[72:75], v[132:135], v[152:155], v[72:75]
    v_mfma_f32_16x16x32_bf16 v[76:79], v[136:139], v[152:155], v[76:79]
    v_mfma_f32_16x16x32_bf16 v[80:83], v[140:143], v[152:155], v[80:83]
    v_mfma_f32_16x16x32_bf16 v[84:87], v[144:147], v[152:155], v[84:87]
    v_mfma_f32_16x16x32_bf16 v[88:91], v[128:131], v[156:159], v[88:91]
    v_mfma_f32_16x16x32_bf16 v[92:95], v[132:135], v[156:159], v[92:95]
    v_mfma_f32_16x16x32_bf16 v[96:99], v[136:139], v[156:159], v[96:99]
    v_mfma_f32_16x16x32_bf16 v[100:103], v[140:143], v[156:159], v[100:103]
    v_mfma_f32_16x16x32_bf16 v[104:107], v[144:147], v[156:159], v[104:107]
    v_mfma_f32_16x16x32_bf16 v[108:111], v[128:131], v[160:163], v[108:111]
    v_mfma_f32_16x16x32_bf16 v[112:115], v[132:135], v[160:163], v[112:115]
    v_mfma_f32_16x16x32_bf16 v[116:119], v[136:139], v[160:163], v[116:119]
    v_mfma_f32_16x16x32_bf16 v[120:123], v[140:143], v[160:163], v[120:123]
    v_mfma_f32_16x16x32_bf16 v[124:127], v[144:147], v[160:163], v[124:127]
    buffer_load_dwordx4 v[128:131], v9, s[20:23], s46 offen offset:0
    buffer_load_dwordx4 v[132:135], v9, s[20:23], s46 offen offset:1024
    buffer_load_dwordx4 v[136:139], v9, s[20:23], s46 offen offset:2048
    buffer_load_dwordx4 v[140:143], v9, s[20:23], s46 offen offset:3072
    s_add_u32 s46, s46, 4096
    buffer_load_dwordx4 v[144:147], v9, s[20:23], s46 offen
    s_add_u32 s46, s46, 1024
    buffer_load_dwordx4 v[148:151], v9, s[32:35], s47 offen offset:0
    buffer_load_dwordx4 v[152:155], v9, s[32:35], s47 offen offset:1024
    buffer_load_dwordx4 v[156:159], v9, s[32:35], s47 offen offset:2048
    buffer_load_dwordx4 v[160:163], v9, s[32:35], s47 offen offset:3072
    s_add_u32 s47, s47, 4096
    s_waitcnt vmcnt(27)
    v_mfma_f32_16x16x32_bf16 v[48:51], v[164:167], v[184:187], v[48:51]
    v_mfma_f32_16x16x32_bf16 v[52:55], v[168:171], v[184:187], v[52:55]
    v_mfma_f32_16x16x32_bf16 v[56:59], v[172:175], v[184:187], v[56:59]
    v_mfma_f32_16x16x32_bf16 v[60:63], v[176:179], v[184:187], v[60:63]
    v_mfma_f32_16x16x32_bf16 v[64:67], v[180:183], v[184:187], v[64:67]
    v_mfma_f32_16x16x32_bf16 v[68:71], v[164:167], v[188:191], v[68:71]
    v_mfma_f32_16x16x32_bf16 v[72:75], v[168:171], v[188:191], v[72:75]
    v_mfma_f32_16x16x32_bf16 v[76:79], v[172:175], v[188:191], v[76:79]
    v_mfma_f32_16x16x32_bf16 v[80:83], v[176:179], v[188:191], v[80:83]
    v_mfma_f32_16x16x32_bf16 v[84:87], v[180:183], v[188:191], v[84:87]
    v_mfma_f32_16x16x32_bf16 v[88:91], v[164:167], v[192:195], v[88:91]
    v_mfma_f32_16x16x32_bf16 v[92:95], v[168:171], v[192:195], v[92:95]
    v_mfma_f32_16x16x32_bf16 v[96:99], v[172:175], v[192:195], v[96:99]
    v_mfma_f32_16x16x32_bf16 v[100:103], v[176:179], v[192:195], v[100:103]
    v_mfma_f32_16x16x32_bf16 v[104:107], v[180:183], v[192:195], v[104:107]
    v_mfma_f32_16x16x32_bf16 v[108:111], v[164:167], v[196:199], v[108:111]
    v_mfma_f32_16x16x32_bf16 v[112:115], v[168:171], v[196:199], v[112:115]
    v_mfma_f32_16x16x32_bf16 v[116:119], v[172:175], v[196:199], v[116:119]
    v_mfma_f32_16x16x32_bf16 v[120:123], v[176:179], v[196:199], v[120:123]
    v_mfma_f32_16x16x32_bf16 v[124:127], v[180:183], v[196:199], v[124:127]
    buffer_load_dwordx4 v[164:167], v9, s[20:23], s46 offen offset:0
    buffer_load_dwordx4 v[168:171], v9, s[20:23], s46 offen offset:1024
    buffer_load_dwordx4 v[172:175], v9, s[20:23], s46 offen offset:2048
    buffer_load_dwordx4 v[176:179], v9, s[20:23], s46 offen offset:3072
    s_add_u32 s46, s46, 4096
    buffer_load_dwordx4 v[180:183], v9, s[20:23], s46 offen
    s_add_u32 s46, s46, 1024
    buffer_load_dwordx4 v[184:187], v9, s[32:35], s47 offen offset:0
    buffer_load_dwordx4 v[188:191], v9, s[32:35], s47 offen offset:1024
    buffer_load_dwordx4 v[192:195], v9, s[32:35], s47 offen offset:2048
    buffer_load_dwordx4 v[196:199], v9, s[32:35], s47 offen offset:3072
    s_add_u32 s47, s47, 4096
    s_waitcnt vmcnt(27)
    v_mfma_f32_16x16x32_bf16 v[48:51], v[200:203], v[220:223], v[48:51]
    v_mfma_f32_16x16x32_bf16 v[52:55], v[204:207], v[220:223], v[52:55]
    v_mfma_f32_16x16x32_bf16 v[56:59], v[208:211], v[220:223], v[56:59]
    v_mfma_f32_16x16x32_bf16 v[60:63], v[212:215], v[220:223], v[60:63]
    v_mfma_f32_16x16x32_bf16 v[64:67], v[216:219], v[220:223], v[64:67]
    v_mfma_f32_16x16x32_bf16 v[68:71], v[200:203], v[224:227], v[68:71]
    v_mfma_f32_16x16x32_bf16 v[72:75], v[204:207], v[224:227], v[72:75]
    v_mfma_f32_16x16x32_bf16 v[76:79], v[208:211], v[224:227], v[76:79]
    v_mfma_f32_16x16x32_bf16 v[80:83], v[212:215], v[224:227], v[80:83]
    v_mfma_f32_16x16x32_bf16 v[84:87], v[216:219], v[224:227], v[84:87]
    v_mfma_f32_16x16x32_bf16 v[88:91], v[200:203], v[228:231], v[88:91]
    v_mfma_f32_16x16x32_bf16 v[92:95], v[204:207], v[228:231], v[92:95]
    v_mfma_f32_16x16x32_bf16 v[96:99], v[208:211], v[228:231], v[96:99]
    v_mfma_f32_16x16x32_bf16 v[100:103], v[212:215], v[228:231], v[100:103]
    v_mfma_f32_16x16x32_bf16 v[104:107], v[216:219], v[228:231], v[104:107]
    v_mfma_f32_16x16x32_bf16 v[108:111], v[200:203], v[232:235], v[108:111]
    v_mfma_f32_16x16x32_bf16 v[112:115], v[204:207], v[232:235], v[112:115]
    v_mfma_f32_16x16x32_bf16 v[116:119], v[208:211], v[232:235], v[116:119]
    v_mfma_f32_16x16x32_bf16 v[120:123], v[212:215], v[232:235], v[120:123]
    v_mfma_f32_16x16x32_bf16 v[124:127], v[216:219], v[232:235], v[124:127]
    buffer_load_dwordx4 v[200:203], v9, s[20:23], s46 offen offset:0
    buffer_load_dwordx4 v[204:207], v9, s[20:23], s46 offen offset:1024
    buffer_load_dwordx4 v[208:211], v9, s[20:23], s46 offen offset:2048
    buffer_load_dwordx4 v[212:215], v9, s[20:23], s46 offen offset:3072
    s_add_u32 s46, s46, 4096
    buffer_load_dwordx4 v[216:219], v9, s[20:23], s46 offen
    s_add_u32 s46, s46, 1024
    buffer_load_dwordx4 v[220:223], v9, s[32:35], s47 offen offset:0
    buffer_load_dwordx4 v[224:227], v9, s[32:35], s47 offen offset:1024
    buffer_load_dwordx4 v[228:231], v9, s[32:35], s47 offen offset:2048
    buffer_load_dwordx4 v[232:235], v9, s[32:35], s47 offen offset:3072
    s_add_u32 s47, s47, 4096
    s_waitcnt vmcnt(27)
    v_mfma_f32_16x16x32_bf16 v[48:51], v[236:239], v[32:35], v[48:51]
    v_mfma_f32_16x16x32_bf16 v[52:55], v[240:243], v[32:35], v[52:55]
    v_mfma_f32_16x16x32_bf16 v[56:59], v[244:247], v[32:35], v[56:59]
    v_mfma_f32_16x16x32_bf16 v[60:63], v[248:251], v[32:35], v[60:63]
    v_mfma_f32_16x16x32_bf16 v[64:67], v[252:255], v[32:35], v[64:67]
    v_mfma_f32_16x16x32_bf16 v[68:71], v[236:239], v[36:39], v[68:71]
    v_mfma_f32_16x16x32_bf16 v[72:75], v[240:243], v[36:39], v[72:75]
    v_mfma_f32_16x16x32_bf16 v[76:79], v[244:247], v[36:39], v[76:79]
    v_mfma_f32_16x16x32_bf16 v[80:83], v[248:251], v[36:39], v[80:83]
    v_mfma_f32_16x16x32_bf16 v[84:87], v[252:255], v[36:39], v[84:87]
    v_mfma_f32_16x16x32_bf16 v[88:91], v[236:239], v[40:43], v[88:91]
    v_mfma_f32_16x16x32_bf16 v[92:95], v[240:243], v[40:43], v[92:95]
    v_mfma_f32_16x16x32_bf16 v[96:99], v[244:247], v[40:43], v[96:99]
    v_mfma_f32_16x16x32_bf16 v[100:103], v[248:251], v[40:43], v[100:103]
    v_mfma_f32_16x16x32_bf16 v[104:107], v[252:255], v[40:43], v[104:107]
    v_mfma_f32_16x16x32_bf16 v[108:111], v[236:239], v[44:47], v[108:111]
    v_mfma_f32_16x16x32_bf16 v[112:115], v[240:243], v[44:47], v[112:115]
    v_mfma_f32_16x16x32_bf16 v[116:119], v[244:247], v[44:47], v[116:119]
    v_mfma_f32_16x16x32_bf16 v[120:123], v[248:251], v[44:47], v[120:123]
    v_mfma_f32_16x16x32_bf16 v[124:127], v[252:255], v[44:47], v[124:127]
    buffer_load_dwordx4 v[236:239], v9, s[20:23], s46 offen offset:0
    buffer_load_dwordx4 v[240:243], v9, s[20:23], s46 offen offset:1024
    buffer_load_dwordx4 v[244:247], v9, s[20:23], s46 offen offset:2048
    buffer_load_dwordx4 v[248:251], v9, s[20:23], s46 offen offset:3072
    s_add_u32 s46, s46, 4096
    buffer_load_dwordx4 v[252:255], v9, s[20:23], s46 offen
    s_add_u32 s46, s46, 1024
    buffer_load_dwordx4 v[32:35], v9, s[32:35], s47 offen offset:0
    buffer_load_dwordx4 v[36:39], v9, s[32:35], s47 offen offset:1024
    buffer_load_dwordx4 v[40:43], v9, s[32:35], s47 offen offset:2048
    buffer_load_dwordx4 v[44:47], v9, s[32:35], s47 offen offset:3072
    s_add_u32 s47, s47, 4096
    s_waitcnt vmcnt(27)
    v_mfma_f32_16x16x32_bf16 v[48:51], v[128:131], v[148:151], v[48:51]
    v_mfma_f32_16x16x32_bf16 v[52:55], v[132:135], v[148:151], v[52:55]
    v_mfma_f32_16x16x32_bf16 v[56:59], v[136:139], v[148:151], v[56:59]
    v_mfma_f32_16x16x32_bf16 v[60:63], v[140:143], v[148:151], v[60:63]
    v_mfma_f32_16x16x32_bf16 v[64:67], v[144:147], v[148:151], v[64:67]
    v_mfma_f32_16x16x32_bf16 v[68:71], v[128:131], v[152:155], v[68:71]
    v_mfma_f32_16x16x32_bf16 v[72:75], v[132:135], v[152:155], v[72:75]
    v_mfma_f32_16x16x32_bf16 v[76:79], v[136:139], v[152:155], v[76:79]
    v_mfma_f32_16x16x32_bf16 v[80:83], v[140:143], v[152:155], v[80:83]
    v_mfma_f32_16x16x32_bf16 v[84:87], v[144:147], v[152:155], v[84:87]
    v_mfma_f32_16x16x32_bf16 v[88:91], v[128:131], v[156:159], v[88:91]
    v_mfma_f32_16x16x32_bf16 v[92:95], v[132:135], v[156:159], v[92:95]
    v_mfma_f32_16x16x32_bf16 v[96:99], v[136:139], v[156:159], v[96:99]
    v_mfma_f32_16x16x32_bf16 v[100:103], v[140:143], v[156:159], v[100:103]
    v_mfma_f32_16x16x32_bf16 v[104:107], v[144:147], v[156:159], v[104:107]
    v_mfma_f32_16x16x32_bf16 v[108:111], v[128:131], v[160:163], v[108:111]
    v_mfma_f32_16x16x32_bf16 v[112:115], v[132:135], v[160:163], v[112:115]
    v_mfma_f32_16x16x32_bf16 v[116:119], v[136:139], v[160:163], v[116:119]
    v_mfma_f32_16x16x32_bf16 v[120:123], v[140:143], v[160:163], v[120:123]
    v_mfma_f32_16x16x32_bf16 v[124:127], v[144:147], v[160:163], v[124:127]
    s_waitcnt vmcnt(18)
    v_mfma_f32_16x16x32_bf16 v[48:51], v[164:167], v[184:187], v[48:51]
    v_mfma_f32_16x16x32_bf16 v[52:55], v[168:171], v[184:187], v[52:55]
    v_mfma_f32_16x16x32_bf16 v[56:59], v[172:175], v[184:187], v[56:59]
    v_mfma_f32_16x16x32_bf16 v[60:63], v[176:179], v[184:187], v[60:63]
    v_mfma_f32_16x16x32_bf16 v[64:67], v[180:183], v[184:187], v[64:67]
    v_mfma_f32_16x16x32_bf16 v[68:71], v[164:167], v[188:191], v[68:71]
    v_mfma_f32_16x16x32_bf16 v[72:75], v[168:171], v[188:191], v[72:75]
    v_mfma_f32_16x16x32_bf16 v[76:79], v[172:175], v[188:191], v[76:79]
    v_mfma_f32_16x16x32_bf16 v[80:83], v[176:179], v[188:191], v[80:83]
    v_mfma_f32_16x16x32_bf16 v[84:87], v[180:183], v[188:191], v[84:87]
    v_mfma_f32_16x16x32_bf16 v[88:91], v[164:167], v[192:195], v[88:91]
    v_mfma_f32_16x16x32_bf16 v[92:95], v[168:171], v[192:195], v[92:95]
    v_mfma_f32_16x16x32_bf16 v[96:99], v[172:175], v[192:195], v[96:99]
    v_mfma_f32_16x16x32_bf16 v[100:103], v[176:179], v[192:195], v[100:103]
    v_mfma_f32_16x16x32_bf16 v[104:107], v[180:183], v[192:195], v[104:107]
    v_mfma_f32_16x16x32_bf16 v[108:111], v[164:167], v[196:199], v[108:111]
    v_mfma_f32_16x16x32_bf16 v[112:115], v[168:171], v[196:199], v[112:115]
    v_mfma_f32_16x16x32_bf16 v[116:119], v[172:175], v[196:199], v[116:119]
    v_mfma_f32_16x16x32_bf16 v[120:123], v[176:179], v[196:199], v[120:123]
    v_mfma_f32_16x16x32_bf16 v[124:127], v[180:183], v[196:199], v[124:127]
    s_waitcnt vmcnt(9)
    v_mfma_f32_16x16x32_bf16 v[48:51], v[200:203], v[220:223], v[48:51]
    v_mfma_f32_16x16x32_bf16 v[52:55], v[204:207], v[220:223], v[52:55]
    v_mfma_f32_16x16x32_bf16 v[56:59], v[208:211], v[220:223], v[56:59]
    v_mfma_f32_16x16x32_bf16 v[60:63], v[212:215], v[220:223], v[60:63]
    v_mfma_f32_16x16x32_bf16 v[64:67], v[216:219], v[220:223], v[64:67]
    v_mfma_f32_16x16x32_bf16 v[68:71], v[200:203], v[224:227], v[68:71]
    v_mfma_f32_16x16x32_bf16 v[72:75], v[204:207], v[224:227], v[72:75]
    v_mfma_f32_16x16x32_bf16 v[76:79], v[208:211], v[224:227], v[76:79]
    v_mfma_f32_16x16x32_bf16 v[80:83], v[212:215], v[224:227], v[80:83]
    v_mfma_f32_16x16x32_bf16 v[84:87], v[216:219], v[224:227], v[84:87]
    v_mfma_f32_16x16x32_bf16 v[88:91], v[200:203], v[228:231], v[88:91]
    v_mfma_f32_16x16x32_bf16 v[92:95], v[204:207], v[228:231], v[92:95]
    v_mfma_f32_16x16x32_bf16 v[96:99], v[208:211], v[228:231], v[96:99]
    v_mfma_f32_16x16x32_bf16 v[100:103], v[212:215], v[228:231], v[100:103]
    v_mfma_f32_16x16x32_bf16 v[104:107], v[216:219], v[228:231], v[104:107]
    v_mfma_f32_16x16x32_bf16 v[108:111], v[200:203], v[232:235], v[108:111]
    v_mfma_f32_16x16x32_bf16 v[112:115], v[204:207], v[232:235], v[112:115]
    v_mfma_f32_16x16x32_bf16 v[116:119], v[208:211], v[232:235], v[116:119]
    v_mfma_f32_16x16x32_bf16 v[120:123], v[212:215], v[232:235], v[120:123]
    v_mfma_f32_16x16x32_bf16 v[124:127], v[216:219], v[232:235], v[124:127]
    s_waitcnt vmcnt(0)
    v_mfma_f32_16x16x32_bf16 v[48:51], v[236:239], v[32:35], v[48:51]
    v_mfma_f32_16x16x32_bf16 v[52:55], v[240:243], v[32:35], v[52:55]
    v_mfma_f32_16x16x32_bf16 v[56:59], v[244:247], v[32:35], v[56:59]
    v_mfma_f32_16x16x32_bf16 v[60:63], v[248:251], v[32:35], v[60:63]
    v_mfma_f32_16x16x32_bf16 v[64:67], v[252:255], v[32:35], v[64:67]
    v_mfma_f32_16x16x32_bf16 v[68:71], v[236:239], v[36:39], v[68:71]
    v_mfma_f32_16x16x32_bf16 v[72:75], v[240:243], v[36:39], v[72:75]
    v_mfma_f32_16x16x32_bf16 v[76:79], v[244:247], v[36:39], v[76:79]
    v_mfma_f32_16x16x32_bf16 v[80:83], v[248:251], v[36:39], v[80:83]
    v_mfma_f32_16x16x32_bf16 v[84:87], v[252:255], v[36:39], v[84:87]
    v_mfma_f32_16x16x32_bf16 v[88:91], v[236:239], v[40:43], v[88:91]
    v_mfma_f32_16x16x32_bf16 v[92:95], v[240:243], v[40:43], v[92:95]
    v_mfma_f32_16x16x32_bf16 v[96:99], v[244:247], v[40:43], v[96:99]
    v_mfma_f32_16x16x32_bf16 v[100:103], v[248:251], v[40:43], v[100:103]
    v_mfma_f32_16x16x32_bf16 v[104:107], v[252:255], v[40:43], v[104:107]
    v_mfma_f32_16x16x32_bf16 v[108:111], v[236:239], v[44:47], v[108:111]
    v_mfma_f32_16x16x32_bf16 v[112:115], v[240:243], v[44:47], v[112:115]
    v_mfma_f32_16x16x32_bf16 v[116:119], v[244:247], v[44:47], v[116:119]
    v_mfma_f32_16x16x32_bf16 v[120:123], v[248:251], v[44:47], v[120:123]
    v_mfma_f32_16x16x32_bf16 v[124:127], v[252:255], v[44:47], v[124:127]
    s_branch K3_REDUCE
K3_DFT_MAIN:
    s_nop 3
    s_barrier
    ds_read_b128 v[32:35], v12 offset:0
    ds_read_b128 v[36:39], v12 offset:5120
    ds_read_b128 v[40:43], v12 offset:10240
    ds_read_b128 v[44:47], v12 offset:15360
    s_waitcnt lgkmcnt(0)
    v_mfma_f32_16x16x32_bf16 v[48:51], v[208:211], v[32:35], 0
    ds_read_b128 v[228:231], v12 offset:64
    v_mfma_f32_16x16x32_bf16 v[68:71], v[208:211], v[36:39], 0
    ds_read_b128 v[232:235], v12 offset:5184
    v_mfma_f32_16x16x32_bf16 v[88:91], v[208:211], v[40:43], 0
    ds_read_b128 v[236:239], v12 offset:10304
    v_mfma_f32_16x16x32_bf16 v[108:111], v[208:211], v[44:47], 0
    ds_read_b128 v[240:243], v12 offset:15424
    v_mfma_f32_16x16x32_bf16 v[52:55], v[212:215], v[32:35], 0
    v_cvt_pk_bf16_f32 v208, v168, v169
    v_cvt_pk_bf16_f32 v209, v170, v171
    v_cvt_pk_bf16_f32 v210, v172, v173
    v_mfma_f32_16x16x32_bf16 v[72:75], v[212:215], v[36:39], 0
    v_cvt_pk_bf16_f32 v211, v174, v175
    v_fma_f32 v128, v26, v168, -v128
    v_fma_f32 v129, v26, v169, -v129
    v_mfma_f32_16x16x32_bf16 v[92:95], v[212:215], v[40:43], 0
    v_fma_f32 v130, v26, v170, -v130
    v_fma_f32 v131, v26, v171, -v131
    v_fma_f32 v132, v26, v172, -v132
    v_mfma_f32_16x16x32_bf16 v[112:115], v[212:215], v[44:47], 0
    v_fma_f32 v133, v26, v173, -v133
    v_fma_f32 v134, v26, v174, -v134
    v_fma_f32 v135, v26, v175, -v135
    v_mfma_f32_16x16x32_bf16 v[56:59], v[216:219], v[32:35], 0
    v_cvt_pk_bf16_f32 v212, v176, v177
    v_cvt_pk_bf16_f32 v213, v178, v179
    v_cvt_pk_bf16_f32 v214, v180, v181
    v_mfma_f32_16x16x32_bf16 v[76:79], v[216:219], v[36:39], 0
    v_cvt_pk_bf16_f32 v215, v182, v183
    v_fma_f32 v136, v27, v176, -v136
    v_fma_f32 v137, v27, v177, -v137
    v_mfma_f32_16x16x32_bf16 v[96:99], v[216:219], v[40:43], 0
    v_fma_f32 v138, v27, v178, -v138
    v_fma_f32 v139, v27, v179, -v139
    v_fma_f32 v140, v27, v180, -v140
    v_mfma_f32_16x16x32_bf16 v[116:119], v[216:219], v[44:47], 0
    v_fma_f32 v141, v27, v181, -v141
    v_fma_f32 v142, v27, v182, -v142
    v_fma_f32 v143, v27, v183, -v143
    v_mfma_f32_16x16x32_bf16 v[60:63], v[220:223], v[32:35], 0
    v_cvt_pk_bf16_f32 v216, v184, v185
    v_cvt_pk_bf16_f32 v217, v186, v187
    v_cvt_pk_bf16_f32 v218, v188, v189
    v_mfma_f32_16x16x32_bf16 v[80:83], v[220:223], v[36:39], 0
    v_cvt_pk_bf16_f32 v219, v190, v191
    v_fma_f32 v144, v28, v184, -v144
    v_fma_f32 v145, v28, v185, -v145
    v_mfma_f32_16x16x32_bf16 v[100:103], v[220:223], v[40:43], 0
    v_fma_f32 v146, v28, v186, -v146
    v_fma_f32 v147, v28, v187, -v147
    v_fma_f32 v148, v28, v188, -v148
    v_mfma_f32_16x16x32_bf16 v[120:123], v[220:223], v[44:47], 0
    v_fma_f32 v149, v28, v189, -v149
    v_fma_f32 v150, v28, v190, -v150
    v_fma_f32 v151, v28, v191, -v151
    v_mfma_f32_16x16x32_bf16 v[64:67], v[224:227], v[32:35], 0
    v_cvt_pk_bf16_f32 v220, v192, v193
    v_cvt_pk_bf16_f32 v221, v194, v195
    v_cvt_pk_bf16_f32 v222, v196, v197
    v_mfma_f32_16x16x32_bf16 v[84:87], v[224:227], v[36:39], 0
    v_cvt_pk_bf16_f32 v223, v198, v199
    v_fma_f32 v152, v29, v192, -v152
    v_fma_f32 v153, v29, v193, -v153
    v_mfma_f32_16x16x32_bf16 v[104:107], v[224:227], v[40:43], 0
    v_fma_f32 v154, v29, v194, -v154
    v_fma_f32 v155, v29, v195, -v155
    v_fma_f32 v156, v29, v196, -v156
    v_mfma_f32_16x16x32_bf16 v[124:127], v[224:227], v[44:47], 0
    v_fma_f32 v157, v29, v197, -v157
    v_fma_f32 v158, v29, v198, -v158
    v_fma_f32 v159, v29, v199, -v159
    v_cvt_pk_bf16_f32 v224, v200, v201
    v_cvt_pk_bf16_f32 v225, v202, v203
    v_cvt_pk_bf16_f32 v226, v204, v205
    v_cvt_pk_bf16_f32 v227, v206, v207
    v_fma_f32 v160, v30, v200, -v160
    v_fma_f32 v161, v30, v201, -v161
    v_fma_f32 v162, v30, v202, -v162
    v_fma_f32 v163, v30, v203, -v163
    v_fma_f32 v164, v30, v204, -v164
    v_fma_f32 v165, v30, v205, -v165
    v_fma_f32 v166, v30, v206, -v166
    v_fma_f32 v167, v30, v207, -v167
    s_waitcnt lgkmcnt(0)
    v_mfma_f32_16x16x32_bf16 v[48:51], v[208:211], v[228:231], v[48:51]
    ds_read_b128 v[32:35], v12 offset:128
    v_mfma_f32_16x16x32_bf16 v[68:71], v[208:211], v[232:235], v[68:71]
    ds_read_b128 v[36:39], v12 offset:5248
    v_mfma_f32_16x16x32_bf16 v[88:91], v[208:211], v[236:239], v[88:91]
    ds_read_b128 v[40:43], v12 offset:10368
    v_mfma_f32_16x16x32_bf16 v[108:111], v[208:211], v[240:243], v[108:111]
    ds_read_b128 v[44:47], v12 offset:15488
    v_mfma_f32_16x16x32_bf16 v[52:55], v[212:215], v[228:231], v[52:55]
    v_cvt_pk_bf16_f32 v208, v128, v129
    v_cvt_pk_bf16_f32 v209, v130, v131
    v_cvt_pk_bf16_f32 v210, v132, v133
    v_mfma_f32_16x16x32_bf16 v[72:75], v[212:215], v[232:235], v[72:75]
    v_cvt_pk_bf16_f32 v211, v134, v135
    v_fma_f32 v168, v26, v128, -v168
    v_fma_f32 v169, v26, v129, -v169
    v_mfma_f32_16x16x32_bf16 v[92:95], v[212:215], v[236:239], v[92:95]
    v_fma_f32 v170, v26, v130, -v170
    v_fma_f32 v171, v26, v131, -v171
    v_fma_f32 v172, v26, v132, -v172
    v_mfma_f32_16x16x32_bf16 v[112:115], v[212:215], v[240:243], v[112:115]
    v_fma_f32 v173, v26, v133, -v173
    v_fma_f32 v174, v26, v134, -v174
    v_fma_f32 v175, v26, v135, -v175
    v_mfma_f32_16x16x32_bf16 v[56:59], v[216:219], v[228:231], v[56:59]
    v_cvt_pk_bf16_f32 v212, v136, v137
    v_cvt_pk_bf16_f32 v213, v138, v139
    v_cvt_pk_bf16_f32 v214, v140, v141
    v_mfma_f32_16x16x32_bf16 v[76:79], v[216:219], v[232:235], v[76:79]
    v_cvt_pk_bf16_f32 v215, v142, v143
    v_fma_f32 v176, v27, v136, -v176
    v_fma_f32 v177, v27, v137, -v177
    v_mfma_f32_16x16x32_bf16 v[96:99], v[216:219], v[236:239], v[96:99]
    v_fma_f32 v178, v27, v138, -v178
    v_fma_f32 v179, v27, v139, -v179
    v_fma_f32 v180, v27, v140, -v180
    v_mfma_f32_16x16x32_bf16 v[116:119], v[216:219], v[240:243], v[116:119]
    v_fma_f32 v181, v27, v141, -v181
    v_fma_f32 v182, v27, v142, -v182
    v_fma_f32 v183, v27, v143, -v183
    v_mfma_f32_16x16x32_bf16 v[60:63], v[220:223], v[228:231], v[60:63]
    v_cvt_pk_bf16_f32 v216, v144, v145
    v_cvt_pk_bf16_f32 v217, v146, v147
    v_cvt_pk_bf16_f32 v218, v148, v149
    v_mfma_f32_16x16x32_bf16 v[80:83], v[220:223], v[232:235], v[80:83]
    v_cvt_pk_bf16_f32 v219, v150, v151
    v_fma_f32 v184, v28, v144, -v184
    v_fma_f32 v185, v28, v145, -v185
    v_mfma_f32_16x16x32_bf16 v[100:103], v[220:223], v[236:239], v[100:103]
    v_fma_f32 v186, v28, v146, -v186
    v_fma_f32 v187, v28, v147, -v187
    v_fma_f32 v188, v28, v148, -v188
    v_mfma_f32_16x16x32_bf16 v[120:123], v[220:223], v[240:243], v[120:123]
    v_fma_f32 v189, v28, v149, -v189
    v_fma_f32 v190, v28, v150, -v190
    v_fma_f32 v191, v28, v151, -v191
    v_mfma_f32_16x16x32_bf16 v[64:67], v[224:227], v[228:231], v[64:67]
    v_cvt_pk_bf16_f32 v220, v152, v153
    v_cvt_pk_bf16_f32 v221, v154, v155
    v_cvt_pk_bf16_f32 v222, v156, v157
    v_mfma_f32_16x16x32_bf16 v[84:87], v[224:227], v[232:235], v[84:87]
    v_cvt_pk_bf16_f32 v223, v158, v159
    v_fma_f32 v192, v29, v152, -v192
    v_fma_f32 v193, v29, v153, -v193
    v_mfma_f32_16x16x32_bf16 v[104:107], v[224:227], v[236:239], v[104:107]
    v_fma_f32 v194, v29, v154, -v194
    v_fma_f32 v195, v29, v155, -v195
    v_fma_f32 v196, v29, v156, -v196
    v_mfma_f32_16x16x32_bf16 v[124:127], v[224:227], v[240:243], v[124:127]
    v_fma_f32 v197, v29, v157, -v197
    v_fma_f32 v198, v29, v158, -v198
    v_fma_f32 v199, v29, v159, -v199
    v_cvt_pk_bf16_f32 v224, v160, v161
    v_cvt_pk_bf16_f32 v225, v162, v163
    v_cvt_pk_bf16_f32 v226, v164, v165
    v_cvt_pk_bf16_f32 v227, v166, v167
    v_fma_f32 v200, v30, v160, -v200
    v_fma_f32 v201, v30, v161, -v201
    v_fma_f32 v202, v30, v162, -v202
    v_fma_f32 v203, v30, v163, -v203
    v_fma_f32 v204, v30, v164, -v204
    v_fma_f32 v205, v30, v165, -v205
    v_fma_f32 v206, v30, v166, -v206
    v_fma_f32 v207, v30, v167, -v207
    s_waitcnt lgkmcnt(0)
    v_mfma_f32_16x16x32_bf16 v[48:51], v[208:211], v[32:35], v[48:51]
    ds_read_b128 v[228:231], v12 offset:192
    v_mfma_f32_16x16x32_bf16 v[68:71], v[208:211], v[36:39], v[68:71]
    ds_read_b128 v[232:235], v12 offset:5312
    v_mfma_f32_16x16x32_bf16 v[88:91], v[208:211], v[40:43], v[88:91]
    ds_read_b128 v[236:239], v12 offset:10432
    v_mfma_f32_16x16x32_bf16 v[108:111], v[208:211], v[44:47], v[108:111]
    ds_read_b128 v[240:243], v12 offset:15552
    v_mfma_f32_16x16x32_bf16 v[52:55], v[212:215], v[32:35], v[52:55]
    v_cvt_pk_bf16_f32 v208, v168, v169
    v_cvt_pk_bf16_f32 v209, v170, v171
    v_cvt_pk_bf16_f32 v210, v172, v173
    v_mfma_f32_16x16x32_bf16 v[72:75], v[212:215], v[36:39], v[72:75]
    v_cvt_pk_bf16_f32 v211, v174, v175
    v_fma_f32 v128, v26, v168, -v128
    v_fma_f32 v129, v26, v169, -v129
    v_mfma_f32_16x16x32_bf16 v[92:95], v[212:215], v[40:43], v[92:95]
    v_fma_f32 v130, v26, v170, -v130
    v_fma_f32 v131, v26, v171, -v131
    v_fma_f32 v132, v26, v172, -v132
    v_mfma_f32_16x16x32_bf16 v[112:115], v[212:215], v[44:47], v[112:115]
    v_fma_f32 v133, v26, v173, -v133
    v_fma_f32 v134, v26, v174, -v134
    v_fma_f32 v135, v26, v175, -v135
    v_mfma_f32_16x16x32_bf16 v[56:59], v[216:219], v[32:35], v[56:59]
    v_cvt_pk_bf16_f32 v212, v176, v177
    v_cvt_pk_bf16_f32 v213, v178, v179
    v_cvt_pk_bf16_f32 v214, v180, v181
    v_mfma_f32_16x16x32_bf16 v[76:79], v[216:219], v[36:39], v[76:79]
    v_cvt_pk_bf16_f32 v215, v182, v183
    v_fma_f32 v136, v27, v176, -v136
    v_fma_f32 v137, v27, v177, -v137
    v_mfma_f32_16x16x32_bf16 v[96:99], v[216:219], v[40:43], v[96:99]
    v_fma_f32 v138, v27, v178, -v138
    v_fma_f32 v139, v27, v179, -v139
    v_fma_f32 v140, v27, v180, -v140
    v_mfma_f32_16x16x32_bf16 v[116:119], v[216:219], v[44:47], v[116:119]
    v_fma_f32 v141, v27, v181, -v141
    v_fma_f32 v142, v27, v182, -v142
    v_fma_f32 v143, v27, v183, -v143
    v_mfma_f32_16x16x32_bf16 v[60:63], v[220:223], v[32:35], v[60:63]
    v_cvt_pk_bf16_f32 v216, v184, v185
    v_cvt_pk_bf16_f32 v217, v186, v187
    v_cvt_pk_bf16_f32 v218, v188, v189
    v_mfma_f32_16x16x32_bf16 v[80:83], v[220:223], v[36:39], v[80:83]
    v_cvt_pk_bf16_f32 v219, v190, v191
    v_fma_f32 v144, v28, v184, -v144
    v_fma_f32 v145, v28, v185, -v145
    v_mfma_f32_16x16x32_bf16 v[100:103], v[220:223], v[40:43], v[100:103]
    v_fma_f32 v146, v28, v186, -v146
    v_fma_f32 v147, v28, v187, -v147
    v_fma_f32 v148, v28, v188, -v148
    v_mfma_f32_16x16x32_bf16 v[120:123], v[220:223], v[44:47], v[120:123]
    v_fma_f32 v149, v28, v189, -v149
    v_fma_f32 v150, v28, v190, -v150
    v_fma_f32 v151, v28, v191, -v151
    v_mfma_f32_16x16x32_bf16 v[64:67], v[224:227], v[32:35], v[64:67]
    v_cvt_pk_bf16_f32 v220, v192, v193
    v_cvt_pk_bf16_f32 v221, v194, v195
    v_cvt_pk_bf16_f32 v222, v196, v197
    v_mfma_f32_16x16x32_bf16 v[84:87], v[224:227], v[36:39], v[84:87]
    v_cvt_pk_bf16_f32 v223, v198, v199
    v_fma_f32 v152, v29, v192, -v152
    v_fma_f32 v153, v29, v193, -v153
    v_mfma_f32_16x16x32_bf16 v[104:107], v[224:227], v[40:43], v[104:107]
    v_fma_f32 v154, v29, v194, -v154
    v_fma_f32 v155, v29, v195, -v155
    v_fma_f32 v156, v29, v196, -v156
    v_mfma_f32_16x16x32_bf16 v[124:127], v[224:227], v[44:47], v[124:127]
    v_fma_f32 v157, v29, v197, -v157
    v_fma_f32 v158, v29, v198, -v158
    v_fma_f32 v159, v29, v199, -v159
    v_cvt_pk_bf16_f32 v224, v200, v201
    v_cvt_pk_bf16_f32 v225, v202, v203
    v_cvt_pk_bf16_f32 v226, v204, v205
    v_cvt_pk_bf16_f32 v227, v206, v207
    v_fma_f32 v160, v30, v200, -v160
    v_fma_f32 v161, v30, v201, -v161
    v_fma_f32 v162, v30, v202, -v162
    v_fma_f32 v163, v30, v203, -v163
    v_fma_f32 v164, v30, v204, -v164
    v_fma_f32 v165, v30, v205, -v165
    v_fma_f32 v166, v30, v206, -v166
    v_fma_f32 v167, v30, v207, -v167
    s_waitcnt lgkmcnt(0)
    v_mfma_f32_16x16x32_bf16 v[48:51], v[208:211], v[228:231], v[48:51]
    ds_read_b128 v[32:35], v12 offset:256
    v_mfma_f32_16x16x32_bf16 v[68:71], v[208:211], v[232:235], v[68:71]
    ds_read_b128 v[36:39], v12 offset:5376
    v_mfma_f32_16x16x32_bf16 v[88:91], v[208:211], v[236:239], v[88:91]
    ds_read_b128 v[40:43], v12 offset:10496
    v_mfma_f32_16x16x32_bf16 v[108:111], v[208:211], v[240:243], v[108:111]
    ds_read_b128 v[44:47], v12 offset:15616
    v_mfma_f32_16x16x32_bf16 v[52:55], v[212:215], v[228:231], v[52:55]
    v_cvt_pk_bf16_f32 v208, v128, v129
    v_cvt_pk_bf16_f32 v209, v130, v131
    v_cvt_pk_bf16_f32 v210, v132, v133
    v_mfma_f32_16x16x32_bf16 v[72:75], v[212:215], v[232:235], v[72:75]
    v_cvt_pk_bf16_f32 v211, v134, v135
    v_fma_f32 v168, v26, v128, -v168
    v_fma_f32 v169, v26, v129, -v169
    v_mfma_f32_16x16x32_bf16 v[92:95], v[212:215], v[236:239], v[92:95]
    v_fma_f32 v170, v26, v130, -v170
    v_fma_f32 v171, v26, v131, -v171
    v_fma_f32 v172, v26, v132, -v172
    v_mfma_f32_16x16x32_bf16 v[112:115], v[212:215], v[240:243], v[112:115]
    v_fma_f32 v173, v26, v133, -v173
    v_fma_f32 v174, v26, v134, -v174
    v_fma_f32 v175, v26, v135, -v175
    v_mfma_f32_16x16x32_bf16 v[56:59], v[216:219], v[228:231], v[56:59]
    v_cvt_pk_bf16_f32 v212, v136, v137
    v_cvt_pk_bf16_f32 v213, v138, v139
    v_cvt_pk_bf16_f32 v214, v140, v141
    v_mfma_f32_16x16x32_bf16 v[76:79], v[216:219], v[232:235], v[76:79]
    v_cvt_pk_bf16_f32 v215, v142, v143
    v_fma_f32 v176, v27, v136, -v176
    v_fma_f32 v177, v27, v137, -v177
    v_mfma_f32_16x16x32_bf16 v[96:99], v[216:219], v[236:239], v[96:99]
    v_fma_f32 v178, v27, v138, -v178
    v_fma_f32 v179, v27, v139, -v179
    v_fma_f32 v180, v27, v140, -v180
    v_mfma_f32_16x16x32_bf16 v[116:119], v[216:219], v[240:243], v[116:119]
    v_fma_f32 v181, v27, v141, -v181
    v_fma_f32 v182, v27, v142, -v182
    v_fma_f32 v183, v27, v143, -v183
    v_mfma_f32_16x16x32_bf16 v[60:63], v[220:223], v[228:231], v[60:63]
    v_cvt_pk_bf16_f32 v216, v144, v145
    v_cvt_pk_bf16_f32 v217, v146, v147
    v_cvt_pk_bf16_f32 v218, v148, v149
    v_mfma_f32_16x16x32_bf16 v[80:83], v[220:223], v[232:235], v[80:83]
    v_cvt_pk_bf16_f32 v219, v150, v151
    v_fma_f32 v184, v28, v144, -v184
    v_fma_f32 v185, v28, v145, -v185
    v_mfma_f32_16x16x32_bf16 v[100:103], v[220:223], v[236:239], v[100:103]
    v_fma_f32 v186, v28, v146, -v186
    v_fma_f32 v187, v28, v147, -v187
    v_fma_f32 v188, v28, v148, -v188
    v_mfma_f32_16x16x32_bf16 v[120:123], v[220:223], v[240:243], v[120:123]
    v_fma_f32 v189, v28, v149, -v189
    v_fma_f32 v190, v28, v150, -v190
    v_fma_f32 v191, v28, v151, -v191
    v_mfma_f32_16x16x32_bf16 v[64:67], v[224:227], v[228:231], v[64:67]
    v_cvt_pk_bf16_f32 v220, v152, v153
    v_cvt_pk_bf16_f32 v221, v154, v155
    v_cvt_pk_bf16_f32 v222, v156, v157
    v_mfma_f32_16x16x32_bf16 v[84:87], v[224:227], v[232:235], v[84:87]
    v_cvt_pk_bf16_f32 v223, v158, v159
    v_fma_f32 v192, v29, v152, -v192
    v_fma_f32 v193, v29, v153, -v193
    v_mfma_f32_16x16x32_bf16 v[104:107], v[224:227], v[236:239], v[104:107]
    v_fma_f32 v194, v29, v154, -v194
    v_fma_f32 v195, v29, v155, -v195
    v_fma_f32 v196, v29, v156, -v196
    v_mfma_f32_16x16x32_bf16 v[124:127], v[224:227], v[240:243], v[124:127]
    v_fma_f32 v197, v29, v157, -v197
    v_fma_f32 v198, v29, v158, -v198
    v_fma_f32 v199, v29, v159, -v199
    v_cvt_pk_bf16_f32 v224, v160, v161
    v_cvt_pk_bf16_f32 v225, v162, v163
    v_cvt_pk_bf16_f32 v226, v164, v165
    v_cvt_pk_bf16_f32 v227, v166, v167
    v_fma_f32 v200, v30, v160, -v200
    v_fma_f32 v201, v30, v161, -v201
    v_fma_f32 v202, v30, v162, -v202
    v_fma_f32 v203, v30, v163, -v203
    v_fma_f32 v204, v30, v164, -v204
    v_fma_f32 v205, v30, v165, -v205
    v_fma_f32 v206, v30, v166, -v206
    v_fma_f32 v207, v30, v167, -v207
    s_waitcnt lgkmcnt(0)
    v_mfma_f32_16x16x32_bf16 v[48:51], v[208:211], v[32:35], v[48:51]
    ds_read_b128 v[228:231], v12 offset:20480
    v_mfma_f32_16x16x32_bf16 v[68:71], v[208:211], v[36:39], v[68:71]
    ds_read_b128 v[232:235], v12 offset:25600
    v_mfma_f32_16x16x32_bf16 v[88:91], v[208:211], v[40:43], v[88:91]
    ds_read_b128 v[236:239], v12 offset:30720
    v_mfma_f32_16x16x32_bf16 v[108:111], v[208:211], v[44:47], v[108:111]
    ds_read_b128 v[240:243], v12 offset:35840
    v_mfma_f32_16x16x32_bf16 v[52:55], v[212:215], v[32:35], v[52:55]
    v_cvt_pk_bf16_f32 v208, v168, v169
    v_cvt_pk_bf16_f32 v209, v170, v171
    v_cvt_pk_bf16_f32 v210, v172, v173
    v_mfma_f32_16x16x32_bf16 v[72:75], v[212:215], v[36:39], v[72:75]
    v_cvt_pk_bf16_f32 v211, v174, v175
    v_fma_f32 v128, v26, v168, -v128
    v_fma_f32 v129, v26, v169, -v129
    v_mfma_f32_16x16x32_bf16 v[92:95], v[212:215], v[40:43], v[92:95]
    v_fma_f32 v130, v26, v170, -v130
    v_fma_f32 v131, v26, v171, -v131
    v_fma_f32 v132, v26, v172, -v132
    v_mfma_f32_16x16x32_bf16 v[112:115], v[212:215], v[44:47], v[112:115]
    v_fma_f32 v133, v26, v173, -v133
    v_fma_f32 v134, v26, v174, -v134
    v_fma_f32 v135, v26, v175, -v135
    v_mfma_f32_16x16x32_bf16 v[56:59], v[216:219], v[32:35], v[56:59]
    v_cvt_pk_bf16_f32 v212, v176, v177
    v_cvt_pk_bf16_f32 v213, v178, v179
    v_cvt_pk_bf16_f32 v214, v180, v181
    v_mfma_f32_16x16x32_bf16 v[76:79], v[216:219], v[36:39], v[76:79]
    v_cvt_pk_bf16_f32 v215, v182, v183
    v_fma_f32 v136, v27, v176, -v136
    v_fma_f32 v137, v27, v177, -v137
    v_mfma_f32_16x16x32_bf16 v[96:99], v[216:219], v[40:43], v[96:99]
    v_fma_f32 v138, v27, v178, -v138
    v_fma_f32 v139, v27, v179, -v139
    v_fma_f32 v140, v27, v180, -v140
    v_mfma_f32_16x16x32_bf16 v[116:119], v[216:219], v[44:47], v[116:119]
    v_fma_f32 v141, v27, v181, -v141
    v_fma_f32 v142, v27, v182, -v142
    v_fma_f32 v143, v27, v183, -v143
    v_mfma_f32_16x16x32_bf16 v[60:63], v[220:223], v[32:35], v[60:63]
    v_cvt_pk_bf16_f32 v216, v184, v185
    v_cvt_pk_bf16_f32 v217, v186, v187
    v_cvt_pk_bf16_f32 v218, v188, v189
    v_mfma_f32_16x16x32_bf16 v[80:83], v[220:223], v[36:39], v[80:83]
    v_cvt_pk_bf16_f32 v219, v190, v191
    v_fma_f32 v144, v28, v184, -v144
    v_fma_f32 v145, v28, v185, -v145
    v_mfma_f32_16x16x32_bf16 v[100:103], v[220:223], v[40:43], v[100:103]
    v_fma_f32 v146, v28, v186, -v146
    v_fma_f32 v147, v28, v187, -v147
    v_fma_f32 v148, v28, v188, -v148
    v_mfma_f32_16x16x32_bf16 v[120:123], v[220:223], v[44:47], v[120:123]
    v_fma_f32 v149, v28, v189, -v149
    v_fma_f32 v150, v28, v190, -v150
    v_fma_f32 v151, v28, v191, -v151
    v_mfma_f32_16x16x32_bf16 v[64:67], v[224:227], v[32:35], v[64:67]
    v_cvt_pk_bf16_f32 v220, v192, v193
    v_cvt_pk_bf16_f32 v221, v194, v195
    v_cvt_pk_bf16_f32 v222, v196, v197
    v_mfma_f32_16x16x32_bf16 v[84:87], v[224:227], v[36:39], v[84:87]
    v_cvt_pk_bf16_f32 v223, v198, v199
    v_fma_f32 v152, v29, v192, -v152
    v_fma_f32 v153, v29, v193, -v153
    v_mfma_f32_16x16x32_bf16 v[104:107], v[224:227], v[40:43], v[104:107]
    v_fma_f32 v154, v29, v194, -v154
    v_fma_f32 v155, v29, v195, -v155
    v_fma_f32 v156, v29, v196, -v156
    v_mfma_f32_16x16x32_bf16 v[124:127], v[224:227], v[44:47], v[124:127]
    v_fma_f32 v157, v29, v197, -v157
    v_fma_f32 v158, v29, v198, -v158
    v_fma_f32 v159, v29, v199, -v159
    v_cvt_pk_bf16_f32 v224, v200, v201
    v_cvt_pk_bf16_f32 v225, v202, v203
    v_cvt_pk_bf16_f32 v226, v204, v205
    v_cvt_pk_bf16_f32 v227, v206, v207
    v_fma_f32 v160, v30, v200, -v160
    v_fma_f32 v161, v30, v201, -v161
    v_fma_f32 v162, v30, v202, -v162
    v_fma_f32 v163, v30, v203, -v163
    v_fma_f32 v164, v30, v204, -v164
    v_fma_f32 v165, v30, v205, -v165
    v_fma_f32 v166, v30, v206, -v166
    v_fma_f32 v167, v30, v207, -v167
    s_waitcnt lgkmcnt(0)
    v_mfma_f32_16x16x32_bf16 v[48:51], v[208:211], v[228:231], v[48:51]
    ds_read_b128 v[32:35], v12 offset:20544
    v_mfma_f32_16x16x32_bf16 v[68:71], v[208:211], v[232:235], v[68:71]
    ds_read_b128 v[36:39], v12 offset:25664
    v_mfma_f32_16x16x32_bf16 v[88:91], v[208:211], v[236:239], v[88:91]
    ds_read_b128 v[40:43], v12 offset:30784
    v_mfma_f32_16x16x32_bf16 v[108:111], v[208:211], v[240:243], v[108:111]
    ds_read_b128 v[44:47], v12 offset:35904
    v_mfma_f32_16x16x32_bf16 v[52:55], v[212:215], v[228:231], v[52:55]
    v_cvt_pk_bf16_f32 v208, v128, v129
    v_cvt_pk_bf16_f32 v209, v130, v131
    v_cvt_pk_bf16_f32 v210, v132, v133
    v_mfma_f32_16x16x32_bf16 v[72:75], v[212:215], v[232:235], v[72:75]
    v_cvt_pk_bf16_f32 v211, v134, v135
    v_fma_f32 v168, v26, v128, -v168
    v_fma_f32 v169, v26, v129, -v169
    v_mfma_f32_16x16x32_bf16 v[92:95], v[212:215], v[236:239], v[92:95]
    v_fma_f32 v170, v26, v130, -v170
    v_fma_f32 v171, v26, v131, -v171
    v_fma_f32 v172, v26, v132, -v172
    v_mfma_f32_16x16x32_bf16 v[112:115], v[212:215], v[240:243], v[112:115]
    v_fma_f32 v173, v26, v133, -v173
    v_fma_f32 v174, v26, v134, -v174
    v_fma_f32 v175, v26, v135, -v175
    v_mfma_f32_16x16x32_bf16 v[56:59], v[216:219], v[228:231], v[56:59]
    v_cvt_pk_bf16_f32 v212, v136, v137
    v_cvt_pk_bf16_f32 v213, v138, v139
    v_cvt_pk_bf16_f32 v214, v140, v141
    v_mfma_f32_16x16x32_bf16 v[76:79], v[216:219], v[232:235], v[76:79]
    v_cvt_pk_bf16_f32 v215, v142, v143
    v_fma_f32 v176, v27, v136, -v176
    v_fma_f32 v177, v27, v137, -v177
    v_mfma_f32_16x16x32_bf16 v[96:99], v[216:219], v[236:239], v[96:99]
    v_fma_f32 v178, v27, v138, -v178
    v_fma_f32 v179, v27, v139, -v179
    v_fma_f32 v180, v27, v140, -v180
    v_mfma_f32_16x16x32_bf16 v[116:119], v[216:219], v[240:243], v[116:119]
    v_fma_f32 v181, v27, v141, -v181
    v_fma_f32 v182, v27, v142, -v182
    v_fma_f32 v183, v27, v143, -v183
    v_mfma_f32_16x16x32_bf16 v[60:63], v[220:223], v[228:231], v[60:63]
    v_cvt_pk_bf16_f32 v216, v144, v145
    v_cvt_pk_bf16_f32 v217, v146, v147
    v_cvt_pk_bf16_f32 v218, v148, v149
    v_mfma_f32_16x16x32_bf16 v[80:83], v[220:223], v[232:235], v[80:83]
    v_cvt_pk_bf16_f32 v219, v150, v151
    v_fma_f32 v184, v28, v144, -v184
    v_fma_f32 v185, v28, v145, -v185
    v_mfma_f32_16x16x32_bf16 v[100:103], v[220:223], v[236:239], v[100:103]
    v_fma_f32 v186, v28, v146, -v186
    v_fma_f32 v187, v28, v147, -v187
    v_fma_f32 v188, v28, v148, -v188
    v_mfma_f32_16x16x32_bf16 v[120:123], v[220:223], v[240:243], v[120:123]
    v_fma_f32 v189, v28, v149, -v189
    v_fma_f32 v190, v28, v150, -v190
    v_fma_f32 v191, v28, v151, -v191
    v_mfma_f32_16x16x32_bf16 v[64:67], v[224:227], v[228:231], v[64:67]
    v_cvt_pk_bf16_f32 v220, v152, v153
    v_cvt_pk_bf16_f32 v221, v154, v155
    v_cvt_pk_bf16_f32 v222, v156, v157
    v_mfma_f32_16x16x32_bf16 v[84:87], v[224:227], v[232:235], v[84:87]
    v_cvt_pk_bf16_f32 v223, v158, v159
    v_fma_f32 v192, v29, v152, -v192
    v_fma_f32 v193, v29, v153, -v193
    v_mfma_f32_16x16x32_bf16 v[104:107], v[224:227], v[236:239], v[104:107]
    v_fma_f32 v194, v29, v154, -v194
    v_fma_f32 v195, v29, v155, -v195
    v_fma_f32 v196, v29, v156, -v196
    v_mfma_f32_16x16x32_bf16 v[124:127], v[224:227], v[240:243], v[124:127]
    v_fma_f32 v197, v29, v157, -v197
    v_fma_f32 v198, v29, v158, -v198
    v_fma_f32 v199, v29, v159, -v199
    v_cvt_pk_bf16_f32 v224, v160, v161
    v_cvt_pk_bf16_f32 v225, v162, v163
    v_cvt_pk_bf16_f32 v226, v164, v165
    v_cvt_pk_bf16_f32 v227, v166, v167
    v_fma_f32 v200, v30, v160, -v200
    v_fma_f32 v201, v30, v161, -v201
    v_fma_f32 v202, v30, v162, -v202
    v_fma_f32 v203, v30, v163, -v203
    v_fma_f32 v204, v30, v164, -v204
    v_fma_f32 v205, v30, v165, -v205
    v_fma_f32 v206, v30, v166, -v206
    v_fma_f32 v207, v30, v167, -v207
    s_waitcnt lgkmcnt(0)
    v_mfma_f32_16x16x32_bf16 v[48:51], v[208:211], v[32:35], v[48:51]
    ds_read_b128 v[228:231], v12 offset:20608
    v_mfma_f32_16x16x32_bf16 v[68:71], v[208:211], v[36:39], v[68:71]
    ds_read_b128 v[232:235], v12 offset:25728
    v_mfma_f32_16x16x32_bf16 v[88:91], v[208:211], v[40:43], v[88:91]
    ds_read_b128 v[236:239], v12 offset:30848
    v_mfma_f32_16x16x32_bf16 v[108:111], v[208:211], v[44:47], v[108:111]
    ds_read_b128 v[240:243], v12 offset:35968
    v_mfma_f32_16x16x32_bf16 v[52:55], v[212:215], v[32:35], v[52:55]
    v_cvt_pk_bf16_f32 v208, v168, v169
    v_cvt_pk_bf16_f32 v209, v170, v171
    v_cvt_pk_bf16_f32 v210, v172, v173
    v_mfma_f32_16x16x32_bf16 v[72:75], v[212:215], v[36:39], v[72:75]
    v_cvt_pk_bf16_f32 v211, v174, v175
    v_fma_f32 v128, v26, v168, -v128
    v_fma_f32 v129, v26, v169, -v129
    v_mfma_f32_16x16x32_bf16 v[92:95], v[212:215], v[40:43], v[92:95]
    v_fma_f32 v130, v26, v170, -v130
    v_fma_f32 v131, v26, v171, -v131
    v_fma_f32 v132, v26, v172, -v132
    v_mfma_f32_16x16x32_bf16 v[112:115], v[212:215], v[44:47], v[112:115]
    v_fma_f32 v133, v26, v173, -v133
    v_fma_f32 v134, v26, v174, -v134
    v_fma_f32 v135, v26, v175, -v135
    v_mfma_f32_16x16x32_bf16 v[56:59], v[216:219], v[32:35], v[56:59]
    v_cvt_pk_bf16_f32 v212, v176, v177
    v_cvt_pk_bf16_f32 v213, v178, v179
    v_cvt_pk_bf16_f32 v214, v180, v181
    v_mfma_f32_16x16x32_bf16 v[76:79], v[216:219], v[36:39], v[76:79]
    v_cvt_pk_bf16_f32 v215, v182, v183
    v_fma_f32 v136, v27, v176, -v136
    v_fma_f32 v137, v27, v177, -v137
    v_mfma_f32_16x16x32_bf16 v[96:99], v[216:219], v[40:43], v[96:99]
    v_fma_f32 v138, v27, v178, -v138
    v_fma_f32 v139, v27, v179, -v139
    v_fma_f32 v140, v27, v180, -v140
    v_mfma_f32_16x16x32_bf16 v[116:119], v[216:219], v[44:47], v[116:119]
    v_fma_f32 v141, v27, v181, -v141
    v_fma_f32 v142, v27, v182, -v142
    v_fma_f32 v143, v27, v183, -v143
    v_mfma_f32_16x16x32_bf16 v[60:63], v[220:223], v[32:35], v[60:63]
    v_cvt_pk_bf16_f32 v216, v184, v185
    v_cvt_pk_bf16_f32 v217, v186, v187
    v_cvt_pk_bf16_f32 v218, v188, v189
    v_mfma_f32_16x16x32_bf16 v[80:83], v[220:223], v[36:39], v[80:83]
    v_cvt_pk_bf16_f32 v219, v190, v191
    v_fma_f32 v144, v28, v184, -v144
    v_fma_f32 v145, v28, v185, -v145
    v_mfma_f32_16x16x32_bf16 v[100:103], v[220:223], v[40:43], v[100:103]
    v_fma_f32 v146, v28, v186, -v146
    v_fma_f32 v147, v28, v187, -v147
    v_fma_f32 v148, v28, v188, -v148
    v_mfma_f32_16x16x32_bf16 v[120:123], v[220:223], v[44:47], v[120:123]
    v_fma_f32 v149, v28, v189, -v149
    v_fma_f32 v150, v28, v190, -v150
    v_fma_f32 v151, v28, v191, -v151
    v_mfma_f32_16x16x32_bf16 v[64:67], v[224:227], v[32:35], v[64:67]
    v_cvt_pk_bf16_f32 v220, v192, v193
    v_cvt_pk_bf16_f32 v221, v194, v195
    v_cvt_pk_bf16_f32 v222, v196, v197
    v_mfma_f32_16x16x32_bf16 v[84:87], v[224:227], v[36:39], v[84:87]
    v_cvt_pk_bf16_f32 v223, v198, v199
    v_fma_f32 v152, v29, v192, -v152
    v_fma_f32 v153, v29, v193, -v153
    v_mfma_f32_16x16x32_bf16 v[104:107], v[224:227], v[40:43], v[104:107]
    v_fma_f32 v154, v29, v194, -v154
    v_fma_f32 v155, v29, v195, -v155
    v_fma_f32 v156, v29, v196, -v156
    v_mfma_f32_16x16x32_bf16 v[124:127], v[224:227], v[44:47], v[124:127]
    v_fma_f32 v157, v29, v197, -v157
    v_fma_f32 v158, v29, v198, -v158
    v_fma_f32 v159, v29, v199, -v159
    v_cvt_pk_bf16_f32 v224, v200, v201
    v_cvt_pk_bf16_f32 v225, v202, v203
    v_cvt_pk_bf16_f32 v226, v204, v205
    v_cvt_pk_bf16_f32 v227, v206, v207
    v_fma_f32 v160, v30, v200, -v160
    v_fma_f32 v161, v30, v201, -v161
    v_fma_f32 v162, v30, v202, -v162
    v_fma_f32 v163, v30, v203, -v163
    v_fma_f32 v164, v30, v204, -v164
    v_fma_f32 v165, v30, v205, -v165
    v_fma_f32 v166, v30, v206, -v166
    v_fma_f32 v167, v30, v207, -v167
    s_waitcnt lgkmcnt(0)
    v_mfma_f32_16x16x32_bf16 v[48:51], v[208:211], v[228:231], v[48:51]
    ds_read_b128 v[32:35], v12 offset:20672
    v_mfma_f32_16x16x32_bf16 v[68:71], v[208:211], v[232:235], v[68:71]
    ds_read_b128 v[36:39], v12 offset:25792
    v_mfma_f32_16x16x32_bf16 v[88:91], v[208:211], v[236:239], v[88:91]
    ds_read_b128 v[40:43], v12 offset:30912
    v_mfma_f32_16x16x32_bf16 v[108:111], v[208:211], v[240:243], v[108:111]
    ds_read_b128 v[44:47], v12 offset:36032
    v_mfma_f32_16x16x32_bf16 v[52:55], v[212:215], v[228:231], v[52:55]
    v_cvt_pk_bf16_f32 v208, v128, v129
    v_cvt_pk_bf16_f32 v209, v130, v131
    v_cvt_pk_bf16_f32 v210, v132, v133
    v_mfma_f32_16x16x32_bf16 v[72:75], v[212:215], v[232:235], v[72:75]
    v_cvt_pk_bf16_f32 v211, v134, v135
    v_fma_f32 v168, v26, v128, -v168
    v_fma_f32 v169, v26, v129, -v169
    v_mfma_f32_16x16x32_bf16 v[92:95], v[212:215], v[236:239], v[92:95]
    v_fma_f32 v170, v26, v130, -v170
    v_fma_f32 v171, v26, v131, -v171
    v_fma_f32 v172, v26, v132, -v172
    v_mfma_f32_16x16x32_bf16 v[112:115], v[212:215], v[240:243], v[112:115]
    v_fma_f32 v173, v26, v133, -v173
    v_fma_f32 v174, v26, v134, -v174
    v_fma_f32 v175, v26, v135, -v175
    v_mfma_f32_16x16x32_bf16 v[56:59], v[216:219], v[228:231], v[56:59]
    v_cvt_pk_bf16_f32 v212, v136, v137
    v_cvt_pk_bf16_f32 v213, v138, v139
    v_cvt_pk_bf16_f32 v214, v140, v141
    v_mfma_f32_16x16x32_bf16 v[76:79], v[216:219], v[232:235], v[76:79]
    v_cvt_pk_bf16_f32 v215, v142, v143
    v_fma_f32 v176, v27, v136, -v176
    v_fma_f32 v177, v27, v137, -v177
    v_mfma_f32_16x16x32_bf16 v[96:99], v[216:219], v[236:239], v[96:99]
    v_fma_f32 v178, v27, v138, -v178
    v_fma_f32 v179, v27, v139, -v179
    v_fma_f32 v180, v27, v140, -v180
    v_mfma_f32_16x16x32_bf16 v[116:119], v[216:219], v[240:243], v[116:119]
    v_fma_f32 v181, v27, v141, -v181
    v_fma_f32 v182, v27, v142, -v182
    v_fma_f32 v183, v27, v143, -v183
    v_mfma_f32_16x16x32_bf16 v[60:63], v[220:223], v[228:231], v[60:63]
    v_cvt_pk_bf16_f32 v216, v144, v145
    v_cvt_pk_bf16_f32 v217, v146, v147
    v_cvt_pk_bf16_f32 v218, v148, v149
    v_mfma_f32_16x16x32_bf16 v[80:83], v[220:223], v[232:235], v[80:83]
    v_cvt_pk_bf16_f32 v219, v150, v151
    v_fma_f32 v184, v28, v144, -v184
    v_fma_f32 v185, v28, v145, -v185
    v_mfma_f32_16x16x32_bf16 v[100:103], v[220:223], v[236:239], v[100:103]
    v_fma_f32 v186, v28, v146, -v186
    v_fma_f32 v187, v28, v147, -v187
    v_fma_f32 v188, v28, v148, -v188
    v_mfma_f32_16x16x32_bf16 v[120:123], v[220:223], v[240:243], v[120:123]
    v_fma_f32 v189, v28, v149, -v189
    v_fma_f32 v190, v28, v150, -v190
    v_fma_f32 v191, v28, v151, -v191
    v_mfma_f32_16x16x32_bf16 v[64:67], v[224:227], v[228:231], v[64:67]
    v_cvt_pk_bf16_f32 v220, v152, v153
    v_cvt_pk_bf16_f32 v221, v154, v155
    v_cvt_pk_bf16_f32 v222, v156, v157
    v_mfma_f32_16x16x32_bf16 v[84:87], v[224:227], v[232:235], v[84:87]
    v_cvt_pk_bf16_f32 v223, v158, v159
    v_fma_f32 v192, v29, v152, -v192
    v_fma_f32 v193, v29, v153, -v193
    v_mfma_f32_16x16x32_bf16 v[104:107], v[224:227], v[236:239], v[104:107]
    v_fma_f32 v194, v29, v154, -v194
    v_fma_f32 v195, v29, v155, -v195
    v_fma_f32 v196, v29, v156, -v196
    v_mfma_f32_16x16x32_bf16 v[124:127], v[224:227], v[240:243], v[124:127]
    v_fma_f32 v197, v29, v157, -v197
    v_fma_f32 v198, v29, v158, -v198
    v_fma_f32 v199, v29, v159, -v199
    v_cvt_pk_bf16_f32 v224, v160, v161
    v_cvt_pk_bf16_f32 v225, v162, v163
    v_cvt_pk_bf16_f32 v226, v164, v165
    v_cvt_pk_bf16_f32 v227, v166, v167
    v_fma_f32 v200, v30, v160, -v200
    v_fma_f32 v201, v30, v161, -v201
    v_fma_f32 v202, v30, v162, -v202
    v_fma_f32 v203, v30, v163, -v203
    v_fma_f32 v204, v30, v164, -v204
    v_fma_f32 v205, v30, v165, -v205
    v_fma_f32 v206, v30, v166, -v206
    v_fma_f32 v207, v30, v167, -v207
    s_waitcnt lgkmcnt(0)
    v_mfma_f32_16x16x32_bf16 v[48:51], v[208:211], v[32:35], v[48:51]
    ds_read_b128 v[228:231], v12 offset:20736
    v_mfma_f32_16x16x32_bf16 v[68:71], v[208:211], v[36:39], v[68:71]
    ds_read_b128 v[232:235], v12 offset:25856
    v_mfma_f32_16x16x32_bf16 v[88:91], v[208:211], v[40:43], v[88:91]
    ds_read_b128 v[236:239], v12 offset:30976
    v_mfma_f32_16x16x32_bf16 v[108:111], v[208:211], v[44:47], v[108:111]
    ds_read_b128 v[240:243], v12 offset:36096
    v_mfma_f32_16x16x32_bf16 v[52:55], v[212:215], v[32:35], v[52:55]
    v_cvt_pk_bf16_f32 v208, v168, v169
    v_cvt_pk_bf16_f32 v209, v170, v171
    v_cvt_pk_bf16_f32 v210, v172, v173
    v_mfma_f32_16x16x32_bf16 v[72:75], v[212:215], v[36:39], v[72:75]
    v_cvt_pk_bf16_f32 v211, v174, v175
    v_mfma_f32_16x16x32_bf16 v[92:95], v[212:215], v[40:43], v[92:95]
    v_mfma_f32_16x16x32_bf16 v[112:115], v[212:215], v[44:47], v[112:115]
    v_mfma_f32_16x16x32_bf16 v[56:59], v[216:219], v[32:35], v[56:59]
    v_cvt_pk_bf16_f32 v212, v176, v177
    v_cvt_pk_bf16_f32 v213, v178, v179
    v_cvt_pk_bf16_f32 v214, v180, v181
    v_mfma_f32_16x16x32_bf16 v[76:79], v[216:219], v[36:39], v[76:79]
    v_cvt_pk_bf16_f32 v215, v182, v183
    v_mfma_f32_16x16x32_bf16 v[96:99], v[216:219], v[40:43], v[96:99]
    v_mfma_f32_16x16x32_bf16 v[116:119], v[216:219], v[44:47], v[116:119]
    v_mfma_f32_16x16x32_bf16 v[60:63], v[220:223], v[32:35], v[60:63]
    v_cvt_pk_bf16_f32 v216, v184, v185
    v_cvt_pk_bf16_f32 v217, v186, v187
    v_cvt_pk_bf16_f32 v218, v188, v189
    v_mfma_f32_16x16x32_bf16 v[80:83], v[220:223], v[36:39], v[80:83]
    v_cvt_pk_bf16_f32 v219, v190, v191
    v_mfma_f32_16x16x32_bf16 v[100:103], v[220:223], v[40:43], v[100:103]
    v_mfma_f32_16x16x32_bf16 v[120:123], v[220:223], v[44:47], v[120:123]
    v_mfma_f32_16x16x32_bf16 v[64:67], v[224:227], v[32:35], v[64:67]
    v_cvt_pk_bf16_f32 v220, v192, v193
    v_cvt_pk_bf16_f32 v221, v194, v195
    v_cvt_pk_bf16_f32 v222, v196, v197
    v_mfma_f32_16x16x32_bf16 v[84:87], v[224:227], v[36:39], v[84:87]
    v_cvt_pk_bf16_f32 v223, v198, v199
    v_mfma_f32_16x16x32_bf16 v[104:107], v[224:227], v[40:43], v[104:107]
    v_mfma_f32_16x16x32_bf16 v[124:127], v[224:227], v[44:47], v[124:127]
    v_cvt_pk_bf16_f32 v224, v200, v201
    v_cvt_pk_bf16_f32 v225, v202, v203
    v_cvt_pk_bf16_f32 v226, v204, v205
    v_cvt_pk_bf16_f32 v227, v206, v207
    s_waitcnt lgkmcnt(0)
    v_mfma_f32_16x16x32_bf16 v[48:51], v[208:211], v[228:231], v[48:51]
    v_mfma_f32_16x16x32_bf16 v[68:71], v[208:211], v[232:235], v[68:71]
    v_mfma_f32_16x16x32_bf16 v[88:91], v[208:211], v[236:239], v[88:91]
    v_mfma_f32_16x16x32_bf16 v[108:111], v[208:211], v[240:243], v[108:111]
    v_mfma_f32_16x16x32_bf16 v[52:55], v[212:215], v[228:231], v[52:55]
    v_mfma_f32_16x16x32_bf16 v[72:75], v[212:215], v[232:235], v[72:75]
    v_mfma_f32_16x16x32_bf16 v[92:95], v[212:215], v[236:239], v[92:95]
    v_mfma_f32_16x16x32_bf16 v[112:115], v[212:215], v[240:243], v[112:115]
    v_mfma_f32_16x16x32_bf16 v[56:59], v[216:219], v[228:231], v[56:59]
    v_mfma_f32_16x16x32_bf16 v[76:79], v[216:219], v[232:235], v[76:79]
    v_mfma_f32_16x16x32_bf16 v[96:99], v[216:219], v[236:239], v[96:99]
    v_mfma_f32_16x16x32_bf16 v[116:119], v[216:219], v[240:243], v[116:119]
    v_mfma_f32_16x16x32_bf16 v[60:63], v[220:223], v[228:231], v[60:63]
    v_mfma_f32_16x16x32_bf16 v[80:83], v[220:223], v[232:235], v[80:83]
    v_mfma_f32_16x16x32_bf16 v[100:103], v[220:223], v[236:239], v[100:103]
    v_mfma_f32_16x16x32_bf16 v[120:123], v[220:223], v[240:243], v[120:123]
    v_mfma_f32_16x16x32_bf16 v[64:67], v[224:227], v[228:231], v[64:67]
    v_mfma_f32_16x16x32_bf16 v[84:87], v[224:227], v[232:235], v[84:87]
    v_mfma_f32_16x16x32_bf16 v[104:107], v[224:227], v[236:239], v[104:107]
    v_mfma_f32_16x16x32_bf16 v[124:127], v[224:227], v[240:243], v[124:127]
K3_REDUCE:
    s_nop 11
    s_add_u32 s13, s12, 4
    s_lshl_b32 s14, s51, 1
    s_cmp_ge_u32 s12, 6
    s_cselect_b32 s13, s14, s13
    s_mul_i32 s13, s13, 20480
    v_lshl_add_u32 v2, v7, 2, v6
    v_lshlrev_b32 v3, 8, v7
    v_add_u32 v3, s13, v3
    v_add_u32 v4, 0, v2
    v_and_b32 v4, 15, v4
    v_lshl_add_u32 v128, v4, 4, v3
    v_add_u32 v4, 1, v2
    v_and_b32 v4, 15, v4
    v_lshl_add_u32 v129, v4, 4, v3
    v_add_u32 v4, 2, v2
    v_and_b32 v4, 15, v4
    v_lshl_add_u32 v130, v4, 4, v3
    v_add_u32 v4, 3, v2
    v_and_b32 v4, 15, v4
    v_lshl_add_u32 v131, v4, 4, v3
    v_add_u32 v4, 4, v2
    v_and_b32 v4, 15, v4
    v_lshl_add_u32 v132, v4, 4, v3
    s_and_b32 s13, s12, 6
    s_cmp_eq_u32 s13, 4
    s_cbranch_scc1 K3_WDONE
    ds_write_b128 v128, v[48:51] offset:0
    ds_write_b128 v129, v[52:55] offset:1024
    ds_write_b128 v130, v[56:59] offset:2048
    ds_write_b128 v131, v[60:63] offset:3072
    ds_write_b128 v132, v[64:67] offset:4096
    ds_write_b128 v128, v[68:71] offset:5120
    ds_write_b128 v129, v[72:75] offset:6144
    ds_write_b128 v130, v[76:79] offset:7168
    ds_write_b128 v131, v[80:83] offset:8192
    ds_write_b128 v132, v[84:87] offset:9216
    ds_write_b128 v128, v[88:91] offset:10240
    ds_write_b128 v129, v[92:95] offset:11264
    ds_write_b128 v130, v[96:99] offset:12288
    ds_write_b128 v131, v[100:103] offset:13312
    ds_write_b128 v132, v[104:107] offset:14336
    ds_write_b128 v128, v[108:111] offset:15360
    ds_write_b128 v129, v[112:115] offset:16384
    ds_write_b128 v130, v[116:119] offset:17408
    ds_write_b128 v131, v[120:123] offset:18432
    ds_write_b128 v132, v[124:127] offset:19456
    s_waitcnt lgkmcnt(0)
K3_WDONE:
    v_mov_b32 v136, v13
    v_add_u32 v137, 61440, v13
    v_add_u32 v138, 122880, v13
    v_mov_b32 v139, v14
    v_add_u32 v140, 61440, v14
    v_add_u32 v141, 122880, v14
    v_mov_b32 v142, v15
    v_add_u32 v143, 61440, v15
    v_add_u32 v144, 122880, v15
    s_barrier
    ds_read_b128 v[48:51], v137 offset:20480
    ds_read_b128 v[52:55], v140 offset:20480
    ds_read_b128 v[56:59], v143 offset:20480
    ds_read_b128 v[60:63], v137 offset:40960
    ds_read_b128 v[64:67], v140 offset:40960
    ds_read_b128 v[68:71], v143 offset:40960
    ds_read_b128 v[72:75], v138 offset:0
    ds_read_b128 v[76:79], v141 offset:0
    ds_read_b128 v[80:83], v144 offset:0
    ds_read_b128 v[84:87], v138 offset:20480
    ds_read_b128 v[88:91], v141 offset:20480
    ds_read_b128 v[92:95], v144 offset:20480
    s_waitcnt lgkmcnt(6)
    ds_read_b128 v[96:99], v136 offset:0
    ds_read_b128 v[100:103], v139 offset:0
    ds_read_b128 v[104:107], v142 offset:0
    ds_read_b128 v[108:111], v136 offset:40960
    ds_read_b128 v[112:115], v139 offset:40960
    ds_read_b128 v[116:119], v142 offset:40960
    s_waitcnt lgkmcnt(0)
    v_pk_add_f32 v[26:27], v[48:49], v[60:61]
    v_pk_add_f32 v[72:73], v[72:73], v[84:85]
    v_pk_add_f32 v[96:97], v[96:97], v[108:109]
    v_pk_add_f32 v[26:27], v[26:27], v[72:73]
    v_pk_add_f32 v[28:29], v[50:51], v[62:63]
    v_pk_add_f32 v[74:75], v[74:75], v[86:87]
    v_pk_add_f32 v[98:99], v[98:99], v[110:111]
    v_pk_add_f32 v[28:29], v[28:29], v[74:75]
    v_pk_add_f32 v[30:31], v[52:53], v[64:65]
    v_pk_add_f32 v[76:77], v[76:77], v[88:89]
    v_pk_add_f32 v[100:101], v[100:101], v[112:113]
    v_pk_add_f32 v[30:31], v[30:31], v[76:77]
    v_pk_add_f32 v[32:33], v[54:55], v[66:67]
    v_pk_add_f32 v[78:79], v[78:79], v[90:91]
    v_pk_add_f32 v[102:103], v[102:103], v[114:115]
    v_pk_add_f32 v[32:33], v[32:33], v[78:79]
    v_pk_add_f32 v[34:35], v[56:57], v[68:69]
    v_pk_add_f32 v[80:81], v[80:81], v[92:93]
    v_pk_add_f32 v[104:105], v[104:105], v[116:117]
    v_pk_add_f32 v[34:35], v[34:35], v[80:81]
    v_pk_add_f32 v[36:37], v[58:59], v[70:71]
    v_pk_add_f32 v[82:83], v[82:83], v[94:95]
    v_pk_add_f32 v[106:107], v[106:107], v[118:119]
    v_pk_add_f32 v[36:37], v[36:37], v[82:83]
    v_mov_b32 v39, 0xffff0000
    v_mov_b32 v40, 0xbfb8aa3b
    v_mov_b32 v42, 1.0
    s_waitcnt vmcnt(0)
    v_cvt_pk_bf16_f32 v52, v26, v27
    v_cvt_pk_bf16_f32 v58, v28, v29
    v_cvt_pk_bf16_f32 v68, v30, v31
    v_cvt_pk_bf16_f32 v74, v32, v33
    v_cvt_pk_bf16_f32 v53, v96, v97
    v_cvt_pk_bf16_f32 v59, v98, v99
    v_cvt_pk_bf16_f32 v69, v100, v101
    v_cvt_pk_bf16_f32 v75, v102, v103
    v_lshlrev_b32 v48, 16, v52
    v_lshlrev_b32 v54, 16, v58
    v_lshlrev_b32 v64, 16, v68
    v_lshlrev_b32 v70, 16, v74
    v_and_b32 v49, v39, v52
    v_and_b32 v55, v39, v58
    v_and_b32 v65, v39, v68
    v_and_b32 v71, v39, v74
    v_pk_mul_f32 v[50:51], v[48:49], v[40:41] op_sel_hi:[1,0]
    v_pk_mul_f32 v[56:57], v[54:55], v[40:41] op_sel_hi:[1,0]
    v_pk_mul_f32 v[66:67], v[64:65], v[40:41] op_sel_hi:[1,0]
    v_pk_mul_f32 v[72:73], v[70:71], v[40:41] op_sel_hi:[1,0]
    v_exp_f32 v50, v50
    v_exp_f32 v56, v56
    v_exp_f32 v66, v66
    v_exp_f32 v72, v72
    v_exp_f32 v51, v51
    v_exp_f32 v57, v57
    v_exp_f32 v67, v67
    v_exp_f32 v73, v73
    v_pk_add_f32 v[50:51], v[50:51], v[42:43] op_sel_hi:[1,0]
    v_pk_add_f32 v[56:57], v[56:57], v[42:43] op_sel_hi:[1,0]
    v_pk_add_f32 v[66:67], v[66:67], v[42:43] op_sel_hi:[1,0]
    v_pk_add_f32 v[72:73], v[72:73], v[42:43] op_sel_hi:[1,0]
    v_rcp_f32 v50, v50
    v_rcp_f32 v56, v56
    v_rcp_f32 v66, v66
    v_rcp_f32 v72, v72
    v_rcp_f32 v51, v51
    v_rcp_f32 v57, v57
    v_rcp_f32 v67, v67
    v_rcp_f32 v73, v73
    v_pk_mul_f32 v[48:49], v[48:49], v[50:51]
    v_pk_mul_f32 v[54:55], v[54:55], v[56:57]
    v_pk_mul_f32 v[64:65], v[64:65], v[66:67]
    v_pk_mul_f32 v[70:71], v[70:71], v[72:73]
    v_cvt_pk_bf16_f32 v52, v48, v49
    v_cvt_pk_bf16_f32 v58, v54, v55
    v_cvt_pk_bf16_f32 v68, v64, v65
    v_cvt_pk_bf16_f32 v74, v70, v71
    v_lshlrev_b32 v50, 16, v53
    v_lshlrev_b32 v56, 16, v59
    v_lshlrev_b32 v66, 16, v69
    v_lshlrev_b32 v72, 16, v75
    v_and_b32 v51, v39, v53
    v_and_b32 v57, v39, v59
    v_and_b32 v67, v39, v69
    v_and_b32 v73, v39, v75
    v_lshlrev_b32 v48, 16, v52
    v_lshlrev_b32 v54, 16, v58
    v_lshlrev_b32 v64, 16, v68
    v_lshlrev_b32 v70, 16, v74
    v_and_b32 v49, v39, v52
    v_and_b32 v55, v39, v58
    v_and_b32 v65, v39, v68
    v_and_b32 v71, v39, v74
    v_pk_mul_f32 v[48:49], v[48:49], v[50:51]
    v_pk_mul_f32 v[54:55], v[54:55], v[56:57]
    v_pk_mul_f32 v[64:65], v[64:65], v[66:67]
    v_pk_mul_f32 v[70:71], v[70:71], v[72:73]
    v_cvt_pk_bf16_f32 v52, v48, v49
    v_cvt_pk_bf16_f32 v58, v54, v55
    v_cvt_pk_bf16_f32 v68, v64, v65
    v_cvt_pk_bf16_f32 v74, v70, v71
    v_lshlrev_b32 v50, 16, v20
    v_lshlrev_b32 v56, 16, v21
    v_lshlrev_b32 v66, 16, v22
    v_lshlrev_b32 v72, 16, v23
    v_and_b32 v51, v39, v20
    v_and_b32 v57, v39, v21
    v_and_b32 v67, v39, v22
    v_and_b32 v73, v39, v23
    v_lshlrev_b32 v48, 16, v52
    v_lshlrev_b32 v54, 16, v58
    v_lshlrev_b32 v64, 16, v68
    v_lshlrev_b32 v70, 16, v74
    v_and_b32 v49, v39, v52
    v_and_b32 v55, v39, v58
    v_and_b32 v65, v39, v68
    v_and_b32 v71, v39, v74
    v_pk_add_f32 v[48:49], v[48:49], v[50:51]
    v_pk_add_f32 v[54:55], v[54:55], v[56:57]
    v_pk_add_f32 v[64:65], v[64:65], v[66:67]
    v_pk_add_f32 v[70:71], v[70:71], v[72:73]
    v_cvt_pk_bf16_f32 v60, v48, v49
    v_cvt_pk_bf16_f32 v61, v54, v55
    v_cvt_pk_bf16_f32 v76, v64, v65
    v_cvt_pk_bf16_f32 v77, v70, v71
    buffer_store_dwordx2 v[60:61], v17, s[24:27], 0 offen sc1
    buffer_store_dwordx2 v[76:77], v18, s[24:27], 0 offen sc1
    s_cmp_ge_u32 s12, 4
    s_cbranch_scc1 K3_DONE
    v_cvt_pk_bf16_f32 v84, v34, v35
    v_cvt_pk_bf16_f32 v90, v36, v37
    v_cvt_pk_bf16_f32 v85, v104, v105
    v_cvt_pk_bf16_f32 v91, v106, v107
    v_lshlrev_b32 v80, 16, v84
    v_lshlrev_b32 v86, 16, v90
    v_and_b32 v81, v39, v84
    v_and_b32 v87, v39, v90
    v_pk_mul_f32 v[82:83], v[80:81], v[40:41] op_sel_hi:[1,0]
    v_pk_mul_f32 v[88:89], v[86:87], v[40:41] op_sel_hi:[1,0]
    v_exp_f32 v82, v82
    v_exp_f32 v88, v88
    v_exp_f32 v83, v83
    v_exp_f32 v89, v89
    v_pk_add_f32 v[82:83], v[82:83], v[42:43] op_sel_hi:[1,0]
    v_pk_add_f32 v[88:89], v[88:89], v[42:43] op_sel_hi:[1,0]
    v_rcp_f32 v82, v82
    v_rcp_f32 v88, v88
    v_rcp_f32 v83, v83
    v_rcp_f32 v89, v89
    v_pk_mul_f32 v[80:81], v[80:81], v[82:83]
    v_pk_mul_f32 v[86:87], v[86:87], v[88:89]
    v_cvt_pk_bf16_f32 v84, v80, v81
    v_cvt_pk_bf16_f32 v90, v86, v87
    v_lshlrev_b32 v82, 16, v85
    v_lshlrev_b32 v88, 16, v91
    v_and_b32 v83, v39, v85
    v_and_b32 v89, v39, v91
    v_lshlrev_b32 v80, 16, v84
    v_lshlrev_b32 v86, 16, v90
    v_and_b32 v81, v39, v84
    v_and_b32 v87, v39, v90
    v_pk_mul_f32 v[80:81], v[80:81], v[82:83]
    v_pk_mul_f32 v[86:87], v[86:87], v[88:89]
    v_cvt_pk_bf16_f32 v84, v80, v81
    v_cvt_pk_bf16_f32 v90, v86, v87
    v_lshlrev_b32 v82, 16, v24
    v_lshlrev_b32 v88, 16, v25
    v_and_b32 v83, v39, v24
    v_and_b32 v89, v39, v25
    v_lshlrev_b32 v80, 16, v84
    v_lshlrev_b32 v86, 16, v90
    v_and_b32 v81, v39, v84
    v_and_b32 v87, v39, v90
    v_pk_add_f32 v[80:81], v[80:81], v[82:83]
    v_pk_add_f32 v[86:87], v[86:87], v[88:89]
    v_cvt_pk_bf16_f32 v92, v80, v81
    v_cvt_pk_bf16_f32 v93, v86, v87
    buffer_store_dwordx2 v[92:93], v19, s[24:27], 0 offen sc1
K3_DONE:
K3_END:
    s_endpgm
K3_TEXT_END:
.section .rodata,"a"
.p2align 6
.amdhsa_kernel k1_kernel
  .amdhsa_next_free_vgpr 152
  .amdhsa_next_free_sgpr 64
  .amdhsa_accum_offset 152
  .amdhsa_group_segment_fixed_size 0
  .amdhsa_kernarg_size 80
  .amdhsa_user_sgpr_count 2
  .amdhsa_user_sgpr_kernarg_segment_ptr 1
  .amdhsa_system_sgpr_workgroup_id_x 1
  .amdhsa_float_denorm_mode_32 3
.end_amdhsa_kernel
.p2align 6
.amdhsa_kernel k2_kernel
  .amdhsa_next_free_vgpr 256
  .amdhsa_next_free_sgpr 48
  .amdhsa_accum_offset 256
  .amdhsa_group_segment_fixed_size 0
  .amdhsa_kernarg_size 80
  .amdhsa_user_sgpr_count 2
  .amdhsa_user_sgpr_kernarg_segment_ptr 1
  .amdhsa_system_sgpr_workgroup_id_x 1
  .amdhsa_float_denorm_mode_32 3
.end_amdhsa_kernel
.p2align 6
.amdhsa_kernel k3_kernel
  .amdhsa_next_free_vgpr 256
  .amdhsa_next_free_sgpr 56
  .amdhsa_accum_offset 256
  .amdhsa_group_segment_fixed_size 0
  .amdhsa_kernarg_size 80
  .amdhsa_user_sgpr_count 2
  .amdhsa_user_sgpr_kernarg_segment_ptr 1
  .amdhsa_system_sgpr_workgroup_id_x 1
  .amdhsa_float_denorm_mode_32 3
.end_amdhsa_kernel
.p2align 8
TBL_E32F:
  .long 0x3f803f80, 0x3f803f80, 0x3f803f80, 0x3f803f80, 0x3f7b3f80, 0x3f553f6d, 0xbf7bbf80, 0xbf55bf6d
  .long 0x3f6d3f80, 0x3ec43f35, 0x3f6d3f80, 0x3ec43f35, 0x3f553f80, 0xbe483ec4, 0xbf55bf80, 0x3e48bec4
  .long 0x3f353f80, 0xbf350000, 0x3f353f80, 0xbf350000, 0x3f0e3f80, 0xbf7bbec4, 0xbf0ebf80, 0x3f7b3ec4
  .long 0x3ec43f80, 0xbf6dbf35, 0x3ec43f80, 0xbf6dbf35, 0x3e483f80, 0xbf0ebf6d, 0xbe48bf80, 0x3f0e3f6d
  .long 0x00003f80, 0x0000bf80, 0x00003f80, 0x0000bf80, 0xbe483f80, 0x3f0ebf6d, 0x3e48bf80, 0xbf0e3f6d
  .long 0xbec43f80, 0x3f6dbf35, 0xbec43f80, 0x3f6dbf35, 0xbf0e3f80, 0x3f7bbec4, 0x3f0ebf80, 0xbf7b3ec4
  .long 0xbf353f80, 0x3f350000, 0xbf353f80, 0x3f350000, 0xbf553f80, 0x3e483ec4, 0x3f55bf80, 0xbe48bec4
  .long 0xbf6d3f80, 0xbec43f35, 0xbf6d3f80, 0xbec43f35, 0xbf7b3f80, 0xbf553f6d, 0x3f7bbf80, 0x3f55bf6d
  .long 0x3f803f80, 0x3f803f80, 0x3f803f80, 0x3f803f80, 0x3f0e3f35, 0x3e483ec4, 0xbf0ebf35, 0xbe48bec4
  .long 0xbec40000, 0xbf6dbf35, 0xbec40000, 0xbf6dbf35, 0xbf7bbf35, 0xbf0ebf6d, 0x3f7b3f35, 0x3f0e3f6d
  .long 0xbf35bf80, 0x3f350000, 0xbf35bf80, 0x3f350000, 0x3e48bf35, 0x3f553f6d, 0xbe483f35, 0xbf55bf6d
  .long 0x3f6d0000, 0xbec43f35, 0x3f6d0000, 0xbec43f35, 0x3f553f35, 0xbf7bbec4, 0xbf55bf35, 0x3f7b3ec4
  .long 0x00003f80, 0x0000bf80, 0x00003f80, 0x0000bf80, 0xbf553f35, 0x3f7bbec4, 0x3f55bf35, 0xbf7b3ec4
  .long 0xbf6d0000, 0x3ec43f35, 0xbf6d0000, 0x3ec43f35, 0xbe48bf35, 0xbf553f6d, 0x3e483f35, 0x3f55bf6d
  .long 0x3f35bf80, 0xbf350000, 0x3f35bf80, 0xbf350000, 0x3f7bbf35, 0x3f0ebf6d, 0xbf7b3f35, 0xbf0e3f6d
  .long 0x3ec40000, 0x3f6dbf35, 0x3ec40000, 0x3f6dbf35, 0xbf0e3f35, 0xbe483ec4, 0x3f0ebf35, 0x3e48bec4
  .long 0x3f803f80, 0x3f803f80, 0x3f803f80, 0x3f803f80, 0xbe480000, 0xbf0ebec4, 0x3e480000, 0x3f0e3ec4
  .long 0xbf6dbf80, 0xbec4bf35, 0xbf6dbf80, 0xbec4bf35, 0x3f0e0000, 0x3f7b3f6d, 0xbf0e0000, 0xbf7bbf6d
  .long 0x3f353f80, 0xbf350000, 0x3f353f80, 0xbf350000, 0xbf550000, 0xbe48bf6d, 0x3f550000, 0x3e483f6d
  .long 0xbec4bf80, 0x3f6d3f35, 0xbec4bf80, 0x3f6d3f35, 0x3f7b0000, 0xbf553ec4, 0xbf7b0000, 0x3f55bec4
  .long 0x00003f80, 0x0000bf80, 0x00003f80, 0x0000bf80, 0xbf7b0000, 0x3f553ec4, 0x3f7b0000, 0xbf55bec4
  .long 0x3ec4bf80, 0xbf6d3f35, 0x3ec4bf80, 0xbf6d3f35, 0x3f550000, 0x3e48bf6d, 0xbf550000, 0xbe483f6d
  .long 0xbf353f80, 0x3f350000, 0xbf353f80, 0x3f350000, 0xbf0e0000, 0xbf7b3f6d, 0x3f0e0000, 0x3f7bbf6d
  .long 0x3f6dbf80, 0x3ec4bf35, 0x3f6dbf80, 0x3ec4bf35, 0x3e480000, 0x3f0ebec4, 0xbe480000, 0xbf0e3ec4
  .long 0x3f803f80, 0x3f803f80, 0x3f803f80, 0x3f803f80, 0xbf55bf35, 0xbf7bbf6d, 0x3f553f35, 0x3f7b3f6d
  .long 0x3ec40000, 0x3f6d3f35, 0x3ec40000, 0x3f6d3f35, 0x3e483f35, 0xbf55bec4, 0xbe48bf35, 0x3f553ec4
  .long 0xbf35bf80, 0x3f350000, 0xbf35bf80, 0x3f350000, 0x3f7b3f35, 0xbf0e3ec4, 0xbf7bbf35, 0x3f0ebec4
  .long 0xbf6d0000, 0x3ec4bf35, 0xbf6d0000, 0x3ec4bf35, 0x3f0ebf35, 0xbe483f6d, 0xbf0e3f35, 0x3e48bf6d
  .long 0x00003f80, 0x0000bf80, 0x00003f80, 0x0000bf80, 0xbf0ebf35, 0x3e483f6d, 0x3f0e3f35, 0xbe48bf6d
  .long 0x3f6d0000, 0xbec4bf35, 0x3f6d0000, 0xbec4bf35, 0xbf7b3f35, 0x3f0e3ec4, 0x3f7bbf35, 0xbf0ebec4
  .long 0x3f35bf80, 0xbf350000, 0x3f35bf80, 0xbf350000, 0xbe483f35, 0x3f55bec4, 0x3e48bf35, 0xbf553ec4
  .long 0xbec40000, 0xbf6d3f35, 0xbec40000, 0xbf6d3f35, 0x3f55bf35, 0x3f7bbf6d, 0xbf553f35, 0xbf7b3f6d
  .long 0xbf803f80, 0xbf803f80, 0xbf803f80, 0xbf803f80, 0xbf7b3f80, 0xbf553f6d, 0x3f7bbf80, 0x3f55bf6d
  .long 0xbf6d3f80, 0xbec43f35, 0xbf6d3f80, 0xbec43f35, 0xbf553f80, 0x3e483ec4, 0x3f55bf80, 0xbe48bec4
  .long 0xbf353f80, 0x3f350000, 0xbf353f80, 0x3f350000, 0xbf0e3f80, 0x3f7bbec4, 0x3f0ebf80, 0xbf7b3ec4
  .long 0xbec43f80, 0x3f6dbf35, 0xbec43f80, 0x3f6dbf35, 0xbe483f80, 0x3f0ebf6d, 0x3e48bf80, 0xbf0e3f6d
  .long 0x00003f80, 0x0000bf80, 0x00003f80, 0x0000bf80, 0x3e483f80, 0xbf0ebf6d, 0xbe48bf80, 0x3f0e3f6d
  .long 0x3ec43f80, 0xbf6dbf35, 0x3ec43f80, 0xbf6dbf35, 0x3f0e3f80, 0xbf7bbec4, 0xbf0ebf80, 0x3f7b3ec4
  .long 0x3f353f80, 0xbf350000, 0x3f353f80, 0xbf350000, 0x3f553f80, 0xbe483ec4, 0xbf55bf80, 0x3e48bec4
  .long 0x3f6d3f80, 0x3ec43f35, 0x3f6d3f80, 0x3ec43f35, 0x3f7b3f80, 0x3f553f6d, 0xbf7bbf80, 0xbf55bf6d
  .long 0xbf803f80, 0xbf803f80, 0xbf803f80, 0xbf803f80, 0xbf0e3f35, 0xbe483ec4, 0x3f0ebf35, 0x3e48bec4
  .long 0x3ec40000, 0x3f6dbf35, 0x3ec40000, 0x3f6dbf35, 0x3f7bbf35, 0x3f0ebf6d, 0xbf7b3f35, 0xbf0e3f6d
  .long 0x3f35bf80, 0xbf350000, 0x3f35bf80, 0xbf350000, 0xbe48bf35, 0xbf553f6d, 0x3e483f35, 0x3f55bf6d
  .long 0xbf6d0000, 0x3ec43f35, 0xbf6d0000, 0x3ec43f35, 0xbf553f35, 0x3f7bbec4, 0x3f55bf35, 0xbf7b3ec4
  .long 0x00003f80, 0x0000bf80, 0x00003f80, 0x0000bf80, 0x3f553f35, 0xbf7bbec4, 0xbf55bf35, 0x3f7b3ec4
  .long 0x3f6d0000, 0xbec43f35, 0x3f6d0000, 0xbec43f35, 0x3e48bf35, 0x3f553f6d, 0xbe483f35, 0xbf55bf6d
  .long 0xbf35bf80, 0x3f350000, 0xbf35bf80, 0x3f350000, 0xbf7bbf35, 0xbf0ebf6d, 0x3f7b3f35, 0x3f0e3f6d
  .long 0xbec40000, 0xbf6dbf35, 0xbec40000, 0xbf6dbf35, 0x3f0e3f35, 0x3e483ec4, 0xbf0ebf35, 0xbe48bec4
  .long 0xbf803f80, 0xbf803f80, 0xbf803f80, 0xbf803f80, 0x3e480000, 0x3f0ebec4, 0xbe480000, 0xbf0e3ec4
  .long 0x3f6dbf80, 0x3ec4bf35, 0x3f6dbf80, 0x3ec4bf35, 0xbf0e0000, 0xbf7b3f6d, 0x3f0e0000, 0x3f7bbf6d
  .long 0xbf353f80, 0x3f350000, 0xbf353f80, 0x3f350000, 0x3f550000, 0x3e48bf6d, 0xbf550000, 0xbe483f6d
  .long 0x3ec4bf80, 0xbf6d3f35, 0x3ec4bf80, 0xbf6d3f35, 0xbf7b0000, 0x3f553ec4, 0x3f7b0000, 0xbf55bec4
  .long 0x00003f80, 0x0000bf80, 0x00003f80, 0x0000bf80, 0x3f7b0000, 0xbf553ec4, 0xbf7b0000, 0x3f55bec4
  .long 0xbec4bf80, 0x3f6d3f35, 0xbec4bf80, 0x3f6d3f35, 0xbf550000, 0xbe48bf6d, 0x3f550000, 0x3e483f6d
  .long 0x3f353f80, 0xbf350000, 0x3f353f80, 0xbf350000, 0x3f0e0000, 0x3f7b3f6d, 0xbf0e0000, 0xbf7bbf6d
  .long 0xbf6dbf80, 0xbec4bf35, 0xbf6dbf80, 0xbec4bf35, 0xbe480000, 0xbf0ebec4, 0x3e480000, 0x3f0e3ec4
  .long 0xbf803f80, 0xbf803f80, 0xbf803f80, 0xbf803f80, 0x3f55bf35, 0x3f7bbf6d, 0xbf553f35, 0xbf7b3f6d
  .long 0xbec40000, 0xbf6d3f35, 0xbec40000, 0xbf6d3f35, 0xbe483f35, 0x3f55bec4, 0x3e48bf35, 0xbf553ec4
  .long 0x3f35bf80, 0xbf350000, 0x3f35bf80, 0xbf350000, 0xbf7b3f35, 0x3f0e3ec4, 0x3f7bbf35, 0xbf0ebec4
  .long 0x3f6d0000, 0xbec4bf35, 0x3f6d0000, 0xbec4bf35, 0xbf0ebf35, 0x3e483f6d, 0x3f0e3f35, 0xbe48bf6d
  .long 0x00003f80, 0x0000bf80, 0x00003f80, 0x0000bf80, 0x3f0ebf35, 0xbe483f6d, 0xbf0e3f35, 0x3e48bf6d
  .long 0xbf6d0000, 0x3ec4bf35, 0xbf6d0000, 0x3ec4bf35, 0x3f7b3f35, 0xbf0e3ec4, 0xbf7bbf35, 0x3f0ebec4
  .long 0xbf35bf80, 0x3f350000, 0xbf35bf80, 0x3f350000, 0x3e483f35, 0xbf55bec4, 0xbe48bf35, 0x3f553ec4
  .long 0x3ec40000, 0x3f6d3f35, 0x3ec40000, 0x3f6d3f35, 0xbf55bf35, 0xbf7bbf6d, 0x3f553f35, 0x3f7b3f6d
  .long 0x00000000, 0x00000000, 0x00000000, 0x00000000, 0x3e480000, 0x3f0e3ec4, 0xbe480000, 0xbf0ebec4
  .long 0x3ec40000, 0x3f6d3f35, 0x3ec40000, 0x3f6d3f35, 0x3f0e0000, 0x3f7b3f6d, 0xbf0e0000, 0xbf7bbf6d
  .long 0x3f350000, 0x3f353f80, 0x3f350000, 0x3f353f80, 0x3f550000, 0x3e483f6d, 0xbf550000, 0xbe48bf6d
  .long 0x3f6d0000, 0xbec43f35, 0x3f6d0000, 0xbec43f35, 0x3f7b0000, 0xbf553ec4, 0xbf7b0000, 0x3f55bec4
  .long 0x3f800000, 0xbf800000, 0x3f800000, 0xbf800000, 0x3f7b0000, 0xbf55bec4, 0xbf7b0000, 0x3f553ec4
  .long 0x3f6d0000, 0xbec4bf35, 0x3f6d0000, 0xbec4bf35, 0x3f550000, 0x3e48bf6d, 0xbf550000, 0xbe483f6d
  .long 0x3f350000, 0x3f35bf80, 0x3f350000, 0x3f35bf80, 0x3f0e0000, 0x3f7bbf6d, 0xbf0e0000, 0xbf7b3f6d
  .long 0x3ec40000, 0x3f6dbf35, 0x3ec40000, 0x3f6dbf35, 0x3e480000, 0x3f0ebec4, 0xbe480000, 0xbf0e3ec4
  .long 0x00000000, 0x00000000, 0x00000000, 0x00000000, 0x3f553f35, 0x3f7b3f6d, 0xbf55bf35, 0xbf7bbf6d
  .long 0x3f6d3f80, 0x3ec43f35, 0x3f6d3f80, 0x3ec43f35, 0x3e483f35, 0xbf55bec4, 0xbe48bf35, 0x3f553ec4
  .long 0xbf350000, 0xbf35bf80, 0xbf350000, 0xbf35bf80, 0xbf7bbf35, 0x3f0ebec4, 0x3f7b3f35, 0xbf0e3ec4
  .long 0xbec4bf80, 0x3f6d3f35, 0xbec4bf80, 0x3f6d3f35, 0x3f0ebf35, 0xbe483f6d, 0xbf0e3f35, 0x3e48bf6d
  .long 0x3f800000, 0xbf800000, 0x3f800000, 0xbf800000, 0x3f0e3f35, 0xbe48bf6d, 0xbf0ebf35, 0x3e483f6d
  .long 0xbec43f80, 0x3f6dbf35, 0xbec43f80, 0x3f6dbf35, 0xbf7b3f35, 0x3f0e3ec4, 0x3f7bbf35, 0xbf0ebec4
  .long 0xbf350000, 0xbf353f80, 0xbf350000, 0xbf353f80, 0x3e48bf35, 0xbf553ec4, 0xbe483f35, 0x3f55bec4
  .long 0x3f6dbf80, 0x3ec4bf35, 0x3f6dbf80, 0x3ec4bf35, 0x3f55bf35, 0x3f7bbf6d, 0xbf553f35, 0xbf7b3f6d
  .long 0x00000000, 0x00000000, 0x00000000, 0x00000000, 0x3f7b3f80, 0x3f553f6d, 0xbf7bbf80, 0xbf55bf6d
  .long 0xbec40000, 0xbf6dbf35, 0xbec40000, 0xbf6dbf35, 0xbf55bf80, 0x3e48bec4, 0x3f553f80, 0xbe483ec4
  .long 0x3f350000, 0x3f353f80, 0x3f350000, 0x3f353f80, 0x3f0e3f80, 0xbf7bbec4, 0xbf0ebf80, 0x3f7b3ec4
  .long 0xbf6d0000, 0x3ec4bf35, 0xbf6d0000, 0x3ec4bf35, 0xbe48bf80, 0x3f0e3f6d, 0x3e483f80, 0xbf0ebf6d
  .long 0x3f800000, 0xbf800000, 0x3f800000, 0xbf800000, 0xbe483f80, 0x3f0ebf6d, 0x3e48bf80, 0xbf0e3f6d
  .long 0xbf6d0000, 0x3ec43f35, 0xbf6d0000, 0x3ec43f35, 0x3f0ebf80, 0xbf7b3ec4, 0xbf0e3f80, 0x3f7bbec4
  .long 0x3f350000, 0x3f35bf80, 0x3f350000, 0x3f35bf80, 0xbf553f80, 0x3e483ec4, 0x3f55bf80, 0xbe48bec4
  .long 0xbec40000, 0xbf6d3f35, 0xbec40000, 0xbf6d3f35, 0x3f7bbf80, 0x3f55bf6d, 0xbf7b3f80, 0xbf553f6d
  .long 0x00000000, 0x00000000, 0x00000000, 0x00000000, 0x3f0e3f35, 0x3e483ec4, 0xbf0ebf35, 0xbe48bec4
  .long 0xbf6dbf80, 0xbec4bf35, 0xbf6dbf80, 0xbec4bf35, 0x3f7b3f35, 0x3f0e3f6d, 0xbf7bbf35, 0xbf0ebf6d
  .long 0xbf350000, 0xbf35bf80, 0xbf350000, 0xbf35bf80, 0x3e48bf35, 0x3f553f6d, 0xbe483f35, 0xbf55bf6d
  .long 0x3ec43f80, 0xbf6dbf35, 0x3ec43f80, 0xbf6dbf35, 0xbf55bf35, 0x3f7b3ec4, 0x3f553f35, 0xbf7bbec4
  .long 0x3f800000, 0xbf800000, 0x3f800000, 0xbf800000, 0xbf553f35, 0x3f7bbec4, 0x3f55bf35, 0xbf7b3ec4
  .long 0x3ec4bf80, 0xbf6d3f35, 0x3ec4bf80, 0xbf6d3f35, 0x3e483f35, 0x3f55bf6d, 0xbe48bf35, 0xbf553f6d
  .long 0xbf350000, 0xbf353f80, 0xbf350000, 0xbf353f80, 0x3f7bbf35, 0x3f0ebf6d, 0xbf7b3f35, 0xbf0e3f6d
  .long 0xbf6d3f80, 0xbec43f35, 0xbf6d3f80, 0xbec43f35, 0x3f0ebf35, 0x3e48bec4, 0xbf0e3f35, 0xbe483ec4
  .long 0x00000000, 0x00000000, 0x00000000, 0x00000000, 0xbe480000, 0xbf0e3ec4, 0x3e480000, 0x3f0ebec4
  .long 0xbec40000, 0xbf6d3f35, 0xbec40000, 0xbf6d3f35, 0xbf0e0000, 0xbf7b3f6d, 0x3f0e0000, 0x3f7bbf6d
  .long 0xbf350000, 0xbf353f80, 0xbf350000, 0xbf353f80, 0xbf550000, 0xbe483f6d, 0x3f550000, 0x3e48bf6d
  .long 0xbf6d0000, 0x3ec43f35, 0xbf6d0000, 0x3ec43f35, 0xbf7b0000, 0x3f553ec4, 0x3f7b0000, 0xbf55bec4
  .long 0xbf800000, 0x3f800000, 0xbf800000, 0x3f800000, 0xbf7b0000, 0x3f55bec4, 0x3f7b0000, 0xbf553ec4
  .long 0xbf6d0000, 0x3ec4bf35, 0xbf6d0000, 0x3ec4bf35, 0xbf550000, 0xbe48bf6d, 0x3f550000, 0x3e483f6d
  .long 0xbf350000, 0xbf35bf80, 0xbf350000, 0xbf35bf80, 0xbf0e0000, 0xbf7bbf6d, 0x3f0e0000, 0x3f7b3f6d
  .long 0xbec40000, 0xbf6dbf35, 0xbec40000, 0xbf6dbf35, 0xbe480000, 0xbf0ebec4, 0x3e480000, 0x3f0e3ec4
  .long 0x00000000, 0x00000000, 0x00000000, 0x00000000, 0xbf553f35, 0xbf7b3f6d, 0x3f55bf35, 0x3f7bbf6d
  .long 0xbf6d3f80, 0xbec43f35, 0xbf6d3f80, 0xbec43f35, 0xbe483f35, 0x3f55bec4, 0x3e48bf35, 0xbf553ec4
  .long 0x3f350000, 0x3f35bf80, 0x3f350000, 0x3f35bf80, 0x3f7bbf35, 0xbf0ebec4, 0xbf7b3f35, 0x3f0e3ec4
  .long 0x3ec4bf80, 0xbf6d3f35, 0x3ec4bf80, 0xbf6d3f35, 0xbf0ebf35, 0x3e483f6d, 0x3f0e3f35, 0xbe48bf6d
  .long 0xbf800000, 0x3f800000, 0xbf800000, 0x3f800000, 0xbf0e3f35, 0x3e48bf6d, 0x3f0ebf35, 0xbe483f6d
  .long 0x3ec43f80, 0xbf6dbf35, 0x3ec43f80, 0xbf6dbf35, 0x3f7b3f35, 0xbf0e3ec4, 0xbf7bbf35, 0x3f0ebec4
  .long 0x3f350000, 0x3f353f80, 0x3f350000, 0x3f353f80, 0xbe48bf35, 0x3f553ec4, 0x3e483f35, 0xbf55bec4
  .long 0xbf6dbf80, 0xbec4bf35, 0xbf6dbf80, 0xbec4bf35, 0xbf55bf35, 0xbf7bbf6d, 0x3f553f35, 0x3f7b3f6d
  .long 0x00000000, 0x00000000, 0x00000000, 0x00000000, 0xbf7b3f80, 0xbf553f6d, 0x3f7bbf80, 0x3f55bf6d
  .long 0x3ec40000, 0x3f6dbf35, 0x3ec40000, 0x3f6dbf35, 0x3f55bf80, 0xbe48bec4, 0xbf553f80, 0x3e483ec4
  .long 0xbf350000, 0xbf353f80, 0xbf350000, 0xbf353f80, 0xbf0e3f80, 0x3f7bbec4, 0x3f0ebf80, 0xbf7b3ec4
  .long 0x3f6d0000, 0xbec4bf35, 0x3f6d0000, 0xbec4bf35, 0x3e48bf80, 0xbf0e3f6d, 0xbe483f80, 0x3f0ebf6d
  .long 0xbf800000, 0x3f800000, 0xbf800000, 0x3f800000, 0x3e483f80, 0xbf0ebf6d, 0xbe48bf80, 0x3f0e3f6d
  .long 0x3f6d0000, 0xbec43f35, 0x3f6d0000, 0xbec43f35, 0xbf0ebf80, 0x3f7b3ec4, 0x3f0e3f80, 0xbf7bbec4
  .long 0xbf350000, 0xbf35bf80, 0xbf350000, 0xbf35bf80, 0x3f553f80, 0xbe483ec4, 0xbf55bf80, 0x3e48bec4
  .long 0x3ec40000, 0x3f6d3f35, 0x3ec40000, 0x3f6d3f35, 0xbf7bbf80, 0xbf55bf6d, 0x3f7b3f80, 0x3f553f6d
  .long 0x00000000, 0x00000000, 0x00000000, 0x00000000, 0xbf0e3f35, 0xbe483ec4, 0x3f0ebf35, 0x3e48bec4
  .long 0x3f6dbf80, 0x3ec4bf35, 0x3f6dbf80, 0x3ec4bf35, 0xbf7b3f35, 0xbf0e3f6d, 0x3f7bbf35, 0x3f0ebf6d
  .long 0x3f350000, 0x3f35bf80, 0x3f350000, 0x3f35bf80, 0xbe48bf35, 0xbf553f6d, 0x3e483f35, 0x3f55bf6d
  .long 0xbec43f80, 0x3f6dbf35, 0xbec43f80, 0x3f6dbf35, 0x3f55bf35, 0xbf7b3ec4, 0xbf553f35, 0x3f7bbec4
  .long 0xbf800000, 0x3f800000, 0xbf800000, 0x3f800000, 0x3f553f35, 0xbf7bbec4, 0xbf55bf35, 0x3f7b3ec4
  .long 0xbec4bf80, 0x3f6d3f35, 0xbec4bf80, 0x3f6d3f35, 0xbe483f35, 0xbf55bf6d, 0x3e48bf35, 0x3f553f6d
  .long 0x3f350000, 0x3f353f80, 0x3f350000, 0x3f353f80, 0xbf7bbf35, 0xbf0ebf6d, 0x3f7b3f35, 0x3f0e3f6d
  .long 0x3f6d3f80, 0x3ec43f35, 0x3f6d3f80, 0x3ec43f35, 0xbf0ebf35, 0xbe48bec4, 0x3f0e3f35, 0x3e483ec4
.p2align 8
TBL_E64:
  .long 0x3f803f80, 0x3f803f80, 0x3f803f80, 0x3f803f80, 0x3f7f3f80, 0x3f753f7b, 0x3f223f35, 0x3ef13f0e
  .long 0x3f7b3f80, 0x3f553f6d, 0xbe480000, 0xbf0ebec4, 0x3f753f80, 0x3f223f55, 0xbf62bf35, 0xbf7fbf7b
  .long 0x3f6d3f80, 0x3ec43f35, 0xbf6dbf80, 0xbec4bf35, 0x3f623f80, 0x3dc93f0e, 0xbe95bf35, 0x3f223e48
  .long 0x3f553f80, 0xbe483ec4, 0x3f0e0000, 0x3f7b3f6d, 0x3f463f80, 0xbef13e48, 0x3f7f3f35, 0x3e953f55
  .long 0x3f353f80, 0xbf350000, 0x3f353f80, 0xbf350000, 0x3f223f80, 0xbf62be48, 0xbdc93f35, 0xbf75bf55
  .long 0x3f0e3f80, 0xbf7bbec4, 0xbf550000, 0xbe48bf6d, 0x3ef13f80, 0xbf7fbf0e, 0xbf75bf35, 0x3f46be48
  .long 0x3ec43f80, 0xbf6dbf35, 0xbec4bf80, 0x3f6d3f35, 0x3e953f80, 0xbf46bf55, 0x3ef1bf35, 0x3dc93f7b
  .long 0x3e483f80, 0xbf0ebf6d, 0x3f7b0000, 0xbf553ec4, 0x3dc93f80, 0xbe95bf7b, 0x3f463f35, 0xbf62bf0e
  .long 0x00003f80, 0x0000bf80, 0x00003f80, 0x0000bf80, 0xbdc93f80, 0x3e95bf7b, 0xbf463f35, 0x3f62bf0e
  .long 0xbe483f80, 0x3f0ebf6d, 0xbf7b0000, 0x3f553ec4, 0xbe953f80, 0x3f46bf55, 0xbef1bf35, 0xbdc93f7b
  .long 0xbec43f80, 0x3f6dbf35, 0x3ec4bf80, 0xbf6d3f35, 0xbef13f80, 0x3f7fbf0e, 0x3f75bf35, 0xbf46be48
  .long 0xbf0e3f80, 0x3f7bbec4, 0x3f550000, 0x3e48bf6d, 0xbf223f80, 0x3f62be48, 0x3dc93f35, 0x3f75bf55
  .long 0xbf353f80, 0x3f350000, 0xbf353f80, 0x3f350000, 0xbf463f80, 0x3ef13e48, 0xbf7f3f35, 0xbe953f55
  .long 0xbf553f80, 0x3e483ec4, 0xbf0e0000, 0xbf7b3f6d, 0xbf623f80, 0xbdc93f0e, 0x3e95bf35, 0xbf223e48
  .long 0xbf6d3f80, 0xbec43f35, 0x3f6dbf80, 0x3ec4bf35, 0xbf753f80, 0xbf223f55, 0x3f62bf35, 0x3f7fbf7b
  .long 0xbf7b3f80, 0xbf553f6d, 0x3e480000, 0x3f0ebec4, 0xbf7f3f80, 0xbf753f7b, 0xbf223f35, 0xbef13f0e
  .long 0x3f803f80, 0x3f803f80, 0x3f803f80, 0x3f803f80, 0x3f623f6d, 0x3f463f55, 0x3e953ec4, 0x3dc93e48
  .long 0x3f0e3f35, 0x3e483ec4, 0xbf55bf35, 0xbf7bbf6d, 0x3dc93ec4, 0xbef1be48, 0xbf46bf6d, 0xbe95bf0e
  .long 0xbec40000, 0xbf6dbf35, 0x3ec40000, 0x3f6d3f35, 0xbf46bec4, 0xbf75bf7b, 0x3f7f3f6d, 0x3ef13f55
  .long 0xbf7bbf35, 0xbf0ebf6d, 0x3e483f35, 0xbf55bec4, 0xbf75bf6d, 0x3dc9bf0e, 0xbf62bec4, 0xbf22bf7b
  .long 0xbf35bf80, 0x3f350000, 0xbf35bf80, 0x3f350000, 0xbe95bf6d, 0x3f7f3f0e, 0x3ef1bec4, 0x3f463f7b
  .long 0x3e48bf35, 0x3f553f6d, 0x3f7b3f35, 0xbf0e3ec4, 0x3f22bec4, 0x3e953f7b, 0x3dc93f6d, 0xbf62bf55
  .long 0x3f6d0000, 0xbec43f35, 0xbf6d0000, 0x3ec4bf35, 0x3f7f3ec4, 0xbf623e48, 0xbf22bf6d, 0x3f753f0e
  .long 0x3f553f35, 0xbf7bbec4, 0x3f0ebf35, 0xbe483f6d, 0x3ef13f6d, 0xbf22bf55, 0x3f753ec4, 0xbf7fbe48
  .long 0x00003f80, 0x0000bf80, 0x00003f80, 0x0000bf80, 0xbef13f6d, 0x3f22bf55, 0xbf753ec4, 0x3f7fbe48
  .long 0xbf553f35, 0x3f7bbec4, 0xbf0ebf35, 0x3e483f6d, 0xbf7f3ec4, 0x3f623e48, 0x3f22bf6d, 0xbf753f0e
  .long 0xbf6d0000, 0x3ec43f35, 0x3f6d0000, 0xbec4bf35, 0xbf22bec4, 0xbe953f7b, 0xbdc93f6d, 0x3f62bf55
  .long 0xbe48bf35, 0xbf553f6d, 0xbf7b3f35, 0x3f0e3ec4, 0x3e95bf6d, 0xbf7f3f0e, 0xbef1bec4, 0xbf463f7b
  .long 0x3f35bf80, 0xbf350000, 0x3f35bf80, 0xbf350000, 0x3f75bf6d, 0xbdc9bf0e, 0x3f62bec4, 0x3f22bf7b
  .long 0x3f7bbf35, 0x3f0ebf6d, 0xbe483f35, 0x3f55bec4, 0x3f46bec4, 0x3f75bf7b, 0xbf7f3f6d, 0xbef13f55
  .long 0x3ec40000, 0x3f6dbf35, 0xbec40000, 0xbf6d3f35, 0xbdc93ec4, 0x3ef1be48, 0x3f46bf6d, 0x3e95bf0e
  .long 0xbf0e3f35, 0xbe483ec4, 0x3f55bf35, 0x3f7bbf6d, 0xbf623f6d, 0xbf463f55, 0xbe953ec4, 0xbdc93e48
  .long 0x3f803f80, 0x3f803f80, 0x3f803f80, 0x3f803f80, 0xbdc90000, 0xbe95be48, 0xbf46bf35, 0xbf62bf55
  .long 0xbf7bbf80, 0xbf55bf6d, 0x3e480000, 0x3f0e3ec4, 0x3e950000, 0x3f463f0e, 0x3ef13f35, 0xbdc93e48
  .long 0x3f6d3f80, 0x3ec43f35, 0xbf6dbf80, 0xbec4bf35, 0xbef10000, 0xbf7fbf55, 0x3f753f35, 0x3f463f7b
  .long 0xbf55bf80, 0x3e48bec4, 0xbf0e0000, 0xbf7bbf6d, 0x3f220000, 0x3f623f7b, 0xbdc9bf35, 0x3f753f0e
  .long 0x3f353f80, 0xbf350000, 0x3f353f80, 0xbf350000, 0xbf460000, 0xbef1bf7b, 0xbf7fbf35, 0x3e95bf0e
  .long 0xbf0ebf80, 0x3f7b3ec4, 0x3f550000, 0x3e483f6d, 0x3f620000, 0xbdc93f55, 0xbe953f35, 0xbf22bf7b
  .long 0x3ec43f80, 0xbf6dbf35, 0xbec4bf80, 0x3f6d3f35, 0xbf750000, 0x3f22bf0e, 0x3f623f35, 0xbf7fbe48
  .long 0xbe48bf80, 0x3f0e3f6d, 0xbf7b0000, 0x3f55bec4, 0x3f7f0000, 0xbf753e48, 0x3f22bf35, 0xbef13f55
  .long 0x00003f80, 0x0000bf80, 0x00003f80, 0x0000bf80, 0xbf7f0000, 0x3f753e48, 0xbf22bf35, 0x3ef13f55
  .long 0x3e48bf80, 0xbf0e3f6d, 0x3f7b0000, 0xbf55bec4, 0x3f750000, 0xbf22bf0e, 0xbf623f35, 0x3f7fbe48
  .long 0xbec43f80, 0x3f6dbf35, 0x3ec4bf80, 0xbf6d3f35, 0xbf620000, 0x3dc93f55, 0x3e953f35, 0x3f22bf7b
  .long 0x3f0ebf80, 0xbf7b3ec4, 0xbf550000, 0xbe483f6d, 0x3f460000, 0x3ef1bf7b, 0x3f7fbf35, 0xbe95bf0e
  .long 0xbf353f80, 0x3f350000, 0xbf353f80, 0x3f350000, 0xbf220000, 0xbf623f7b, 0x3dc9bf35, 0xbf753f0e
  .long 0x3f55bf80, 0xbe48bec4, 0x3f0e0000, 0x3f7bbf6d, 0x3ef10000, 0x3f7fbf55, 0xbf753f35, 0xbf463f7b
  .long 0xbf6d3f80, 0xbec43f35, 0x3f6dbf80, 0x3ec4bf35, 0xbe950000, 0xbf463f0e, 0xbef13f35, 0x3dc93e48
  .long 0x3f7bbf80, 0x3f55bf6d, 0xbe480000, 0xbf0e3ec4, 0x3dc90000, 0x3e95be48, 0x3f46bf35, 0x3f62bf55
  .long 0x3f803f80, 0x3f803f80, 0x3f803f80, 0x3f803f80, 0xbef1bec4, 0xbf22bf0e, 0xbf75bf6d, 0xbf7fbf7b
  .long 0xbf0ebf35, 0xbe48bec4, 0x3f553f35, 0x3f7b3f6d, 0x3f7f3f6d, 0x3f623f7b, 0xbf22bec4, 0xbf75bf55
  .long 0xbec40000, 0xbf6dbf35, 0x3ec40000, 0x3f6d3f35, 0xbf22bf6d, 0x3e95be48, 0xbdc93ec4, 0xbf62bf0e
  .long 0x3f7b3f35, 0x3f0e3f6d, 0xbe48bf35, 0x3f553ec4, 0xbe953ec4, 0xbf7fbf55, 0x3ef13f6d, 0xbf46be48
  .long 0xbf35bf80, 0x3f350000, 0xbf35bf80, 0x3f350000, 0x3f753ec4, 0x3dc93f55, 0x3f623f6d, 0xbf223e48
  .long 0xbe483f35, 0xbf55bf6d, 0xbf7bbf35, 0x3f0ebec4, 0xbf46bf6d, 0x3f753e48, 0x3f7f3ec4, 0xbef13f0e
  .long 0x3f6d0000, 0xbec43f35, 0xbf6d0000, 0x3ec4bf35, 0xbdc93f6d, 0xbef1bf7b, 0x3f46bec4, 0xbe953f55
  .long 0xbf55bf35, 0x3f7b3ec4, 0xbf0e3f35, 0x3e48bf6d, 0x3f62bec4, 0xbf463f0e, 0x3e95bf6d, 0xbdc93f7b
  .long 0x00003f80, 0x0000bf80, 0x00003f80, 0x0000bf80, 0xbf62bec4, 0x3f463f0e, 0xbe95bf6d, 0x3dc93f7b
  .long 0x3f55bf35, 0xbf7b3ec4, 0x3f0e3f35, 0xbe48bf6d, 0x3dc93f6d, 0x3ef1bf7b, 0xbf46bec4, 0x3e953f55
  .long 0xbf6d0000, 0x3ec43f35, 0x3f6d0000, 0xbec4bf35, 0x3f46bf6d, 0xbf753e48, 0xbf7f3ec4, 0x3ef13f0e
  .long 0x3e483f35, 0x3f55bf6d, 0x3f7bbf35, 0xbf0ebec4, 0xbf753ec4, 0xbdc93f55, 0xbf623f6d, 0x3f223e48
  .long 0x3f35bf80, 0xbf350000, 0x3f35bf80, 0xbf350000, 0x3e953ec4, 0x3f7fbf55, 0xbef13f6d, 0x3f46be48
  .long 0xbf7b3f35, 0xbf0e3f6d, 0x3e48bf35, 0xbf553ec4, 0x3f22bf6d, 0xbe95be48, 0x3dc93ec4, 0x3f62bf0e
  .long 0x3ec40000, 0x3f6dbf35, 0xbec40000, 0xbf6d3f35, 0xbf7f3f6d, 0xbf623f7b, 0x3f22bec4, 0x3f75bf55
  .long 0x3f0ebf35, 0x3e48bec4, 0xbf553f35, 0xbf7b3f6d, 0x3ef1bec4, 0x3f22bf0e, 0x3f75bf6d, 0x3f7fbf7b
  .long 0x3f803f80, 0x3f803f80, 0x3f803f80, 0x3f803f80, 0xbf7fbf80, 0xbf75bf7b, 0xbf22bf35, 0xbef1bf0e
  .long 0x3f7b3f80, 0x3f553f6d, 0xbe480000, 0xbf0ebec4, 0xbf75bf80, 0xbf22bf55, 0x3f623f35, 0x3f7f3f7b
  .long 0x3f6d3f80, 0x3ec43f35, 0xbf6dbf80, 0xbec4bf35, 0xbf62bf80, 0xbdc9bf0e, 0x3e953f35, 0xbf22be48
  .long 0x3f553f80, 0xbe483ec4, 0x3f0e0000, 0x3f7b3f6d, 0xbf46bf80, 0x3ef1be48, 0xbf7fbf35, 0xbe95bf55
  .long 0x3f353f80, 0xbf350000, 0x3f353f80, 0xbf350000, 0xbf22bf80, 0x3f623e48, 0x3dc9bf35, 0x3f753f55
  .long 0x3f0e3f80, 0xbf7bbec4, 0xbf550000, 0xbe48bf6d, 0xbef1bf80, 0x3f7f3f0e, 0x3f753f35, 0xbf463e48
  .long 0x3ec43f80, 0xbf6dbf35, 0xbec4bf80, 0x3f6d3f35, 0xbe95bf80, 0x3f463f55, 0xbef13f35, 0xbdc9bf7b
  .long 0x3e483f80, 0xbf0ebf6d, 0x3f7b0000, 0xbf553ec4, 0xbdc9bf80, 0x3e953f7b, 0xbf46bf35, 0x3f623f0e
  .long 0x00003f80, 0x0000bf80, 0x00003f80, 0x0000bf80, 0x3dc9bf80, 0xbe953f7b, 0x3f46bf35, 0xbf623f0e
  .long 0xbe483f80, 0x3f0ebf6d, 0xbf7b0000, 0x3f553ec4, 0x3e95bf80, 0xbf463f55, 0x3ef13f35, 0x3dc9bf7b
  .long 0xbec43f80, 0x3f6dbf35, 0x3ec4bf80, 0xbf6d3f35, 0x3ef1bf80, 0xbf7f3f0e, 0xbf753f35, 0x3f463e48
  .long 0xbf0e3f80, 0x3f7bbec4, 0x3f550000, 0x3e48bf6d, 0x3f22bf80, 0xbf623e48, 0xbdc9bf35, 0xbf753f55
  .long 0xbf353f80, 0x3f350000, 0xbf353f80, 0x3f350000, 0x3f46bf80, 0xbef1be48, 0x3f7fbf35, 0x3e95bf55
  .long 0xbf553f80, 0x3e483ec4, 0xbf0e0000, 0xbf7b3f6d, 0x3f62bf80, 0x3dc9bf0e, 0xbe953f35, 0x3f22be48
  .long 0xbf6d3f80, 0xbec43f35, 0x3f6dbf80, 0x3ec4bf35, 0x3f75bf80, 0x3f22bf55, 0xbf623f35, 0xbf7f3f7b
  .long 0xbf7b3f80, 0xbf553f6d, 0x3e480000, 0x3f0ebec4, 0x3f7fbf80, 0x3f75bf7b, 0x3f22bf35, 0x3ef1bf0e
  .long 0x3f803f80, 0x3f803f80, 0x3f803f80, 0x3f803f80, 0xbf62bf6d, 0xbf46bf55, 0xbe95bec4, 0xbdc9be48
  .long 0x3f0e3f35, 0x3e483ec4, 0xbf55bf35, 0xbf7bbf6d, 0xbdc9bec4, 0x3ef13e48, 0x3f463f6d, 0x3e953f0e
  .long 0xbec40000, 0xbf6dbf35, 0x3ec40000, 0x3f6d3f35, 0x3f463ec4, 0x3f753f7b, 0xbf7fbf6d, 0xbef1bf55
  .long 0xbf7bbf35, 0xbf0ebf6d, 0x3e483f35, 0xbf55bec4, 0x3f753f6d, 0xbdc93f0e, 0x3f623ec4, 0x3f223f7b
  .long 0xbf35bf80, 0x3f350000, 0xbf35bf80, 0x3f350000, 0x3e953f6d, 0xbf7fbf0e, 0xbef13ec4, 0xbf46bf7b
  .long 0x3e48bf35, 0x3f553f6d, 0x3f7b3f35, 0xbf0e3ec4, 0xbf223ec4, 0xbe95bf7b, 0xbdc9bf6d, 0x3f623f55
  .long 0x3f6d0000, 0xbec43f35, 0xbf6d0000, 0x3ec4bf35, 0xbf7fbec4, 0x3f62be48, 0x3f223f6d, 0xbf75bf0e
  .long 0x3f553f35, 0xbf7bbec4, 0x3f0ebf35, 0xbe483f6d, 0xbef1bf6d, 0x3f223f55, 0xbf75bec4, 0x3f7f3e48
  .long 0x00003f80, 0x0000bf80, 0x00003f80, 0x0000bf80, 0x3ef1bf6d, 0xbf223f55, 0x3f75bec4, 0xbf7f3e48
  .long 0xbf553f35, 0x3f7bbec4, 0xbf0ebf35, 0x3e483f6d, 0x3f7fbec4, 0xbf62be48, 0xbf223f6d, 0x3f75bf0e
  .long 0xbf6d0000, 0x3ec43f35, 0x3f6d0000, 0xbec4bf35, 0x3f223ec4, 0x3e95bf7b, 0x3dc9bf6d, 0xbf623f55
  .long 0xbe48bf35, 0xbf553f6d, 0xbf7b3f35, 0x3f0e3ec4, 0xbe953f6d, 0x3f7fbf0e, 0x3ef13ec4, 0x3f46bf7b
  .long 0x3f35bf80, 0xbf350000, 0x3f35bf80, 0xbf350000, 0xbf753f6d, 0x3dc93f0e, 0xbf623ec4, 0xbf223f7b
  .long 0x3f7bbf35, 0x3f0ebf6d, 0xbe483f35, 0x3f55bec4, 0xbf463ec4, 0xbf753f7b, 0x3f7fbf6d, 0x3ef1bf55
  .long 0x3ec40000, 0x3f6dbf35, 0xbec40000, 0xbf6d3f35, 0x3dc9bec4, 0xbef13e48, 0xbf463f6d, 0xbe953f0e
  .long 0xbf0e3f35, 0xbe483ec4, 0x3f55bf35, 0x3f7bbf6d, 0x3f62bf6d, 0x3f46bf55, 0x3e95bec4, 0x3dc9be48
  .long 0x3f803f80, 0x3f803f80, 0x3f803f80, 0x3f803f80, 0x3dc90000, 0x3e953e48, 0x3f463f35, 0x3f623f55
  .long 0xbf7bbf80, 0xbf55bf6d, 0x3e480000, 0x3f0e3ec4, 0xbe950000, 0xbf46bf0e, 0xbef1bf35, 0x3dc9be48
  .long 0x3f6d3f80, 0x3ec43f35, 0xbf6dbf80, 0xbec4bf35, 0x3ef10000, 0x3f7f3f55, 0xbf75bf35, 0xbf46bf7b
  .long 0xbf55bf80, 0x3e48bec4, 0xbf0e0000, 0xbf7bbf6d, 0xbf220000, 0xbf62bf7b, 0x3dc93f35, 0xbf75bf0e
  .long 0x3f353f80, 0xbf350000, 0x3f353f80, 0xbf350000, 0x3f460000, 0x3ef13f7b, 0x3f7f3f35, 0xbe953f0e
  .long 0xbf0ebf80, 0x3f7b3ec4, 0x3f550000, 0x3e483f6d, 0xbf620000, 0x3dc9bf55, 0x3e95bf35, 0x3f223f7b
  .long 0x3ec43f80, 0xbf6dbf35, 0xbec4bf80, 0x3f6d3f35, 0x3f750000, 0xbf223f0e, 0xbf62bf35, 0x3f7f3e48
  .long 0xbe48bf80, 0x3f0e3f6d, 0xbf7b0000, 0x3f55bec4, 0xbf7f0000, 0x3f75be48, 0xbf223f35, 0x3ef1bf55
  .long 0x00003f80, 0x0000bf80, 0x00003f80, 0x0000bf80, 0x3f7f0000, 0xbf75be48, 0x3f223f35, 0xbef1bf55
  .long 0x3e48bf80, 0xbf0e3f6d, 0x3f7b0000, 0xbf55bec4, 0xbf750000, 0x3f223f0e, 0x3f62bf35, 0xbf7f3e48
  .long 0xbec43f80, 0x3f6dbf35, 0x3ec4bf80, 0xbf6d3f35, 0x3f620000, 0xbdc9bf55, 0xbe95bf35, 0xbf223f7b
  .long 0x3f0ebf80, 0xbf7b3ec4, 0xbf550000, 0xbe483f6d, 0xbf460000, 0xbef13f7b, 0xbf7f3f35, 0x3e953f0e
  .long 0xbf353f80, 0x3f350000, 0xbf353f80, 0x3f350000, 0x3f220000, 0x3f62bf7b, 0xbdc93f35, 0x3f75bf0e
  .long 0x3f55bf80, 0xbe48bec4, 0x3f0e0000, 0x3f7bbf6d, 0xbef10000, 0xbf7f3f55, 0x3f75bf35, 0x3f46bf7b
  .long 0xbf6d3f80, 0xbec43f35, 0x3f6dbf80, 0x3ec4bf35, 0x3e950000, 0x3f46bf0e, 0x3ef1bf35, 0xbdc9be48
  .long 0x3f7bbf80, 0x3f55bf6d, 0xbe480000, 0xbf0e3ec4, 0xbdc90000, 0xbe953e48, 0xbf463f35, 0xbf623f55
  .long 0x3f803f80, 0x3f803f80, 0x3f803f80, 0x3f803f80, 0x3ef13ec4, 0x3f223f0e, 0x3f753f6d, 0x3f7f3f7b
  .long 0xbf0ebf35, 0xbe48bec4, 0x3f553f35, 0x3f7b3f6d, 0xbf7fbf6d, 0xbf62bf7b, 0x3f223ec4, 0x3f753f55
  .long 0xbec40000, 0xbf6dbf35, 0x3ec40000, 0x3f6d3f35, 0x3f223f6d, 0xbe953e48, 0x3dc9bec4, 0x3f623f0e
  .long 0x3f7b3f35, 0x3f0e3f6d, 0xbe48bf35, 0x3f553ec4, 0x3e95bec4, 0x3f7f3f55, 0xbef1bf6d, 0x3f463e48
  .long 0xbf35bf80, 0x3f350000, 0xbf35bf80, 0x3f350000, 0xbf75bec4, 0xbdc9bf55, 0xbf62bf6d, 0x3f22be48
  .long 0xbe483f35, 0xbf55bf6d, 0xbf7bbf35, 0x3f0ebec4, 0x3f463f6d, 0xbf75be48, 0xbf7fbec4, 0x3ef1bf0e
  .long 0x3f6d0000, 0xbec43f35, 0xbf6d0000, 0x3ec4bf35, 0x3dc9bf6d, 0x3ef13f7b, 0xbf463ec4, 0x3e95bf55
  .long 0xbf55bf35, 0x3f7b3ec4, 0xbf0e3f35, 0x3e48bf6d, 0xbf623ec4, 0x3f46bf0e, 0xbe953f6d, 0x3dc9bf7b
  .long 0x00003f80, 0x0000bf80, 0x00003f80, 0x0000bf80, 0x3f623ec4, 0xbf46bf0e, 0x3e953f6d, 0xbdc9bf7b
  .long 0x3f55bf35, 0xbf7b3ec4, 0x3f0e3f35, 0xbe48bf6d, 0xbdc9bf6d, 0xbef13f7b, 0x3f463ec4, 0xbe95bf55
  .long 0xbf6d0000, 0x3ec43f35, 0x3f6d0000, 0xbec4bf35, 0xbf463f6d, 0x3f75be48, 0x3f7fbec4, 0xbef1bf0e
  .long 0x3e483f35, 0x3f55bf6d, 0x3f7bbf35, 0xbf0ebec4, 0x3f75bec4, 0x3dc9bf55, 0x3f62bf6d, 0xbf22be48
  .long 0x3f35bf80, 0xbf350000, 0x3f35bf80, 0xbf350000, 0xbe95bec4, 0xbf7f3f55, 0x3ef1bf6d, 0xbf463e48
  .long 0xbf7b3f35, 0xbf0e3f6d, 0x3e48bf35, 0xbf553ec4, 0xbf223f6d, 0x3e953e48, 0xbdc9bec4, 0xbf623f0e
  .long 0x3ec40000, 0x3f6dbf35, 0xbec40000, 0xbf6d3f35, 0x3f7fbf6d, 0x3f62bf7b, 0xbf223ec4, 0xbf753f55
  .long 0x3f0ebf35, 0x3e48bec4, 0xbf553f35, 0xbf7b3f6d, 0xbef13ec4, 0xbf223f0e, 0xbf753f6d, 0xbf7f3f7b
  .long 0xbf803f80, 0xbf803f80, 0xbf803f80, 0xbf803f80, 0xbf7f3f80, 0xbf753f7b, 0xbf223f35, 0xbef13f0e
  .long 0xbf7b3f80, 0xbf553f6d, 0x3e480000, 0x3f0ebec4, 0xbf753f80, 0xbf223f55, 0x3f62bf35, 0x3f7fbf7b
  .long 0xbf6d3f80, 0xbec43f35, 0x3f6dbf80, 0x3ec4bf35, 0xbf623f80, 0xbdc93f0e, 0x3e95bf35, 0xbf223e48
  .long 0xbf553f80, 0x3e483ec4, 0xbf0e0000, 0xbf7b3f6d, 0xbf463f80, 0x3ef13e48, 0xbf7f3f35, 0xbe953f55
  .long 0xbf353f80, 0x3f350000, 0xbf353f80, 0x3f350000, 0xbf223f80, 0x3f62be48, 0x3dc93f35, 0x3f75bf55
  .long 0xbf0e3f80, 0x3f7bbec4, 0x3f550000, 0x3e48bf6d, 0xbef13f80, 0x3f7fbf0e, 0x3f75bf35, 0xbf46be48
  .long 0xbec43f80, 0x3f6dbf35, 0x3ec4bf80, 0xbf6d3f35, 0xbe953f80, 0x3f46bf55, 0xbef1bf35, 0xbdc93f7b
  .long 0xbe483f80, 0x3f0ebf6d, 0xbf7b0000, 0x3f553ec4, 0xbdc93f80, 0x3e95bf7b, 0xbf463f35, 0x3f62bf0e
  .long 0x00003f80, 0x0000bf80, 0x00003f80, 0x0000bf80, 0x3dc93f80, 0xbe95bf7b, 0x3f463f35, 0xbf62bf0e
  .long 0x3e483f80, 0xbf0ebf6d, 0x3f7b0000, 0xbf553ec4, 0x3e953f80, 0xbf46bf55, 0x3ef1bf35, 0x3dc93f7b
  .long 0x3ec43f80, 0xbf6dbf35, 0xbec4bf80, 0x3f6d3f35, 0x3ef13f80, 0xbf7fbf0e, 0xbf75bf35, 0x3f46be48
  .long 0x3f0e3f80, 0xbf7bbec4, 0xbf550000, 0xbe48bf6d, 0x3f223f80, 0xbf62be48, 0xbdc93f35, 0xbf75bf55
  .long 0x3f353f80, 0xbf350000, 0x3f353f80, 0xbf350000, 0x3f463f80, 0xbef13e48, 0x3f7f3f35, 0x3e953f55
  .long 0x3f553f80, 0xbe483ec4, 0x3f0e0000, 0x3f7b3f6d, 0x3f623f80, 0x3dc93f0e, 0xbe95bf35, 0x3f223e48
  .long 0x3f6d3f80, 0x3ec43f35, 0xbf6dbf80, 0xbec4bf35, 0x3f753f80, 0x3f223f55, 0xbf62bf35, 0xbf7fbf7b
  .long 0x3f7b3f80, 0x3f553f6d, 0xbe480000, 0xbf0ebec4, 0x3f7f3f80, 0x3f753f7b, 0x3f223f35, 0x3ef13f0e
  .long 0xbf803f80, 0xbf803f80, 0xbf803f80, 0xbf803f80, 0xbf623f6d, 0xbf463f55, 0xbe953ec4, 0xbdc93e48
  .long 0xbf0e3f35, 0xbe483ec4, 0x3f55bf35, 0x3f7bbf6d, 0xbdc93ec4, 0x3ef1be48, 0x3f46bf6d, 0x3e95bf0e
  .long 0x3ec40000, 0x3f6dbf35, 0xbec40000, 0xbf6d3f35, 0x3f46bec4, 0x3f75bf7b, 0xbf7f3f6d, 0xbef13f55
  .long 0x3f7bbf35, 0x3f0ebf6d, 0xbe483f35, 0x3f55bec4, 0x3f75bf6d, 0xbdc9bf0e, 0x3f62bec4, 0x3f22bf7b
  .long 0x3f35bf80, 0xbf350000, 0x3f35bf80, 0xbf350000, 0x3e95bf6d, 0xbf7f3f0e, 0xbef1bec4, 0xbf463f7b
  .long 0xbe48bf35, 0xbf553f6d, 0xbf7b3f35, 0x3f0e3ec4, 0xbf22bec4, 0xbe953f7b, 0xbdc93f6d, 0x3f62bf55
  .long 0xbf6d0000, 0x3ec43f35, 0x3f6d0000, 0xbec4bf35, 0xbf7f3ec4, 0x3f623e48, 0x3f22bf6d, 0xbf753f0e
  .long 0xbf553f35, 0x3f7bbec4, 0xbf0ebf35, 0x3e483f6d, 0xbef13f6d, 0x3f22bf55, 0xbf753ec4, 0x3f7fbe48
  .long 0x00003f80, 0x0000bf80, 0x00003f80, 0x0000bf80, 0x3ef13f6d, 0xbf22bf55, 0x3f753ec4, 0xbf7fbe48
  .long 0x3f553f35, 0xbf7bbec4, 0x3f0ebf35, 0xbe483f6d, 0x3f7f3ec4, 0xbf623e48, 0xbf22bf6d, 0x3f753f0e
  .long 0x3f6d0000, 0xbec43f35, 0xbf6d0000, 0x3ec4bf35, 0x3f22bec4, 0x3e953f7b, 0x3dc93f6d, 0xbf62bf55
  .long 0x3e48bf35, 0x3f553f6d, 0x3f7b3f35, 0xbf0e3ec4, 0xbe95bf6d, 0x3f7f3f0e, 0x3ef1bec4, 0x3f463f7b
  .long 0xbf35bf80, 0x3f350000, 0xbf35bf80, 0x3f350000, 0xbf75bf6d, 0x3dc9bf0e, 0xbf62bec4, 0xbf22bf7b
  .long 0xbf7bbf35, 0xbf0ebf6d, 0x3e483f35, 0xbf55bec4, 0xbf46bec4, 0xbf75bf7b, 0x3f7f3f6d, 0x3ef13f55
  .long 0xbec40000, 0xbf6dbf35, 0x3ec40000, 0x3f6d3f35, 0x3dc93ec4, 0xbef1be48, 0xbf46bf6d, 0xbe95bf0e
  .long 0x3f0e3f35, 0x3e483ec4, 0xbf55bf35, 0xbf7bbf6d, 0x3f623f6d, 0x3f463f55, 0x3e953ec4, 0x3dc93e48
  .long 0xbf803f80, 0xbf803f80, 0xbf803f80, 0xbf803f80, 0x3dc90000, 0x3e95be48, 0x3f46bf35, 0x3f62bf55
  .long 0x3f7bbf80, 0x3f55bf6d, 0xbe480000, 0xbf0e3ec4, 0xbe950000, 0xbf463f0e, 0xbef13f35, 0x3dc93e48
  .long 0xbf6d3f80, 0xbec43f35, 0x3f6dbf80, 0x3ec4bf35, 0x3ef10000, 0x3f7fbf55, 0xbf753f35, 0xbf463f7b
  .long 0x3f55bf80, 0xbe48bec4, 0x3f0e0000, 0x3f7bbf6d, 0xbf220000, 0xbf623f7b, 0x3dc9bf35, 0xbf753f0e
  .long 0xbf353f80, 0x3f350000, 0xbf353f80, 0x3f350000, 0x3f460000, 0x3ef1bf7b, 0x3f7fbf35, 0xbe95bf0e
  .long 0x3f0ebf80, 0xbf7b3ec4, 0xbf550000, 0xbe483f6d, 0xbf620000, 0x3dc93f55, 0x3e953f35, 0x3f22bf7b
  .long 0xbec43f80, 0x3f6dbf35, 0x3ec4bf80, 0xbf6d3f35, 0x3f750000, 0xbf22bf0e, 0xbf623f35, 0x3f7fbe48
  .long 0x3e48bf80, 0xbf0e3f6d, 0x3f7b0000, 0xbf55bec4, 0xbf7f0000, 0x3f753e48, 0xbf22bf35, 0x3ef13f55
  .long 0x00003f80, 0x0000bf80, 0x00003f80, 0x0000bf80, 0x3f7f0000, 0xbf753e48, 0x3f22bf35, 0xbef13f55
  .long 0xbe48bf80, 0x3f0e3f6d, 0xbf7b0000, 0x3f55bec4, 0xbf750000, 0x3f22bf0e, 0x3f623f35, 0xbf7fbe48
  .long 0x3ec43f80, 0xbf6dbf35, 0xbec4bf80, 0x3f6d3f35, 0x3f620000, 0xbdc93f55, 0xbe953f35, 0xbf22bf7b
  .long 0xbf0ebf80, 0x3f7b3ec4, 0x3f550000, 0x3e483f6d, 0xbf460000, 0xbef1bf7b, 0xbf7fbf35, 0x3e95bf0e
  .long 0x3f353f80, 0xbf350000, 0x3f353f80, 0xbf350000, 0x3f220000, 0x3f623f7b, 0xbdc9bf35, 0x3f753f0e
  .long 0xbf55bf80, 0x3e48bec4, 0xbf0e0000, 0xbf7bbf6d, 0xbef10000, 0xbf7fbf55, 0x3f753f35, 0x3f463f7b
  .long 0x3f6d3f80, 0x3ec43f35, 0xbf6dbf80, 0xbec4bf35, 0x3e950000, 0x3f463f0e, 0x3ef13f35, 0xbdc93e48
  .long 0xbf7bbf80, 0xbf55bf6d, 0x3e480000, 0x3f0e3ec4, 0xbdc90000, 0xbe95be48, 0xbf46bf35, 0xbf62bf55
  .long 0xbf803f80, 0xbf803f80, 0xbf803f80, 0xbf803f80, 0x3ef1bec4, 0x3f22bf0e, 0x3f75bf6d, 0x3f7fbf7b
  .long 0x3f0ebf35, 0x3e48bec4, 0xbf553f35, 0xbf7b3f6d, 0xbf7f3f6d, 0xbf623f7b, 0x3f22bec4, 0x3f75bf55
  .long 0x3ec40000, 0x3f6dbf35, 0xbec40000, 0xbf6d3f35, 0x3f22bf6d, 0xbe95be48, 0x3dc93ec4, 0x3f62bf0e
  .long 0xbf7b3f35, 0xbf0e3f6d, 0x3e48bf35, 0xbf553ec4, 0x3e953ec4, 0x3f7fbf55, 0xbef13f6d, 0x3f46be48
  .long 0x3f35bf80, 0xbf350000, 0x3f35bf80, 0xbf350000, 0xbf753ec4, 0xbdc93f55, 0xbf623f6d, 0x3f223e48
  .long 0x3e483f35, 0x3f55bf6d, 0x3f7bbf35, 0xbf0ebec4, 0x3f46bf6d, 0xbf753e48, 0xbf7f3ec4, 0x3ef13f0e
  .long 0xbf6d0000, 0x3ec43f35, 0x3f6d0000, 0xbec4bf35, 0x3dc93f6d, 0x3ef1bf7b, 0xbf46bec4, 0x3e953f55
  .long 0x3f55bf35, 0xbf7b3ec4, 0x3f0e3f35, 0xbe48bf6d, 0xbf62bec4, 0x3f463f0e, 0xbe95bf6d, 0x3dc93f7b
  .long 0x00003f80, 0x0000bf80, 0x00003f80, 0x0000bf80, 0x3f62bec4, 0xbf463f0e, 0x3e95bf6d, 0xbdc93f7b
  .long 0xbf55bf35, 0x3f7b3ec4, 0xbf0e3f35, 0x3e48bf6d, 0xbdc93f6d, 0xbef1bf7b, 0x3f46bec4, 0xbe953f55
  .long 0x3f6d0000, 0xbec43f35, 0xbf6d0000, 0x3ec4bf35, 0xbf46bf6d, 0x3f753e48, 0x3f7f3ec4, 0xbef13f0e
  .long 0xbe483f35, 0xbf55bf6d, 0xbf7bbf35, 0x3f0ebec4, 0x3f753ec4, 0x3dc93f55, 0x3f623f6d, 0xbf223e48
  .long 0xbf35bf80, 0x3f350000, 0xbf35bf80, 0x3f350000, 0xbe953ec4, 0xbf7fbf55, 0x3ef13f6d, 0xbf46be48
  .long 0x3f7b3f35, 0x3f0e3f6d, 0xbe48bf35, 0x3f553ec4, 0xbf22bf6d, 0x3e95be48, 0xbdc93ec4, 0xbf62bf0e
  .long 0xbec40000, 0xbf6dbf35, 0x3ec40000, 0x3f6d3f35, 0x3f7f3f6d, 0x3f623f7b, 0xbf22bec4, 0xbf75bf55
  .long 0xbf0ebf35, 0xbe48bec4, 0x3f553f35, 0x3f7b3f6d, 0xbef1bec4, 0xbf22bf0e, 0xbf75bf6d, 0xbf7fbf7b
  .long 0xbf803f80, 0xbf803f80, 0xbf803f80, 0xbf803f80, 0x3f7fbf80, 0x3f75bf7b, 0x3f22bf35, 0x3ef1bf0e
  .long 0xbf7b3f80, 0xbf553f6d, 0x3e480000, 0x3f0ebec4, 0x3f75bf80, 0x3f22bf55, 0xbf623f35, 0xbf7f3f7b
  .long 0xbf6d3f80, 0xbec43f35, 0x3f6dbf80, 0x3ec4bf35, 0x3f62bf80, 0x3dc9bf0e, 0xbe953f35, 0x3f22be48
  .long 0xbf553f80, 0x3e483ec4, 0xbf0e0000, 0xbf7b3f6d, 0x3f46bf80, 0xbef1be48, 0x3f7fbf35, 0x3e95bf55
  .long 0xbf353f80, 0x3f350000, 0xbf353f80, 0x3f350000, 0x3f22bf80, 0xbf623e48, 0xbdc9bf35, 0xbf753f55
  .long 0xbf0e3f80, 0x3f7bbec4, 0x3f550000, 0x3e48bf6d, 0x3ef1bf80, 0xbf7f3f0e, 0xbf753f35, 0x3f463e48
  .long 0xbec43f80, 0x3f6dbf35, 0x3ec4bf80, 0xbf6d3f35, 0x3e95bf80, 0xbf463f55, 0x3ef13f35, 0x3dc9bf7b
  .long 0xbe483f80, 0x3f0ebf6d, 0xbf7b0000, 0x3f553ec4, 0x3dc9bf80, 0xbe953f7b, 0x3f46bf35, 0xbf623f0e
  .long 0x00003f80, 0x0000bf80, 0x00003f80, 0x0000bf80, 0xbdc9bf80, 0x3e953f7b, 0xbf46bf35, 0x3f623f0e
  .long 0x3e483f80, 0xbf0ebf6d, 0x3f7b0000, 0xbf553ec4, 0xbe95bf80, 0x3f463f55, 0xbef13f35, 0xbdc9bf7b
  .long 0x3ec43f80, 0xbf6dbf35, 0xbec4bf80, 0x3f6d3f35, 0xbef1bf80, 0x3f7f3f0e, 0x3f753f35, 0xbf463e48
  .long 0x3f0e3f80, 0xbf7bbec4, 0xbf550000, 0xbe48bf6d, 0xbf22bf80, 0x3f623e48, 0x3dc9bf35, 0x3f753f55
  .long 0x3f353f80, 0xbf350000, 0x3f353f80, 0xbf350000, 0xbf46bf80, 0x3ef1be48, 0xbf7fbf35, 0xbe95bf55
  .long 0x3f553f80, 0xbe483ec4, 0x3f0e0000, 0x3f7b3f6d, 0xbf62bf80, 0xbdc9bf0e, 0x3e953f35, 0xbf22be48
  .long 0x3f6d3f80, 0x3ec43f35, 0xbf6dbf80, 0xbec4bf35, 0xbf75bf80, 0xbf22bf55, 0x3f623f35, 0x3f7f3f7b
  .long 0x3f7b3f80, 0x3f553f6d, 0xbe480000, 0xbf0ebec4, 0xbf7fbf80, 0xbf75bf7b, 0xbf22bf35, 0xbef1bf0e
  .long 0xbf803f80, 0xbf803f80, 0xbf803f80, 0xbf803f80, 0x3f62bf6d, 0x3f46bf55, 0x3e95bec4, 0x3dc9be48
  .long 0xbf0e3f35, 0xbe483ec4, 0x3f55bf35, 0x3f7bbf6d, 0x3dc9bec4, 0xbef13e48, 0xbf463f6d, 0xbe953f0e
  .long 0x3ec40000, 0x3f6dbf35, 0xbec40000, 0xbf6d3f35, 0xbf463ec4, 0xbf753f7b, 0x3f7fbf6d, 0x3ef1bf55
  .long 0x3f7bbf35, 0x3f0ebf6d, 0xbe483f35, 0x3f55bec4, 0xbf753f6d, 0x3dc93f0e, 0xbf623ec4, 0xbf223f7b
  .long 0x3f35bf80, 0xbf350000, 0x3f35bf80, 0xbf350000, 0xbe953f6d, 0x3f7fbf0e, 0x3ef13ec4, 0x3f46bf7b
  .long 0xbe48bf35, 0xbf553f6d, 0xbf7b3f35, 0x3f0e3ec4, 0x3f223ec4, 0x3e95bf7b, 0x3dc9bf6d, 0xbf623f55
  .long 0xbf6d0000, 0x3ec43f35, 0x3f6d0000, 0xbec4bf35, 0x3f7fbec4, 0xbf62be48, 0xbf223f6d, 0x3f75bf0e
  .long 0xbf553f35, 0x3f7bbec4, 0xbf0ebf35, 0x3e483f6d, 0x3ef1bf6d, 0xbf223f55, 0x3f75bec4, 0xbf7f3e48
  .long 0x00003f80, 0x0000bf80, 0x00003f80, 0x0000bf80, 0xbef1bf6d, 0x3f223f55, 0xbf75bec4, 0x3f7f3e48
  .long 0x3f553f35, 0xbf7bbec4, 0x3f0ebf35, 0xbe483f6d, 0xbf7fbec4, 0x3f62be48, 0x3f223f6d, 0xbf75bf0e
  .long 0x3f6d0000, 0xbec43f35, 0xbf6d0000, 0x3ec4bf35, 0xbf223ec4, 0xbe95bf7b, 0xbdc9bf6d, 0x3f623f55
  .long 0x3e48bf35, 0x3f553f6d, 0x3f7b3f35, 0xbf0e3ec4, 0x3e953f6d, 0xbf7fbf0e, 0xbef13ec4, 0xbf46bf7b
  .long 0xbf35bf80, 0x3f350000, 0xbf35bf80, 0x3f350000, 0x3f753f6d, 0xbdc93f0e, 0x3f623ec4, 0x3f223f7b
  .long 0xbf7bbf35, 0xbf0ebf6d, 0x3e483f35, 0xbf55bec4, 0x3f463ec4, 0x3f753f7b, 0xbf7fbf6d, 0xbef1bf55
  .long 0xbec40000, 0xbf6dbf35, 0x3ec40000, 0x3f6d3f35, 0xbdc9bec4, 0x3ef13e48, 0x3f463f6d, 0x3e953f0e
  .long 0x3f0e3f35, 0x3e483ec4, 0xbf55bf35, 0xbf7bbf6d, 0xbf62bf6d, 0xbf46bf55, 0xbe95bec4, 0xbdc9be48
  .long 0xbf803f80, 0xbf803f80, 0xbf803f80, 0xbf803f80, 0xbdc90000, 0xbe953e48, 0xbf463f35, 0xbf623f55
  .long 0x3f7bbf80, 0x3f55bf6d, 0xbe480000, 0xbf0e3ec4, 0x3e950000, 0x3f46bf0e, 0x3ef1bf35, 0xbdc9be48
  .long 0xbf6d3f80, 0xbec43f35, 0x3f6dbf80, 0x3ec4bf35, 0xbef10000, 0xbf7f3f55, 0x3f75bf35, 0x3f46bf7b
  .long 0x3f55bf80, 0xbe48bec4, 0x3f0e0000, 0x3f7bbf6d, 0x3f220000, 0x3f62bf7b, 0xbdc93f35, 0x3f75bf0e
  .long 0xbf353f80, 0x3f350000, 0xbf353f80, 0x3f350000, 0xbf460000, 0xbef13f7b, 0xbf7f3f35, 0x3e953f0e
  .long 0x3f0ebf80, 0xbf7b3ec4, 0xbf550000, 0xbe483f6d, 0x3f620000, 0xbdc9bf55, 0xbe95bf35, 0xbf223f7b
  .long 0xbec43f80, 0x3f6dbf35, 0x3ec4bf80, 0xbf6d3f35, 0xbf750000, 0x3f223f0e, 0x3f62bf35, 0xbf7f3e48
  .long 0x3e48bf80, 0xbf0e3f6d, 0x3f7b0000, 0xbf55bec4, 0x3f7f0000, 0xbf75be48, 0x3f223f35, 0xbef1bf55
  .long 0x00003f80, 0x0000bf80, 0x00003f80, 0x0000bf80, 0xbf7f0000, 0x3f75be48, 0xbf223f35, 0x3ef1bf55
  .long 0xbe48bf80, 0x3f0e3f6d, 0xbf7b0000, 0x3f55bec4, 0x3f750000, 0xbf223f0e, 0xbf62bf35, 0x3f7f3e48
  .long 0x3ec43f80, 0xbf6dbf35, 0xbec4bf80, 0x3f6d3f35, 0xbf620000, 0x3dc9bf55, 0x3e95bf35, 0x3f223f7b
  .long 0xbf0ebf80, 0x3f7b3ec4, 0x3f550000, 0x3e483f6d, 0x3f460000, 0x3ef13f7b, 0x3f7f3f35, 0xbe953f0e
  .long 0x3f353f80, 0xbf350000, 0x3f353f80, 0xbf350000, 0xbf220000, 0xbf62bf7b, 0x3dc93f35, 0xbf75bf0e
  .long 0xbf55bf80, 0x3e48bec4, 0xbf0e0000, 0xbf7bbf6d, 0x3ef10000, 0x3f7f3f55, 0xbf75bf35, 0xbf46bf7b
  .long 0x3f6d3f80, 0x3ec43f35, 0xbf6dbf80, 0xbec4bf35, 0xbe950000, 0xbf46bf0e, 0xbef1bf35, 0x3dc9be48
  .long 0xbf7bbf80, 0xbf55bf6d, 0x3e480000, 0x3f0e3ec4, 0x3dc90000, 0x3e953e48, 0x3f463f35, 0x3f623f55
  .long 0xbf803f80, 0xbf803f80, 0xbf803f80, 0xbf803f80, 0xbef13ec4, 0xbf223f0e, 0xbf753f6d, 0xbf7f3f7b
  .long 0x3f0ebf35, 0x3e48bec4, 0xbf553f35, 0xbf7b3f6d, 0x3f7fbf6d, 0x3f62bf7b, 0xbf223ec4, 0xbf753f55
  .long 0x3ec40000, 0x3f6dbf35, 0xbec40000, 0xbf6d3f35, 0xbf223f6d, 0x3e953e48, 0xbdc9bec4, 0xbf623f0e
  .long 0xbf7b3f35, 0xbf0e3f6d, 0x3e48bf35, 0xbf553ec4, 0xbe95bec4, 0xbf7f3f55, 0x3ef1bf6d, 0xbf463e48
  .long 0x3f35bf80, 0xbf350000, 0x3f35bf80, 0xbf350000, 0x3f75bec4, 0x3dc9bf55, 0x3f62bf6d, 0xbf22be48
  .long 0x3e483f35, 0x3f55bf6d, 0x3f7bbf35, 0xbf0ebec4, 0xbf463f6d, 0x3f75be48, 0x3f7fbec4, 0xbef1bf0e
  .long 0xbf6d0000, 0x3ec43f35, 0x3f6d0000, 0xbec4bf35, 0xbdc9bf6d, 0xbef13f7b, 0x3f463ec4, 0xbe95bf55
  .long 0x3f55bf35, 0xbf7b3ec4, 0x3f0e3f35, 0xbe48bf6d, 0x3f623ec4, 0xbf46bf0e, 0x3e953f6d, 0xbdc9bf7b
  .long 0x00003f80, 0x0000bf80, 0x00003f80, 0x0000bf80, 0xbf623ec4, 0x3f46bf0e, 0xbe953f6d, 0x3dc9bf7b
  .long 0xbf55bf35, 0x3f7b3ec4, 0xbf0e3f35, 0x3e48bf6d, 0x3dc9bf6d, 0x3ef13f7b, 0xbf463ec4, 0x3e95bf55
  .long 0x3f6d0000, 0xbec43f35, 0xbf6d0000, 0x3ec4bf35, 0x3f463f6d, 0xbf75be48, 0xbf7fbec4, 0x3ef1bf0e
  .long 0xbe483f35, 0xbf55bf6d, 0xbf7bbf35, 0x3f0ebec4, 0xbf75bec4, 0xbdc9bf55, 0xbf62bf6d, 0x3f22be48
  .long 0xbf35bf80, 0x3f350000, 0xbf35bf80, 0x3f350000, 0x3e95bec4, 0x3f7f3f55, 0xbef1bf6d, 0x3f463e48
  .long 0x3f7b3f35, 0x3f0e3f6d, 0xbe48bf35, 0x3f553ec4, 0x3f223f6d, 0xbe953e48, 0x3dc9bec4, 0x3f623f0e
  .long 0xbec40000, 0xbf6dbf35, 0x3ec40000, 0x3f6d3f35, 0xbf7fbf6d, 0xbf62bf7b, 0x3f223ec4, 0x3f753f55
  .long 0xbf0ebf35, 0xbe48bec4, 0x3f553f35, 0x3f7b3f6d, 0x3ef13ec4, 0x3f223f0e, 0x3f753f6d, 0x3f7f3f7b
  .long 0x00000000, 0x00000000, 0x00000000, 0x00000000, 0x3dc90000, 0x3e953e48, 0x3f463f35, 0x3f623f55
  .long 0x3e480000, 0x3f0e3ec4, 0x3f7b3f80, 0x3f553f6d, 0x3e950000, 0x3f463f0e, 0x3ef13f35, 0xbdc93e48
  .long 0x3ec40000, 0x3f6d3f35, 0xbec40000, 0xbf6dbf35, 0x3ef10000, 0x3f7f3f55, 0xbf75bf35, 0xbf46bf7b
  .long 0x3f0e0000, 0x3f7b3f6d, 0xbf55bf80, 0x3e48bec4, 0x3f220000, 0x3f623f7b, 0xbdc9bf35, 0x3f753f0e
  .long 0x3f350000, 0x3f353f80, 0x3f350000, 0x3f353f80, 0x3f460000, 0x3ef13f7b, 0x3f7f3f35, 0xbe953f0e
  .long 0x3f550000, 0x3e483f6d, 0x3f0e3f80, 0xbf7bbec4, 0x3f620000, 0xbdc93f55, 0xbe953f35, 0xbf22bf7b
  .long 0x3f6d0000, 0xbec43f35, 0xbf6d0000, 0x3ec4bf35, 0x3f750000, 0xbf223f0e, 0xbf62bf35, 0x3f7f3e48
  .long 0x3f7b0000, 0xbf553ec4, 0xbe48bf80, 0x3f0e3f6d, 0x3f7f0000, 0xbf753e48, 0x3f22bf35, 0xbef13f55
  .long 0x3f800000, 0xbf800000, 0x3f800000, 0xbf800000, 0x3f7f0000, 0xbf75be48, 0x3f223f35, 0xbef1bf55
  .long 0x3f7b0000, 0xbf55bec4, 0xbe483f80, 0x3f0ebf6d, 0x3f750000, 0xbf22bf0e, 0xbf623f35, 0x3f7fbe48
  .long 0x3f6d0000, 0xbec4bf35, 0xbf6d0000, 0x3ec43f35, 0x3f620000, 0xbdc9bf55, 0xbe95bf35, 0xbf223f7b
  .long 0x3f550000, 0x3e48bf6d, 0x3f0ebf80, 0xbf7b3ec4, 0x3f460000, 0x3ef1bf7b, 0x3f7fbf35, 0xbe95bf0e
  .long 0x3f350000, 0x3f35bf80, 0x3f350000, 0x3f35bf80, 0x3f220000, 0x3f62bf7b, 0xbdc93f35, 0x3f75bf0e
  .long 0x3f0e0000, 0x3f7bbf6d, 0xbf553f80, 0x3e483ec4, 0x3ef10000, 0x3f7fbf55, 0xbf753f35, 0xbf463f7b
  .long 0x3ec40000, 0x3f6dbf35, 0xbec40000, 0xbf6d3f35, 0x3e950000, 0x3f46bf0e, 0x3ef1bf35, 0xbdc9be48
  .long 0x3e480000, 0x3f0ebec4, 0x3f7bbf80, 0x3f55bf6d, 0x3dc90000, 0x3e95be48, 0x3f46bf35, 0x3f62bf55
  .long 0x00000000, 0x00000000, 0x00000000, 0x00000000, 0x3ef13ec4, 0x3f223f0e, 0x3f753f6d, 0x3f7f3f7b
  .long 0x3f553f35, 0x3f7b3f6d, 0x3f0e3f35, 0x3e483ec4, 0x3f7f3f6d, 0x3f623f7b, 0xbf22bec4, 0xbf75bf55
  .long 0x3f6d3f80, 0x3ec43f35, 0xbf6dbf80, 0xbec4bf35, 0x3f223f6d, 0xbe953e48, 0x3dc9bec4, 0x3f623f0e
  .long 0x3e483f35, 0xbf55bec4, 0x3f7b3f35, 0x3f0e3f6d, 0xbe953ec4, 0xbf7fbf55, 0x3ef13f6d, 0xbf46be48
  .long 0xbf350000, 0xbf35bf80, 0xbf350000, 0xbf35bf80, 0xbf75bec4, 0xbdc9bf55, 0xbf62bf6d, 0x3f22be48
  .long 0xbf7bbf35, 0x3f0ebec4, 0x3e48bf35, 0x3f553f6d, 0xbf46bf6d, 0x3f753e48, 0x3f7f3ec4, 0xbef13f0e
  .long 0xbec4bf80, 0x3f6d3f35, 0x3ec43f80, 0xbf6dbf35, 0x3dc9bf6d, 0x3ef13f7b, 0xbf463ec4, 0x3e95bf55
  .long 0x3f0ebf35, 0xbe483f6d, 0xbf55bf35, 0x3f7b3ec4, 0x3f62bec4, 0xbf463f0e, 0x3e95bf6d, 0xbdc93f7b
  .long 0x3f800000, 0xbf800000, 0x3f800000, 0xbf800000, 0x3f623ec4, 0xbf46bf0e, 0x3e953f6d, 0xbdc9bf7b
  .long 0x3f0e3f35, 0xbe48bf6d, 0xbf553f35, 0x3f7bbec4, 0x3dc93f6d, 0x3ef1bf7b, 0xbf46bec4, 0x3e953f55
  .long 0xbec43f80, 0x3f6dbf35, 0x3ec4bf80, 0xbf6d3f35, 0xbf463f6d, 0x3f75be48, 0x3f7fbec4, 0xbef1bf0e
  .long 0xbf7b3f35, 0x3f0e3ec4, 0x3e483f35, 0x3f55bf6d, 0xbf753ec4, 0xbdc93f55, 0xbf623f6d, 0x3f223e48
  .long 0xbf350000, 0xbf353f80, 0xbf350000, 0xbf353f80, 0xbe95bec4, 0xbf7f3f55, 0x3ef1bf6d, 0xbf463e48
  .long 0x3e48bf35, 0xbf553ec4, 0x3f7bbf35, 0x3f0ebf6d, 0x3f22bf6d, 0xbe95be48, 0x3dc93ec4, 0x3f62bf0e
  .long 0x3f6dbf80, 0x3ec4bf35, 0xbf6d3f80, 0xbec43f35, 0x3f7fbf6d, 0x3f62bf7b, 0xbf223ec4, 0xbf753f55
  .long 0x3f55bf35, 0x3f7bbf6d, 0x3f0ebf35, 0x3e48bec4, 0x3ef1bec4, 0x3f22bf0e, 0x3f75bf6d, 0x3f7fbf7b
  .long 0x00000000, 0x00000000, 0x00000000, 0x00000000, 0x3f7f3f80, 0x3f753f7b, 0x3f223f35, 0x3ef13f0e
  .long 0xbe480000, 0xbf0ebec4, 0xbf7bbf80, 0xbf55bf6d, 0xbf75bf80, 0xbf22bf55, 0x3f623f35, 0x3f7f3f7b
  .long 0x3ec40000, 0x3f6d3f35, 0xbec40000, 0xbf6dbf35, 0x3f623f80, 0x3dc93f0e, 0xbe95bf35, 0x3f223e48
  .long 0xbf0e0000, 0xbf7bbf6d, 0x3f553f80, 0xbe483ec4, 0xbf46bf80, 0x3ef1be48, 0xbf7fbf35, 0xbe95bf55
  .long 0x3f350000, 0x3f353f80, 0x3f350000, 0x3f353f80, 0x3f223f80, 0xbf62be48, 0xbdc93f35, 0xbf75bf55
  .long 0xbf550000, 0xbe48bf6d, 0xbf0ebf80, 0x3f7b3ec4, 0xbef1bf80, 0x3f7f3f0e, 0x3f753f35, 0xbf463e48
  .long 0x3f6d0000, 0xbec43f35, 0xbf6d0000, 0x3ec4bf35, 0x3e953f80, 0xbf46bf55, 0x3ef1bf35, 0x3dc93f7b
  .long 0xbf7b0000, 0x3f55bec4, 0x3e483f80, 0xbf0ebf6d, 0xbdc9bf80, 0x3e953f7b, 0xbf46bf35, 0x3f623f0e
  .long 0x3f800000, 0xbf800000, 0x3f800000, 0xbf800000, 0xbdc93f80, 0x3e95bf7b, 0xbf463f35, 0x3f62bf0e
  .long 0xbf7b0000, 0x3f553ec4, 0x3e48bf80, 0xbf0e3f6d, 0x3e95bf80, 0xbf463f55, 0x3ef13f35, 0x3dc9bf7b
  .long 0x3f6d0000, 0xbec4bf35, 0xbf6d0000, 0x3ec43f35, 0xbef13f80, 0x3f7fbf0e, 0x3f75bf35, 0xbf46be48
  .long 0xbf550000, 0xbe483f6d, 0xbf0e3f80, 0x3f7bbec4, 0x3f22bf80, 0xbf623e48, 0xbdc9bf35, 0xbf753f55
  .long 0x3f350000, 0x3f35bf80, 0x3f350000, 0x3f35bf80, 0xbf463f80, 0x3ef13e48, 0xbf7f3f35, 0xbe953f55
  .long 0xbf0e0000, 0xbf7b3f6d, 0x3f55bf80, 0xbe48bec4, 0x3f62bf80, 0x3dc9bf0e, 0xbe953f35, 0x3f22be48
  .long 0x3ec40000, 0x3f6dbf35, 0xbec40000, 0xbf6d3f35, 0xbf753f80, 0xbf223f55, 0x3f62bf35, 0x3f7fbf7b
  .long 0xbe480000, 0xbf0e3ec4, 0xbf7b3f80, 0xbf553f6d, 0x3f7fbf80, 0x3f75bf7b, 0x3f22bf35, 0x3ef1bf0e
  .long 0x00000000, 0x00000000, 0x00000000, 0x00000000, 0x3f623f6d, 0x3f463f55, 0x3e953ec4, 0x3dc93e48
  .long 0xbf55bf35, 0xbf7bbf6d, 0xbf0ebf35, 0xbe48bec4, 0xbdc9bec4, 0x3ef13e48, 0x3f463f6d, 0x3e953f0e
  .long 0x3f6d3f80, 0x3ec43f35, 0xbf6dbf80, 0xbec4bf35, 0xbf46bec4, 0xbf75bf7b, 0x3f7f3f6d, 0x3ef13f55
  .long 0xbe48bf35, 0x3f553ec4, 0xbf7bbf35, 0xbf0ebf6d, 0x3f753f6d, 0xbdc93f0e, 0x3f623ec4, 0x3f223f7b
  .long 0xbf350000, 0xbf35bf80, 0xbf350000, 0xbf35bf80, 0xbe95bf6d, 0x3f7f3f0e, 0x3ef1bec4, 0x3f463f7b
  .long 0x3f7b3f35, 0xbf0e3ec4, 0xbe483f35, 0xbf55bf6d, 0xbf223ec4, 0xbe95bf7b, 0xbdc9bf6d, 0x3f623f55
  .long 0xbec4bf80, 0x3f6d3f35, 0x3ec43f80, 0xbf6dbf35, 0x3f7f3ec4, 0xbf623e48, 0xbf22bf6d, 0x3f753f0e
  .long 0xbf0e3f35, 0x3e48bf6d, 0x3f553f35, 0xbf7bbec4, 0xbef1bf6d, 0x3f223f55, 0xbf75bec4, 0x3f7f3e48
  .long 0x3f800000, 0xbf800000, 0x3f800000, 0xbf800000, 0xbef13f6d, 0x3f22bf55, 0xbf753ec4, 0x3f7fbe48
  .long 0xbf0ebf35, 0x3e483f6d, 0x3f55bf35, 0xbf7b3ec4, 0x3f7fbec4, 0xbf62be48, 0xbf223f6d, 0x3f75bf0e
  .long 0xbec43f80, 0x3f6dbf35, 0x3ec4bf80, 0xbf6d3f35, 0xbf22bec4, 0xbe953f7b, 0xbdc93f6d, 0x3f62bf55
  .long 0x3f7bbf35, 0xbf0ebec4, 0xbe48bf35, 0xbf553f6d, 0xbe953f6d, 0x3f7fbf0e, 0x3ef13ec4, 0x3f46bf7b
  .long 0xbf350000, 0xbf353f80, 0xbf350000, 0xbf353f80, 0x3f75bf6d, 0xbdc9bf0e, 0x3f62bec4, 0x3f22bf7b
  .long 0xbe483f35, 0x3f55bec4, 0xbf7b3f35, 0xbf0e3f6d, 0xbf463ec4, 0xbf753f7b, 0x3f7fbf6d, 0x3ef1bf55
  .long 0x3f6dbf80, 0x3ec4bf35, 0xbf6d3f80, 0xbec43f35, 0xbdc93ec4, 0x3ef1be48, 0x3f46bf6d, 0x3e95bf0e
  .long 0xbf553f35, 0xbf7b3f6d, 0xbf0e3f35, 0xbe483ec4, 0x3f62bf6d, 0x3f46bf55, 0x3e95bec4, 0x3dc9be48
  .long 0x00000000, 0x00000000, 0x00000000, 0x00000000, 0xbdc90000, 0xbe95be48, 0xbf46bf35, 0xbf62bf55
  .long 0x3e480000, 0x3f0e3ec4, 0x3f7b3f80, 0x3f553f6d, 0xbe950000, 0xbf46bf0e, 0xbef1bf35, 0x3dc9be48
  .long 0x3ec40000, 0x3f6d3f35, 0xbec40000, 0xbf6dbf35, 0xbef10000, 0xbf7fbf55, 0x3f753f35, 0x3f463f7b
  .long 0x3f0e0000, 0x3f7b3f6d, 0xbf55bf80, 0x3e48bec4, 0xbf220000, 0xbf62bf7b, 0x3dc93f35, 0xbf75bf0e
  .long 0x3f350000, 0x3f353f80, 0x3f350000, 0x3f353f80, 0xbf460000, 0xbef1bf7b, 0xbf7fbf35, 0x3e95bf0e
  .long 0x3f550000, 0x3e483f6d, 0x3f0e3f80, 0xbf7bbec4, 0xbf620000, 0x3dc9bf55, 0x3e95bf35, 0x3f223f7b
  .long 0x3f6d0000, 0xbec43f35, 0xbf6d0000, 0x3ec4bf35, 0xbf750000, 0x3f22bf0e, 0x3f623f35, 0xbf7fbe48
  .long 0x3f7b0000, 0xbf553ec4, 0xbe48bf80, 0x3f0e3f6d, 0xbf7f0000, 0x3f75be48, 0xbf223f35, 0x3ef1bf55
  .long 0x3f800000, 0xbf800000, 0x3f800000, 0xbf800000, 0xbf7f0000, 0x3f753e48, 0xbf22bf35, 0x3ef13f55
  .long 0x3f7b0000, 0xbf55bec4, 0xbe483f80, 0x3f0ebf6d, 0xbf750000, 0x3f223f0e, 0x3f62bf35, 0xbf7f3e48
  .long 0x3f6d0000, 0xbec4bf35, 0xbf6d0000, 0x3ec43f35, 0xbf620000, 0x3dc93f55, 0x3e953f35, 0x3f22bf7b
  .long 0x3f550000, 0x3e48bf6d, 0x3f0ebf80, 0xbf7b3ec4, 0xbf460000, 0xbef13f7b, 0xbf7f3f35, 0x3e953f0e
  .long 0x3f350000, 0x3f35bf80, 0x3f350000, 0x3f35bf80, 0xbf220000, 0xbf623f7b, 0x3dc9bf35, 0xbf753f0e
  .long 0x3f0e0000, 0x3f7bbf6d, 0xbf553f80, 0x3e483ec4, 0xbef10000, 0xbf7f3f55, 0x3f75bf35, 0x3f46bf7b
  .long 0x3ec40000, 0x3f6dbf35, 0xbec40000, 0xbf6d3f35, 0xbe950000, 0xbf463f0e, 0xbef13f35, 0x3dc93e48
  .long 0x3e480000, 0x3f0ebec4, 0x3f7bbf80, 0x3f55bf6d, 0xbdc90000, 0xbe953e48, 0xbf463f35, 0xbf623f55
  .long 0x00000000, 0x00000000, 0x00000000, 0x00000000, 0xbef1bec4, 0xbf22bf0e, 0xbf75bf6d, 0xbf7fbf7b
  .long 0x3f553f35, 0x3f7b3f6d, 0x3f0e3f35, 0x3e483ec4, 0xbf7fbf6d, 0xbf62bf7b, 0x3f223ec4, 0x3f753f55
  .long 0x3f6d3f80, 0x3ec43f35, 0xbf6dbf80, 0xbec4bf35, 0xbf22bf6d, 0x3e95be48, 0xbdc93ec4, 0xbf62bf0e
  .long 0x3e483f35, 0xbf55bec4, 0x3f7b3f35, 0x3f0e3f6d, 0x3e95bec4, 0x3f7f3f55, 0xbef1bf6d, 0x3f463e48
  .long 0xbf350000, 0xbf35bf80, 0xbf350000, 0xbf35bf80, 0x3f753ec4, 0x3dc93f55, 0x3f623f6d, 0xbf223e48
  .long 0xbf7bbf35, 0x3f0ebec4, 0x3e48bf35, 0x3f553f6d, 0x3f463f6d, 0xbf75be48, 0xbf7fbec4, 0x3ef1bf0e
  .long 0xbec4bf80, 0x3f6d3f35, 0x3ec43f80, 0xbf6dbf35, 0xbdc93f6d, 0xbef1bf7b, 0x3f46bec4, 0xbe953f55
  .long 0x3f0ebf35, 0xbe483f6d, 0xbf55bf35, 0x3f7b3ec4, 0xbf623ec4, 0x3f46bf0e, 0xbe953f6d, 0x3dc9bf7b
  .long 0x3f800000, 0xbf800000, 0x3f800000, 0xbf800000, 0xbf62bec4, 0x3f463f0e, 0xbe95bf6d, 0x3dc93f7b
  .long 0x3f0e3f35, 0xbe48bf6d, 0xbf553f35, 0x3f7bbec4, 0xbdc9bf6d, 0xbef13f7b, 0x3f463ec4, 0xbe95bf55
  .long 0xbec43f80, 0x3f6dbf35, 0x3ec4bf80, 0xbf6d3f35, 0x3f46bf6d, 0xbf753e48, 0xbf7f3ec4, 0x3ef13f0e
  .long 0xbf7b3f35, 0x3f0e3ec4, 0x3e483f35, 0x3f55bf6d, 0x3f75bec4, 0x3dc9bf55, 0x3f62bf6d, 0xbf22be48
  .long 0xbf350000, 0xbf353f80, 0xbf350000, 0xbf353f80, 0x3e953ec4, 0x3f7fbf55, 0xbef13f6d, 0x3f46be48
  .long 0x3e48bf35, 0xbf553ec4, 0x3f7bbf35, 0x3f0ebf6d, 0xbf223f6d, 0x3e953e48, 0xbdc9bec4, 0xbf623f0e
  .long 0x3f6dbf80, 0x3ec4bf35, 0xbf6d3f80, 0xbec43f35, 0xbf7f3f6d, 0xbf623f7b, 0x3f22bec4, 0x3f75bf55
  .long 0x3f55bf35, 0x3f7bbf6d, 0x3f0ebf35, 0x3e48bec4, 0xbef13ec4, 0xbf223f0e, 0xbf753f6d, 0xbf7f3f7b
  .long 0x00000000, 0x00000000, 0x00000000, 0x00000000, 0xbf7fbf80, 0xbf75bf7b, 0xbf22bf35, 0xbef1bf0e
  .long 0xbe480000, 0xbf0ebec4, 0xbf7bbf80, 0xbf55bf6d, 0x3f753f80, 0x3f223f55, 0xbf62bf35, 0xbf7fbf7b
  .long 0x3ec40000, 0x3f6d3f35, 0xbec40000, 0xbf6dbf35, 0xbf62bf80, 0xbdc9bf0e, 0x3e953f35, 0xbf22be48
  .long 0xbf0e0000, 0xbf7bbf6d, 0x3f553f80, 0xbe483ec4, 0x3f463f80, 0xbef13e48, 0x3f7f3f35, 0x3e953f55
  .long 0x3f350000, 0x3f353f80, 0x3f350000, 0x3f353f80, 0xbf22bf80, 0x3f623e48, 0x3dc9bf35, 0x3f753f55
  .long 0xbf550000, 0xbe48bf6d, 0xbf0ebf80, 0x3f7b3ec4, 0x3ef13f80, 0xbf7fbf0e, 0xbf75bf35, 0x3f46be48
  .long 0x3f6d0000, 0xbec43f35, 0xbf6d0000, 0x3ec4bf35, 0xbe95bf80, 0x3f463f55, 0xbef13f35, 0xbdc9bf7b
  .long 0xbf7b0000, 0x3f55bec4, 0x3e483f80, 0xbf0ebf6d, 0x3dc93f80, 0xbe95bf7b, 0x3f463f35, 0xbf62bf0e
  .long 0x3f800000, 0xbf800000, 0x3f800000, 0xbf800000, 0x3dc9bf80, 0xbe953f7b, 0x3f46bf35, 0xbf623f0e
  .long 0xbf7b0000, 0x3f553ec4, 0x3e48bf80, 0xbf0e3f6d, 0xbe953f80, 0x3f46bf55, 0xbef1bf35, 0xbdc93f7b
  .long 0x3f6d0000, 0xbec4bf35, 0xbf6d0000, 0x3ec43f35, 0x3ef1bf80, 0xbf7f3f0e, 0xbf753f35, 0x3f463e48
  .long 0xbf550000, 0xbe483f6d, 0xbf0e3f80, 0x3f7bbec4, 0xbf223f80, 0x3f62be48, 0x3dc93f35, 0x3f75bf55
  .long 0x3f350000, 0x3f35bf80, 0x3f350000, 0x3f35bf80, 0x3f46bf80, 0xbef1be48, 0x3f7fbf35, 0x3e95bf55
  .long 0xbf0e0000, 0xbf7b3f6d, 0x3f55bf80, 0xbe48bec4, 0xbf623f80, 0xbdc93f0e, 0x3e95bf35, 0xbf223e48
  .long 0x3ec40000, 0x3f6dbf35, 0xbec40000, 0xbf6d3f35, 0x3f75bf80, 0x3f22bf55, 0xbf623f35, 0xbf7f3f7b
  .long 0xbe480000, 0xbf0e3ec4, 0xbf7b3f80, 0xbf553f6d, 0xbf7f3f80, 0xbf753f7b, 0xbf223f35, 0xbef13f0e
  .long 0x00000000, 0x00000000, 0x00000000, 0x00000000, 0xbf62bf6d, 0xbf46bf55, 0xbe95bec4, 0xbdc9be48
  .long 0xbf55bf35, 0xbf7bbf6d, 0xbf0ebf35, 0xbe48bec4, 0x3dc93ec4, 0xbef1be48, 0xbf46bf6d, 0xbe95bf0e
  .long 0x3f6d3f80, 0x3ec43f35, 0xbf6dbf80, 0xbec4bf35, 0x3f463ec4, 0x3f753f7b, 0xbf7fbf6d, 0xbef1bf55
  .long 0xbe48bf35, 0x3f553ec4, 0xbf7bbf35, 0xbf0ebf6d, 0xbf75bf6d, 0x3dc9bf0e, 0xbf62bec4, 0xbf22bf7b
  .long 0xbf350000, 0xbf35bf80, 0xbf350000, 0xbf35bf80, 0x3e953f6d, 0xbf7fbf0e, 0xbef13ec4, 0xbf46bf7b
  .long 0x3f7b3f35, 0xbf0e3ec4, 0xbe483f35, 0xbf55bf6d, 0x3f22bec4, 0x3e953f7b, 0x3dc93f6d, 0xbf62bf55
  .long 0xbec4bf80, 0x3f6d3f35, 0x3ec43f80, 0xbf6dbf35, 0xbf7fbec4, 0x3f62be48, 0x3f223f6d, 0xbf75bf0e
  .long 0xbf0e3f35, 0x3e48bf6d, 0x3f553f35, 0xbf7bbec4, 0x3ef13f6d, 0xbf22bf55, 0x3f753ec4, 0xbf7fbe48
  .long 0x3f800000, 0xbf800000, 0x3f800000, 0xbf800000, 0x3ef1bf6d, 0xbf223f55, 0x3f75bec4, 0xbf7f3e48
  .long 0xbf0ebf35, 0x3e483f6d, 0x3f55bf35, 0xbf7b3ec4, 0xbf7f3ec4, 0x3f623e48, 0x3f22bf6d, 0xbf753f0e
  .long 0xbec43f80, 0x3f6dbf35, 0x3ec4bf80, 0xbf6d3f35, 0x3f223ec4, 0x3e95bf7b, 0x3dc9bf6d, 0xbf623f55
  .long 0x3f7bbf35, 0xbf0ebec4, 0xbe48bf35, 0xbf553f6d, 0x3e95bf6d, 0xbf7f3f0e, 0xbef1bec4, 0xbf463f7b
  .long 0xbf350000, 0xbf353f80, 0xbf350000, 0xbf353f80, 0xbf753f6d, 0x3dc93f0e, 0xbf623ec4, 0xbf223f7b
  .long 0xbe483f35, 0x3f55bec4, 0xbf7b3f35, 0xbf0e3f6d, 0x3f46bec4, 0x3f75bf7b, 0xbf7f3f6d, 0xbef13f55
  .long 0x3f6dbf80, 0x3ec4bf35, 0xbf6d3f80, 0xbec43f35, 0x3dc9bec4, 0xbef13e48, 0xbf463f6d, 0xbe953f0e
  .long 0xbf553f35, 0xbf7b3f6d, 0xbf0e3f35, 0xbe483ec4, 0xbf623f6d, 0xbf463f55, 0xbe953ec4, 0xbdc93e48
  .long 0x00000000, 0x00000000, 0x00000000, 0x00000000, 0xbdc90000, 0xbe953e48, 0xbf463f35, 0xbf623f55
  .long 0xbe480000, 0xbf0e3ec4, 0xbf7b3f80, 0xbf553f6d, 0xbe950000, 0xbf463f0e, 0xbef13f35, 0x3dc93e48
  .long 0xbec40000, 0xbf6d3f35, 0x3ec40000, 0x3f6dbf35, 0xbef10000, 0xbf7f3f55, 0x3f75bf35, 0x3f46bf7b
  .long 0xbf0e0000, 0xbf7b3f6d, 0x3f55bf80, 0xbe48bec4, 0xbf220000, 0xbf623f7b, 0x3dc9bf35, 0xbf753f0e
  .long 0xbf350000, 0xbf353f80, 0xbf350000, 0xbf353f80, 0xbf460000, 0xbef13f7b, 0xbf7f3f35, 0x3e953f0e
  .long 0xbf550000, 0xbe483f6d, 0xbf0e3f80, 0x3f7bbec4, 0xbf620000, 0x3dc93f55, 0x3e953f35, 0x3f22bf7b
  .long 0xbf6d0000, 0x3ec43f35, 0x3f6d0000, 0xbec4bf35, 0xbf750000, 0x3f223f0e, 0x3f62bf35, 0xbf7f3e48
  .long 0xbf7b0000, 0x3f553ec4, 0x3e48bf80, 0xbf0e3f6d, 0xbf7f0000, 0x3f753e48, 0xbf22bf35, 0x3ef13f55
  .long 0xbf800000, 0x3f800000, 0xbf800000, 0x3f800000, 0xbf7f0000, 0x3f75be48, 0xbf223f35, 0x3ef1bf55
  .long 0xbf7b0000, 0x3f55bec4, 0x3e483f80, 0xbf0ebf6d, 0xbf750000, 0x3f22bf0e, 0x3f623f35, 0xbf7fbe48
  .long 0xbf6d0000, 0x3ec4bf35, 0x3f6d0000, 0xbec43f35, 0xbf620000, 0x3dc9bf55, 0x3e95bf35, 0x3f223f7b
  .long 0xbf550000, 0xbe48bf6d, 0xbf0ebf80, 0x3f7b3ec4, 0xbf460000, 0xbef1bf7b, 0xbf7fbf35, 0x3e95bf0e
  .long 0xbf350000, 0xbf35bf80, 0xbf350000, 0xbf35bf80, 0xbf220000, 0xbf62bf7b, 0x3dc93f35, 0xbf75bf0e
  .long 0xbf0e0000, 0xbf7bbf6d, 0x3f553f80, 0xbe483ec4, 0xbef10000, 0xbf7fbf55, 0x3f753f35, 0x3f463f7b
  .long 0xbec40000, 0xbf6dbf35, 0x3ec40000, 0x3f6d3f35, 0xbe950000, 0xbf46bf0e, 0xbef1bf35, 0x3dc9be48
  .long 0xbe480000, 0xbf0ebec4, 0xbf7bbf80, 0xbf55bf6d, 0xbdc90000, 0xbe95be48, 0xbf46bf35, 0xbf62bf55
  .long 0x00000000, 0x00000000, 0x00000000, 0x00000000, 0xbef13ec4, 0xbf223f0e, 0xbf753f6d, 0xbf7f3f7b
  .long 0xbf553f35, 0xbf7b3f6d, 0xbf0e3f35, 0xbe483ec4, 0xbf7f3f6d, 0xbf623f7b, 0x3f22bec4, 0x3f75bf55
  .long 0xbf6d3f80, 0xbec43f35, 0x3f6dbf80, 0x3ec4bf35, 0xbf223f6d, 0x3e953e48, 0xbdc9bec4, 0xbf623f0e
  .long 0xbe483f35, 0x3f55bec4, 0xbf7b3f35, 0xbf0e3f6d, 0x3e953ec4, 0x3f7fbf55, 0xbef13f6d, 0x3f46be48
  .long 0x3f350000, 0x3f35bf80, 0x3f350000, 0x3f35bf80, 0x3f75bec4, 0x3dc9bf55, 0x3f62bf6d, 0xbf22be48
  .long 0x3f7bbf35, 0xbf0ebec4, 0xbe48bf35, 0xbf553f6d, 0x3f46bf6d, 0xbf753e48, 0xbf7f3ec4, 0x3ef13f0e
  .long 0x3ec4bf80, 0xbf6d3f35, 0xbec43f80, 0x3f6dbf35, 0xbdc9bf6d, 0xbef13f7b, 0x3f463ec4, 0xbe95bf55
  .long 0xbf0ebf35, 0x3e483f6d, 0x3f55bf35, 0xbf7b3ec4, 0xbf62bec4, 0x3f463f0e, 0xbe95bf6d, 0x3dc93f7b
  .long 0xbf800000, 0x3f800000, 0xbf800000, 0x3f800000, 0xbf623ec4, 0x3f46bf0e, 0xbe953f6d, 0x3dc9bf7b
  .long 0xbf0e3f35, 0x3e48bf6d, 0x3f553f35, 0xbf7bbec4, 0xbdc93f6d, 0xbef1bf7b, 0x3f46bec4, 0xbe953f55
  .long 0x3ec43f80, 0xbf6dbf35, 0xbec4bf80, 0x3f6d3f35, 0x3f463f6d, 0xbf75be48, 0xbf7fbec4, 0x3ef1bf0e
  .long 0x3f7b3f35, 0xbf0e3ec4, 0xbe483f35, 0xbf55bf6d, 0x3f753ec4, 0x3dc93f55, 0x3f623f6d, 0xbf223e48
  .long 0x3f350000, 0x3f353f80, 0x3f350000, 0x3f353f80, 0x3e95bec4, 0x3f7f3f55, 0xbef1bf6d, 0x3f463e48
  .long 0xbe48bf35, 0x3f553ec4, 0xbf7bbf35, 0xbf0ebf6d, 0xbf22bf6d, 0x3e95be48, 0xbdc93ec4, 0xbf62bf0e
  .long 0xbf6dbf80, 0xbec4bf35, 0x3f6d3f80, 0x3ec43f35, 0xbf7fbf6d, 0xbf62bf7b, 0x3f223ec4, 0x3f753f55
  .long 0xbf55bf35, 0xbf7bbf6d, 0xbf0ebf35, 0xbe48bec4, 0xbef1bec4, 0xbf22bf0e, 0xbf75bf6d, 0xbf7fbf7b
  .long 0x00000000, 0x00000000, 0x00000000, 0x00000000, 0xbf7f3f80, 0xbf753f7b, 0xbf223f35, 0xbef13f0e
  .long 0x3e480000, 0x3f0ebec4, 0x3f7bbf80, 0x3f55bf6d, 0x3f75bf80, 0x3f22bf55, 0xbf623f35, 0xbf7f3f7b
  .long 0xbec40000, 0xbf6d3f35, 0x3ec40000, 0x3f6dbf35, 0xbf623f80, 0xbdc93f0e, 0x3e95bf35, 0xbf223e48
  .long 0x3f0e0000, 0x3f7bbf6d, 0xbf553f80, 0x3e483ec4, 0x3f46bf80, 0xbef1be48, 0x3f7fbf35, 0x3e95bf55
  .long 0xbf350000, 0xbf353f80, 0xbf350000, 0xbf353f80, 0xbf223f80, 0x3f62be48, 0x3dc93f35, 0x3f75bf55
  .long 0x3f550000, 0x3e48bf6d, 0x3f0ebf80, 0xbf7b3ec4, 0x3ef1bf80, 0xbf7f3f0e, 0xbf753f35, 0x3f463e48
  .long 0xbf6d0000, 0x3ec43f35, 0x3f6d0000, 0xbec4bf35, 0xbe953f80, 0x3f46bf55, 0xbef1bf35, 0xbdc93f7b
  .long 0x3f7b0000, 0xbf55bec4, 0xbe483f80, 0x3f0ebf6d, 0x3dc9bf80, 0xbe953f7b, 0x3f46bf35, 0xbf623f0e
  .long 0xbf800000, 0x3f800000, 0xbf800000, 0x3f800000, 0x3dc93f80, 0xbe95bf7b, 0x3f463f35, 0xbf62bf0e
  .long 0x3f7b0000, 0xbf553ec4, 0xbe48bf80, 0x3f0e3f6d, 0xbe95bf80, 0x3f463f55, 0xbef13f35, 0xbdc9bf7b
  .long 0xbf6d0000, 0x3ec4bf35, 0x3f6d0000, 0xbec43f35, 0x3ef13f80, 0xbf7fbf0e, 0xbf75bf35, 0x3f46be48
  .long 0x3f550000, 0x3e483f6d, 0x3f0e3f80, 0xbf7bbec4, 0xbf22bf80, 0x3f623e48, 0x3dc9bf35, 0x3f753f55
  .long 0xbf350000, 0xbf35bf80, 0xbf350000, 0xbf35bf80, 0x3f463f80, 0xbef13e48, 0x3f7f3f35, 0x3e953f55
  .long 0x3f0e0000, 0x3f7b3f6d, 0xbf55bf80, 0x3e48bec4, 0xbf62bf80, 0xbdc9bf0e, 0x3e953f35, 0xbf22be48
  .long 0xbec40000, 0xbf6dbf35, 0x3ec40000, 0x3f6d3f35, 0x3f753f80, 0x3f223f55, 0xbf62bf35, 0xbf7fbf7b
  .long 0x3e480000, 0x3f0e3ec4, 0x3f7b3f80, 0x3f553f6d, 0xbf7fbf80, 0xbf75bf7b, 0xbf22bf35, 0xbef1bf0e
  .long 0x00000000, 0x00000000, 0x00000000, 0x00000000, 0xbf623f6d, 0xbf463f55, 0xbe953ec4, 0xbdc93e48
  .long 0x3f55bf35, 0x3f7bbf6d, 0x3f0ebf35, 0x3e48bec4, 0x3dc9bec4, 0xbef13e48, 0xbf463f6d, 0xbe953f0e
  .long 0xbf6d3f80, 0xbec43f35, 0x3f6dbf80, 0x3ec4bf35, 0x3f46bec4, 0x3f75bf7b, 0xbf7f3f6d, 0xbef13f55
  .long 0x3e48bf35, 0xbf553ec4, 0x3f7bbf35, 0x3f0ebf6d, 0xbf753f6d, 0x3dc93f0e, 0xbf623ec4, 0xbf223f7b
  .long 0x3f350000, 0x3f35bf80, 0x3f350000, 0x3f35bf80, 0x3e95bf6d, 0xbf7f3f0e, 0xbef1bec4, 0xbf463f7b
  .long 0xbf7b3f35, 0x3f0e3ec4, 0x3e483f35, 0x3f55bf6d, 0x3f223ec4, 0x3e95bf7b, 0x3dc9bf6d, 0xbf623f55
  .long 0x3ec4bf80, 0xbf6d3f35, 0xbec43f80, 0x3f6dbf35, 0xbf7f3ec4, 0x3f623e48, 0x3f22bf6d, 0xbf753f0e
  .long 0x3f0e3f35, 0xbe48bf6d, 0xbf553f35, 0x3f7bbec4, 0x3ef1bf6d, 0xbf223f55, 0x3f75bec4, 0xbf7f3e48
  .long 0xbf800000, 0x3f800000, 0xbf800000, 0x3f800000, 0x3ef13f6d, 0xbf22bf55, 0x3f753ec4, 0xbf7fbe48
  .long 0x3f0ebf35, 0xbe483f6d, 0xbf55bf35, 0x3f7b3ec4, 0xbf7fbec4, 0x3f62be48, 0x3f223f6d, 0xbf75bf0e
  .long 0x3ec43f80, 0xbf6dbf35, 0xbec4bf80, 0x3f6d3f35, 0x3f22bec4, 0x3e953f7b, 0x3dc93f6d, 0xbf62bf55
  .long 0xbf7bbf35, 0x3f0ebec4, 0x3e48bf35, 0x3f553f6d, 0x3e953f6d, 0xbf7fbf0e, 0xbef13ec4, 0xbf46bf7b
  .long 0x3f350000, 0x3f353f80, 0x3f350000, 0x3f353f80, 0xbf75bf6d, 0x3dc9bf0e, 0xbf62bec4, 0xbf22bf7b
  .long 0x3e483f35, 0xbf55bec4, 0x3f7b3f35, 0x3f0e3f6d, 0x3f463ec4, 0x3f753f7b, 0xbf7fbf6d, 0xbef1bf55
  .long 0xbf6dbf80, 0xbec4bf35, 0x3f6d3f80, 0x3ec43f35, 0x3dc93ec4, 0xbef1be48, 0xbf46bf6d, 0xbe95bf0e
  .long 0x3f553f35, 0x3f7b3f6d, 0x3f0e3f35, 0x3e483ec4, 0xbf62bf6d, 0xbf46bf55, 0xbe95bec4, 0xbdc9be48
  .long 0x00000000, 0x00000000, 0x00000000, 0x00000000, 0x3dc90000, 0x3e95be48, 0x3f46bf35, 0x3f62bf55
  .long 0xbe480000, 0xbf0e3ec4, 0xbf7b3f80, 0xbf553f6d, 0x3e950000, 0x3f46bf0e, 0x3ef1bf35, 0xbdc9be48
  .long 0xbec40000, 0xbf6d3f35, 0x3ec40000, 0x3f6dbf35, 0x3ef10000, 0x3f7fbf55, 0xbf753f35, 0xbf463f7b
  .long 0xbf0e0000, 0xbf7b3f6d, 0x3f55bf80, 0xbe48bec4, 0x3f220000, 0x3f62bf7b, 0xbdc93f35, 0x3f75bf0e
  .long 0xbf350000, 0xbf353f80, 0xbf350000, 0xbf353f80, 0x3f460000, 0x3ef1bf7b, 0x3f7fbf35, 0xbe95bf0e
  .long 0xbf550000, 0xbe483f6d, 0xbf0e3f80, 0x3f7bbec4, 0x3f620000, 0xbdc9bf55, 0xbe95bf35, 0xbf223f7b
  .long 0xbf6d0000, 0x3ec43f35, 0x3f6d0000, 0xbec4bf35, 0x3f750000, 0xbf22bf0e, 0xbf623f35, 0x3f7fbe48
  .long 0xbf7b0000, 0x3f553ec4, 0x3e48bf80, 0xbf0e3f6d, 0x3f7f0000, 0xbf75be48, 0x3f223f35, 0xbef1bf55
  .long 0xbf800000, 0x3f800000, 0xbf800000, 0x3f800000, 0x3f7f0000, 0xbf753e48, 0x3f22bf35, 0xbef13f55
  .long 0xbf7b0000, 0x3f55bec4, 0x3e483f80, 0xbf0ebf6d, 0x3f750000, 0xbf223f0e, 0xbf62bf35, 0x3f7f3e48
  .long 0xbf6d0000, 0x3ec4bf35, 0x3f6d0000, 0xbec43f35, 0x3f620000, 0xbdc93f55, 0xbe953f35, 0xbf22bf7b
  .long 0xbf550000, 0xbe48bf6d, 0xbf0ebf80, 0x3f7b3ec4, 0x3f460000, 0x3ef13f7b, 0x3f7f3f35, 0xbe953f0e
  .long 0xbf350000, 0xbf35bf80, 0xbf350000, 0xbf35bf80, 0x3f220000, 0x3f623f7b, 0xbdc9bf35, 0x3f753f0e
  .long 0xbf0e0000, 0xbf7bbf6d, 0x3f553f80, 0xbe483ec4, 0x3ef10000, 0x3f7f3f55, 0xbf75bf35, 0xbf46bf7b
  .long 0xbec40000, 0xbf6dbf35, 0x3ec40000, 0x3f6d3f35, 0x3e950000, 0x3f463f0e, 0x3ef13f35, 0xbdc93e48
  .long 0xbe480000, 0xbf0ebec4, 0xbf7bbf80, 0xbf55bf6d, 0x3dc90000, 0x3e953e48, 0x3f463f35, 0x3f623f55
  .long 0x00000000, 0x00000000, 0x00000000, 0x00000000, 0x3ef1bec4, 0x3f22bf0e, 0x3f75bf6d, 0x3f7fbf7b
  .long 0xbf553f35, 0xbf7b3f6d, 0xbf0e3f35, 0xbe483ec4, 0x3f7fbf6d, 0x3f62bf7b, 0xbf223ec4, 0xbf753f55
  .long 0xbf6d3f80, 0xbec43f35, 0x3f6dbf80, 0x3ec4bf35, 0x3f22bf6d, 0xbe95be48, 0x3dc93ec4, 0x3f62bf0e
  .long 0xbe483f35, 0x3f55bec4, 0xbf7b3f35, 0xbf0e3f6d, 0xbe95bec4, 0xbf7f3f55, 0x3ef1bf6d, 0xbf463e48
  .long 0x3f350000, 0x3f35bf80, 0x3f350000, 0x3f35bf80, 0xbf753ec4, 0xbdc93f55, 0xbf623f6d, 0x3f223e48
  .long 0x3f7bbf35, 0xbf0ebec4, 0xbe48bf35, 0xbf553f6d, 0xbf463f6d, 0x3f75be48, 0x3f7fbec4, 0xbef1bf0e
  .long 0x3ec4bf80, 0xbf6d3f35, 0xbec43f80, 0x3f6dbf35, 0x3dc93f6d, 0x3ef1bf7b, 0xbf46bec4, 0x3e953f55
  .long 0xbf0ebf35, 0x3e483f6d, 0x3f55bf35, 0xbf7b3ec4, 0x3f623ec4, 0xbf46bf0e, 0x3e953f6d, 0xbdc9bf7b
  .long 0xbf800000, 0x3f800000, 0xbf800000, 0x3f800000, 0x3f62bec4, 0xbf463f0e, 0x3e95bf6d, 0xbdc93f7b
  .long 0xbf0e3f35, 0x3e48bf6d, 0x3f553f35, 0xbf7bbec4, 0x3dc9bf6d, 0x3ef13f7b, 0xbf463ec4, 0x3e95bf55
  .long 0x3ec43f80, 0xbf6dbf35, 0xbec4bf80, 0x3f6d3f35, 0xbf46bf6d, 0x3f753e48, 0x3f7f3ec4, 0xbef13f0e
  .long 0x3f7b3f35, 0xbf0e3ec4, 0xbe483f35, 0xbf55bf6d, 0xbf75bec4, 0xbdc9bf55, 0xbf62bf6d, 0x3f22be48
  .long 0x3f350000, 0x3f353f80, 0x3f350000, 0x3f353f80, 0xbe953ec4, 0xbf7fbf55, 0x3ef13f6d, 0xbf46be48
  .long 0xbe48bf35, 0x3f553ec4, 0xbf7bbf35, 0xbf0ebf6d, 0x3f223f6d, 0xbe953e48, 0x3dc9bec4, 0x3f623f0e
  .long 0xbf6dbf80, 0xbec4bf35, 0x3f6d3f80, 0x3ec43f35, 0x3f7f3f6d, 0x3f623f7b, 0xbf22bec4, 0xbf75bf55
  .long 0xbf55bf35, 0xbf7bbf6d, 0xbf0ebf35, 0xbe48bec4, 0x3ef13ec4, 0x3f223f0e, 0x3f753f6d, 0x3f7f3f7b
  .long 0x00000000, 0x00000000, 0x00000000, 0x00000000, 0x3f7fbf80, 0x3f75bf7b, 0x3f22bf35, 0x3ef1bf0e
  .long 0x3e480000, 0x3f0ebec4, 0x3f7bbf80, 0x3f55bf6d, 0xbf753f80, 0xbf223f55, 0x3f62bf35, 0x3f7fbf7b
  .long 0xbec40000, 0xbf6d3f35, 0x3ec40000, 0x3f6dbf35, 0x3f62bf80, 0x3dc9bf0e, 0xbe953f35, 0x3f22be48
  .long 0x3f0e0000, 0x3f7bbf6d, 0xbf553f80, 0x3e483ec4, 0xbf463f80, 0x3ef13e48, 0xbf7f3f35, 0xbe953f55
  .long 0xbf350000, 0xbf353f80, 0xbf350000, 0xbf353f80, 0x3f22bf80, 0xbf623e48, 0xbdc9bf35, 0xbf753f55
  .long 0x3f550000, 0x3e48bf6d, 0x3f0ebf80, 0xbf7b3ec4, 0xbef13f80, 0x3f7fbf0e, 0x3f75bf35, 0xbf46be48
  .long 0xbf6d0000, 0x3ec43f35, 0x3f6d0000, 0xbec4bf35, 0x3e95bf80, 0xbf463f55, 0x3ef13f35, 0x3dc9bf7b
  .long 0x3f7b0000, 0xbf55bec4, 0xbe483f80, 0x3f0ebf6d, 0xbdc93f80, 0x3e95bf7b, 0xbf463f35, 0x3f62bf0e
  .long 0xbf800000, 0x3f800000, 0xbf800000, 0x3f800000, 0xbdc9bf80, 0x3e953f7b, 0xbf46bf35, 0x3f623f0e
  .long 0x3f7b0000, 0xbf553ec4, 0xbe48bf80, 0x3f0e3f6d, 0x3e953f80, 0xbf46bf55, 0x3ef1bf35, 0x3dc93f7b
  .long 0xbf6d0000, 0x3ec4bf35, 0x3f6d0000, 0xbec43f35, 0xbef1bf80, 0x3f7f3f0e, 0x3f753f35, 0xbf463e48
  .long 0x3f550000, 0x3e483f6d, 0x3f0e3f80, 0xbf7bbec4, 0x3f223f80, 0xbf62be48, 0xbdc93f35, 0xbf75bf55
  .long 0xbf350000, 0xbf35bf80, 0xbf350000, 0xbf35bf80, 0xbf46bf80, 0x3ef1be48, 0xbf7fbf35, 0xbe95bf55
  .long 0x3f0e0000, 0x3f7b3f6d, 0xbf55bf80, 0x3e48bec4, 0x3f623f80, 0x3dc93f0e, 0xbe95bf35, 0x3f223e48
  .long 0xbec40000, 0xbf6dbf35, 0x3ec40000, 0x3f6d3f35, 0xbf75bf80, 0xbf22bf55, 0x3f623f35, 0x3f7f3f7b
  .long 0x3e480000, 0x3f0e3ec4, 0x3f7b3f80, 0x3f553f6d, 0x3f7f3f80, 0x3f753f7b, 0x3f223f35, 0x3ef13f0e
  .long 0x00000000, 0x00000000, 0x00000000, 0x00000000, 0x3f62bf6d, 0x3f46bf55, 0x3e95bec4, 0x3dc9be48
  .long 0x3f55bf35, 0x3f7bbf6d, 0x3f0ebf35, 0x3e48bec4, 0xbdc93ec4, 0x3ef1be48, 0x3f46bf6d, 0x3e95bf0e
  .long 0xbf6d3f80, 0xbec43f35, 0x3f6dbf80, 0x3ec4bf35, 0xbf463ec4, 0xbf753f7b, 0x3f7fbf6d, 0x3ef1bf55
  .long 0x3e48bf35, 0xbf553ec4, 0x3f7bbf35, 0x3f0ebf6d, 0x3f75bf6d, 0xbdc9bf0e, 0x3f62bec4, 0x3f22bf7b
  .long 0x3f350000, 0x3f35bf80, 0x3f350000, 0x3f35bf80, 0xbe953f6d, 0x3f7fbf0e, 0x3ef13ec4, 0x3f46bf7b
  .long 0xbf7b3f35, 0x3f0e3ec4, 0x3e483f35, 0x3f55bf6d, 0xbf22bec4, 0xbe953f7b, 0xbdc93f6d, 0x3f62bf55
  .long 0x3ec4bf80, 0xbf6d3f35, 0xbec43f80, 0x3f6dbf35, 0x3f7fbec4, 0xbf62be48, 0xbf223f6d, 0x3f75bf0e
  .long 0x3f0e3f35, 0xbe48bf6d, 0xbf553f35, 0x3f7bbec4, 0xbef13f6d, 0x3f22bf55, 0xbf753ec4, 0x3f7fbe48
  .long 0xbf800000, 0x3f800000, 0xbf800000, 0x3f800000, 0xbef1bf6d, 0x3f223f55, 0xbf75bec4, 0x3f7f3e48
  .long 0x3f0ebf35, 0xbe483f6d, 0xbf55bf35, 0x3f7b3ec4, 0x3f7f3ec4, 0xbf623e48, 0xbf22bf6d, 0x3f753f0e
  .long 0x3ec43f80, 0xbf6dbf35, 0xbec4bf80, 0x3f6d3f35, 0xbf223ec4, 0xbe95bf7b, 0xbdc9bf6d, 0x3f623f55
  .long 0xbf7bbf35, 0x3f0ebec4, 0x3e48bf35, 0x3f553f6d, 0xbe95bf6d, 0x3f7f3f0e, 0x3ef1bec4, 0x3f463f7b
  .long 0x3f350000, 0x3f353f80, 0x3f350000, 0x3f353f80, 0x3f753f6d, 0xbdc93f0e, 0x3f623ec4, 0x3f223f7b
  .long 0x3e483f35, 0xbf55bec4, 0x3f7b3f35, 0x3f0e3f6d, 0xbf46bec4, 0xbf75bf7b, 0x3f7f3f6d, 0x3ef13f55
  .long 0xbf6dbf80, 0xbec4bf35, 0x3f6d3f80, 0x3ec43f35, 0xbdc9bec4, 0x3ef13e48, 0x3f463f6d, 0x3e953f0e
  .long 0x3f553f35, 0x3f7b3f6d, 0x3f0e3f35, 0x3e483ec4, 0x3f623f6d, 0x3f463f55, 0x3e953ec4, 0x3dc93e48
TBL_END:
```
